```python
import torch

def _softmax(x, axis=-1):
    return torch.softmax(x, dim=axis)
def _gelu(x):
    return torch.nn.functional.gelu(x, approximate="tanh")
def _silu(x):
    return torch.nn.functional.silu(x)
def _sigmoid(x):
    return torch.sigmoid(x)
def _layernorm(x, axis=-1, eps=1e-5):
    m = x.mean(dim=axis, keepdim=True)
    v = x.var(dim=axis, keepdim=True, unbiased=False)
    return (x - m) / torch.sqrt(v + eps)
def _scatter_add(tgt, idx, src, axis=0):
    return tgt.clone().index_add_(axis, idx, src)
def _segment_sum(src, seg, n):
    out = torch.zeros((n,) + src.shape[1:], dtype=src.dtype)
    return out.index_add_(0, seg, src)
def _pad(x, pw):
    flat = tuple(v for pair in reversed(pw) for v in pair)
    return torch.nn.functional.pad(x, flat)

kernel_name = 'recurrent_scan__softmax_full_mha__glu_gated_swiglu__prompt'

def setup_inputs():

    _w = (lambda a: (lambda t: t.to(torch.bfloat16) if t.is_floating_point() else t)(torch.as_tensor(a)))
    def _A_setup():
        B, S, D = 1, 2048, 512
        return {
            "x": _w((lambda *s: torch.randn(*s, dtype=torch.bfloat16) * 0.05)(B, S, D)),
            "wqkv": _w((lambda *s: torch.randn(*s, dtype=torch.bfloat16) * 0.2)(D, 3 * D)),
            "wo": _w((lambda *s: torch.randn(*s, dtype=torch.bfloat16) * 0.2)(D, D)),
        }
    _A_in = _A_setup()

    def _B_setup():
        B, S, D, F = 1, 2048, 512, 1792
        return {
            "x": _w((lambda *s: torch.randn(*s, dtype=torch.bfloat16) * 0.05)(B, S, D)),
            "w1": _w((lambda *s: torch.randn(*s, dtype=torch.bfloat16) * 0.1)(D, F) * (2.0 / D) ** 0.5),
            "w3": _w((lambda *s: torch.randn(*s, dtype=torch.bfloat16) * 0.1)(D, F) * (2.0 / D) ** 0.5),
            "w2": _w((lambda *s: torch.randn(*s, dtype=torch.bfloat16) * 0.1)(F, D) * (2.0 / F) ** 0.5),
        }
    _B_in = _B_setup()

    return {
        "A_x": _A_in["x"],
        "A_wqkv": _A_in["wqkv"],
        "A_wo": _A_in["wo"],
        "B_x": _B_in["x"],
        "B_w1": _B_in["w1"],
        "B_w3": _B_in["w3"],
        "B_w2": _B_in["w2"],
    }

def reference(A_x, A_wqkv, A_wo, B_x, B_w1, B_w3, B_w2):
    def _A_ref(x, wqkv, wo):
        B, S, D = x.shape
        H = 32; Dh = D // H
        qkv = (lambda x, *d: x.permute(*d))((x @ wqkv).reshape(B, S, 3, H, Dh), 2, 0, 3, 1, 4)
        q, k, v = qkv[0], qkv[1], qkv[2]
        scale = Dh ** -0.5
        scores = torch.einsum("bhqd,bhkd->bhqk", q, k) * scale
        p = _softmax(scores, axis=-1)
        o = torch.einsum("bhqk,bhkd->bhqd", p, v)
        return (lambda x, *d: x.permute(*d))(o, 0, 2, 1, 3).reshape(B, S, D) @ wo

    def _B_ref(x, w1, w3, w2):
        gate = torch.einsum("bsd,df->bsf", x, w1)
        up = torch.einsum("bsd,df->bsf", x, w3)
        h = _silu(gate) * up
        out = torch.einsum("bsf,fd->bsd", h, w2)
        return out

    x = A_x
    xn = _layernorm(x, axis=-1)
    s = _A_ref(xn, A_wqkv, A_wo)
    g = _silu(_B_ref(xn, B_w1, B_w3, B_w2))
    return x + s * g
```

```asm
; @launch grid=(256,1,1) block=(512,1,1) lds=163840
.amdgcn_target "amdgcn-amd-amdhsa--gfx950"
.text
.globl recurrent_scan__softmax_full_mha__glu_gated_swiglu__prompt_kernel
.p2align 8
.type recurrent_scan__softmax_full_mha__glu_gated_swiglu__prompt_kernel,@function
recurrent_scan__softmax_full_mha__glu_gated_swiglu__prompt_kernel:
    s_cmp_ge_u32 s2, 256
    s_cbranch_scc1 L_exit
    s_load_dwordx16 s[4:19], s[0:1], 0
    s_load_dwordx4 s[20:23], s[0:1], 64
    v_lshrrev_b32 v1, 6, v0
    v_and_b32 v0, 63, v0
    v_readfirstlane_b32 s3, v1
    s_and_b32 s48, s2, 7
    s_lshr_b32 s49, s2, 3
    s_getpc_b64 s[44:45]
L_pc:
    s_sub_u32 s44, s44, L_pc-recurrent_scan__softmax_full_mha__glu_gated_swiglu__prompt_kernel
    s_subb_u32 s45, s45, 0
    s_lshl_b32 s57, s3, 5
    s_add_u32 s57, s57, s49
    v_lshl_add_u32 v2, v0, 8, s57
    v_lshlrev_b32 v2, 7, v2
    v_min_u32 v2, L_code_end-recurrent_scan__softmax_full_mha__glu_gated_swiglu__prompt_kernel-4, v2
    v_mov_b32 v3, s45
    v_add_co_u32 v2, vcc, s44, v2
    s_nop 1
    v_addc_co_u32 v3, vcc, 0, v3, vcc
    global_load_dword v255, v[2:3], off
    s_and_b32 s55, s49, 7
    s_lshr_b32 s53, s49, 3
    s_lshl_b32 s54, s48, 2
    s_add_u32 s54, s54, s53
    s_lshr_b32 s52, s48, 1
    s_and_b32 s50, s48, 1
    s_lshl_b32 s50, s50, 3
    s_add_u32 s50, s50, s55
    s_lshl_b32 s51, s52, 2
    s_add_u32 s51, s51, s53
    s_and_b32 s56, s3, 3
    v_lshlrev_b32 v1, 4, v0
    s_cmp_ge_u32 s3, 4
    s_cbranch_scc1 L_helper
    s_lshl_b32 s58, s50, 2
    s_add_u32 s58, s58, s56
    v_lshrrev_b32 v104, 3, v0
    v_lshlrev_b32 v104, 10, v104
    v_lshrrev_b32 v105, 4, v0
    v_and_b32 v106, 7, v0
    v_xor_b32 v106, v105, v106
    v_lshl_add_u32 v96, v106, 4, v104
    v_xor_b32 v97, 64, v96
    v_add_u32 v97, 8192, v97
    v_add_u32 v98, 16384, v96
    v_add_u32 v99, 16384, v97
    s_lshl_b32 s57, s58, 15
    s_lshl_b32 s67, s56, 15
    s_waitcnt lgkmcnt(0)
    s_mov_b32 s24, s22
    s_mov_b32 s25, s23
    s_mov_b32 s26, 20971520
    s_mov_b32 s27, 0x00020000
    s_mov_b32 s28, s4
    s_mov_b32 s29, s5
    s_mov_b32 s30, 2097152
    s_mov_b32 s31, 0x00020000
    s_mov_b32 m0, s67
    s_add_u32 s68, s57, 1024
L_xload:
    buffer_load_dwordx4 v96, s[28:31], s57 offen lds
    s_addk_i32 m0, 1024
    s_nop 0
    buffer_load_dwordx4 v97, s[28:31], s57 offen lds
    s_addk_i32 m0, 1024
    s_nop 0
    buffer_load_dwordx4 v98, s[28:31], s57 offen lds
    s_addk_i32 m0, 1024
    s_nop 0
    buffer_load_dwordx4 v99, s[28:31], s57 offen lds
    s_addk_i32 m0, 1024
    s_addk_i32 s57, 128
    s_cmp_lg_u32 s57, s68
    s_cbranch_scc1 L_xload
    v_and_b32 v104, 31, v0
    v_lshlrev_b32 v105, 7, v104
    v_add_u32 v105, s67, v105
    v_bfe_u32 v104, v0, 1, 3
    v_lshrrev_b32 v106, 5, v0
    v_xor_b32 v104, v104, v106
    v_xor_b32 v100, 0, v104
    v_lshl_add_u32 v100, v100, 4, v105
    v_xor_b32 v101, 2, v104
    v_lshl_add_u32 v101, v101, 4, v105
    v_xor_b32 v102, 4, v104
    v_lshl_add_u32 v102, v102, 4, v105
    v_xor_b32 v103, 6, v104
    v_lshl_add_u32 v103, v103, 4, v105
    v_bfe_u32 v104, v0, 2, 2
    v_and_b32 v105, 3, v0
    v_lshlrev_b32 v105, 3, v105
    v_lshl_add_u32 v105, v106, 8, v105
    v_add_u32 v105, 102912, v105
    v_bfe_u32 v106, v0, 4, 1
    v_mul_u32_u24 v3, 1056, v104
    v_mul_u32_u24 v4, 4224, v106
    v_add3_u32 v3, v3, v4, v105
    v_mul_u32_u24 v4, 1088, v104
    v_lshl_add_u32 v4, v106, 5, v4
    v_add_u32 v4, v4, v105
    v_lshrrev_b32 v104, 5, v0
    v_lshlrev_b32 v104, 8, v104
    v_and_b32 v105, 15, v0
    v_lshl_add_u32 v104, v105, 4, v104
    v_lshl_add_u32 v104, v106, 17, v104
    v_add_u32 v104, 1024, v104
    s_cmp_lt_u32 s53, 2
    s_cselect_b64 vcc, -1, 0
    s_movk_i32 s57, 512
    s_cselect_b32 s57, 131072, s57
    v_cndmask_b32 v2, v104, v1, vcc
    s_and_b32 s63, s53, 1
    s_lshl_b32 s64, s52, 1
    s_add_u32 s63, s63, s64
    s_lshl_b32 s63, s63, 8
    s_add_u32 s63, s63, s58
    s_lshl_b32 s63, s63, 11
    s_add_u32 s64, s63, s57
    s_add_u32 s65, s63, 262144
    s_add_u32 s66, s64, 262144
    s_mul_i32 s62, s52, 7
    s_lshl_b32 s57, s53, 1
    s_add_u32 s62, s62, s57
    s_lshl_b32 s62, s62, 2
    s_mul_i32 s57, s58, 112
    s_add_u32 s62, s62, s57
    s_lshl_b32 s62, s62, 10
    s_add_u32 s62, s62, 8388608
    s_sub_u32 s61, s62, 4096
    s_lshl_b32 s70, s52, 9
    s_add_u32 s70, s70, s58
    s_lshl_b32 s70, s70, 10
    s_add_u32 s70, s70, 4194304
    s_mov_b32 s59, 0xffff0000
    s_mov_b32 s60, 0xbfb8aa3b
    s_mov_b32 s69, 0x3f803f80
    s_lshl_b32 s57, s51, 6
    s_add_u32 s57, s57, s58
    s_lshl_b32 s57, s57, 7
    s_add_u32 s57, s57, 16777216
    s_add_u32 s32, s22, s57
    s_addc_u32 s33, s23, 0
    s_mov_b32 s34, 4
    s_mov_b32 s35, 0x00020000
    v_mov_b32 v108, 0
    v_mov_b32 v109, 0
    v_mov_b32 v110, 0
    v_mov_b32 v111, 0
    s_waitcnt vmcnt(28)
    ds_read_b128 v[128:131], v100 offset:0
    ds_read_b128 v[132:135], v101 offset:0
    ds_read_b128 v[136:139], v102 offset:0
    ds_read_b128 v[140:143], v103 offset:0
    s_waitcnt vmcnt(24)
    ds_read_b128 v[144:147], v100 offset:4096
    ds_read_b128 v[148:151], v101 offset:4096
    ds_read_b128 v[152:155], v102 offset:4096
    ds_read_b128 v[156:159], v103 offset:4096
    s_waitcnt lgkmcnt(4)
    v_dot2c_f32_bf16 v108, s69, v128
    v_dot2c_f32_bf16 v110, v128, v128
    v_dot2c_f32_bf16 v109, s69, v129
    v_dot2c_f32_bf16 v111, v129, v129
    v_dot2c_f32_bf16 v108, s69, v130
    v_dot2c_f32_bf16 v110, v130, v130
    v_dot2c_f32_bf16 v109, s69, v131
    v_dot2c_f32_bf16 v111, v131, v131
    v_dot2c_f32_bf16 v108, s69, v132
    v_dot2c_f32_bf16 v110, v132, v132
    v_dot2c_f32_bf16 v109, s69, v133
    v_dot2c_f32_bf16 v111, v133, v133
    v_dot2c_f32_bf16 v108, s69, v134
    v_dot2c_f32_bf16 v110, v134, v134
    v_dot2c_f32_bf16 v109, s69, v135
    v_dot2c_f32_bf16 v111, v135, v135
    v_dot2c_f32_bf16 v108, s69, v136
    v_dot2c_f32_bf16 v110, v136, v136
    v_dot2c_f32_bf16 v109, s69, v137
    v_dot2c_f32_bf16 v111, v137, v137
    v_dot2c_f32_bf16 v108, s69, v138
    v_dot2c_f32_bf16 v110, v138, v138
    v_dot2c_f32_bf16 v109, s69, v139
    v_dot2c_f32_bf16 v111, v139, v139
    v_dot2c_f32_bf16 v108, s69, v140
    v_dot2c_f32_bf16 v110, v140, v140
    v_dot2c_f32_bf16 v109, s69, v141
    v_dot2c_f32_bf16 v111, v141, v141
    v_dot2c_f32_bf16 v108, s69, v142
    v_dot2c_f32_bf16 v110, v142, v142
    v_dot2c_f32_bf16 v109, s69, v143
    v_dot2c_f32_bf16 v111, v143, v143
    s_waitcnt vmcnt(20)
    ds_read_b128 v[160:163], v100 offset:8192
    ds_read_b128 v[164:167], v101 offset:8192
    ds_read_b128 v[168:171], v102 offset:8192
    ds_read_b128 v[172:175], v103 offset:8192
    s_waitcnt lgkmcnt(4)
    v_dot2c_f32_bf16 v108, s69, v144
    v_dot2c_f32_bf16 v110, v144, v144
    v_dot2c_f32_bf16 v109, s69, v145
    v_dot2c_f32_bf16 v111, v145, v145
    v_dot2c_f32_bf16 v108, s69, v146
    v_dot2c_f32_bf16 v110, v146, v146
    v_dot2c_f32_bf16 v109, s69, v147
    v_dot2c_f32_bf16 v111, v147, v147
    v_dot2c_f32_bf16 v108, s69, v148
    v_dot2c_f32_bf16 v110, v148, v148
    v_dot2c_f32_bf16 v109, s69, v149
    v_dot2c_f32_bf16 v111, v149, v149
    v_dot2c_f32_bf16 v108, s69, v150
    v_dot2c_f32_bf16 v110, v150, v150
    v_dot2c_f32_bf16 v109, s69, v151
    v_dot2c_f32_bf16 v111, v151, v151
    v_dot2c_f32_bf16 v108, s69, v152
    v_dot2c_f32_bf16 v110, v152, v152
    v_dot2c_f32_bf16 v109, s69, v153
    v_dot2c_f32_bf16 v111, v153, v153
    v_dot2c_f32_bf16 v108, s69, v154
    v_dot2c_f32_bf16 v110, v154, v154
    v_dot2c_f32_bf16 v109, s69, v155
    v_dot2c_f32_bf16 v111, v155, v155
    v_dot2c_f32_bf16 v108, s69, v156
    v_dot2c_f32_bf16 v110, v156, v156
    v_dot2c_f32_bf16 v109, s69, v157
    v_dot2c_f32_bf16 v111, v157, v157
    v_dot2c_f32_bf16 v108, s69, v158
    v_dot2c_f32_bf16 v110, v158, v158
    v_dot2c_f32_bf16 v109, s69, v159
    v_dot2c_f32_bf16 v111, v159, v159
    s_waitcnt vmcnt(16)
    ds_read_b128 v[176:179], v100 offset:12288
    ds_read_b128 v[180:183], v101 offset:12288
    ds_read_b128 v[184:187], v102 offset:12288
    ds_read_b128 v[188:191], v103 offset:12288
    s_waitcnt lgkmcnt(4)
    v_dot2c_f32_bf16 v108, s69, v160
    v_dot2c_f32_bf16 v110, v160, v160
    v_dot2c_f32_bf16 v109, s69, v161
    v_dot2c_f32_bf16 v111, v161, v161
    v_dot2c_f32_bf16 v108, s69, v162
    v_dot2c_f32_bf16 v110, v162, v162
    v_dot2c_f32_bf16 v109, s69, v163
    v_dot2c_f32_bf16 v111, v163, v163
    v_dot2c_f32_bf16 v108, s69, v164
    v_dot2c_f32_bf16 v110, v164, v164
    v_dot2c_f32_bf16 v109, s69, v165
    v_dot2c_f32_bf16 v111, v165, v165
    v_dot2c_f32_bf16 v108, s69, v166
    v_dot2c_f32_bf16 v110, v166, v166
    v_dot2c_f32_bf16 v109, s69, v167
    v_dot2c_f32_bf16 v111, v167, v167
    v_dot2c_f32_bf16 v108, s69, v168
    v_dot2c_f32_bf16 v110, v168, v168
    v_dot2c_f32_bf16 v109, s69, v169
    v_dot2c_f32_bf16 v111, v169, v169
    v_dot2c_f32_bf16 v108, s69, v170
    v_dot2c_f32_bf16 v110, v170, v170
    v_dot2c_f32_bf16 v109, s69, v171
    v_dot2c_f32_bf16 v111, v171, v171
    v_dot2c_f32_bf16 v108, s69, v172
    v_dot2c_f32_bf16 v110, v172, v172
    v_dot2c_f32_bf16 v109, s69, v173
    v_dot2c_f32_bf16 v111, v173, v173
    v_dot2c_f32_bf16 v108, s69, v174
    v_dot2c_f32_bf16 v110, v174, v174
    v_dot2c_f32_bf16 v109, s69, v175
    v_dot2c_f32_bf16 v111, v175, v175
    s_waitcnt vmcnt(12)
    ds_read_b128 v[192:195], v100 offset:16384
    ds_read_b128 v[196:199], v101 offset:16384
    ds_read_b128 v[200:203], v102 offset:16384
    ds_read_b128 v[204:207], v103 offset:16384
    s_waitcnt lgkmcnt(4)
    v_dot2c_f32_bf16 v108, s69, v176
    v_dot2c_f32_bf16 v110, v176, v176
    v_dot2c_f32_bf16 v109, s69, v177
    v_dot2c_f32_bf16 v111, v177, v177
    v_dot2c_f32_bf16 v108, s69, v178
    v_dot2c_f32_bf16 v110, v178, v178
    v_dot2c_f32_bf16 v109, s69, v179
    v_dot2c_f32_bf16 v111, v179, v179
    v_dot2c_f32_bf16 v108, s69, v180
    v_dot2c_f32_bf16 v110, v180, v180
    v_dot2c_f32_bf16 v109, s69, v181
    v_dot2c_f32_bf16 v111, v181, v181
    v_dot2c_f32_bf16 v108, s69, v182
    v_dot2c_f32_bf16 v110, v182, v182
    v_dot2c_f32_bf16 v109, s69, v183
    v_dot2c_f32_bf16 v111, v183, v183
    v_dot2c_f32_bf16 v108, s69, v184
    v_dot2c_f32_bf16 v110, v184, v184
    v_dot2c_f32_bf16 v109, s69, v185
    v_dot2c_f32_bf16 v111, v185, v185
    v_dot2c_f32_bf16 v108, s69, v186
    v_dot2c_f32_bf16 v110, v186, v186
    v_dot2c_f32_bf16 v109, s69, v187
    v_dot2c_f32_bf16 v111, v187, v187
    v_dot2c_f32_bf16 v108, s69, v188
    v_dot2c_f32_bf16 v110, v188, v188
    v_dot2c_f32_bf16 v109, s69, v189
    v_dot2c_f32_bf16 v111, v189, v189
    v_dot2c_f32_bf16 v108, s69, v190
    v_dot2c_f32_bf16 v110, v190, v190
    v_dot2c_f32_bf16 v109, s69, v191
    v_dot2c_f32_bf16 v111, v191, v191
    s_waitcnt vmcnt(8)
    ds_read_b128 v[208:211], v100 offset:20480
    ds_read_b128 v[212:215], v101 offset:20480
    ds_read_b128 v[216:219], v102 offset:20480
    ds_read_b128 v[220:223], v103 offset:20480
    s_waitcnt lgkmcnt(4)
    v_dot2c_f32_bf16 v108, s69, v192
    v_dot2c_f32_bf16 v110, v192, v192
    v_dot2c_f32_bf16 v109, s69, v193
    v_dot2c_f32_bf16 v111, v193, v193
    v_dot2c_f32_bf16 v108, s69, v194
    v_dot2c_f32_bf16 v110, v194, v194
    v_dot2c_f32_bf16 v109, s69, v195
    v_dot2c_f32_bf16 v111, v195, v195
    v_dot2c_f32_bf16 v108, s69, v196
    v_dot2c_f32_bf16 v110, v196, v196
    v_dot2c_f32_bf16 v109, s69, v197
    v_dot2c_f32_bf16 v111, v197, v197
    v_dot2c_f32_bf16 v108, s69, v198
    v_dot2c_f32_bf16 v110, v198, v198
    v_dot2c_f32_bf16 v109, s69, v199
    v_dot2c_f32_bf16 v111, v199, v199
    v_dot2c_f32_bf16 v108, s69, v200
    v_dot2c_f32_bf16 v110, v200, v200
    v_dot2c_f32_bf16 v109, s69, v201
    v_dot2c_f32_bf16 v111, v201, v201
    v_dot2c_f32_bf16 v108, s69, v202
    v_dot2c_f32_bf16 v110, v202, v202
    v_dot2c_f32_bf16 v109, s69, v203
    v_dot2c_f32_bf16 v111, v203, v203
    v_dot2c_f32_bf16 v108, s69, v204
    v_dot2c_f32_bf16 v110, v204, v204
    v_dot2c_f32_bf16 v109, s69, v205
    v_dot2c_f32_bf16 v111, v205, v205
    v_dot2c_f32_bf16 v108, s69, v206
    v_dot2c_f32_bf16 v110, v206, v206
    v_dot2c_f32_bf16 v109, s69, v207
    v_dot2c_f32_bf16 v111, v207, v207
    s_waitcnt vmcnt(4)
    ds_read_b128 v[224:227], v100 offset:24576
    ds_read_b128 v[228:231], v101 offset:24576
    ds_read_b128 v[232:235], v102 offset:24576
    ds_read_b128 v[236:239], v103 offset:24576
    s_waitcnt lgkmcnt(4)
    v_dot2c_f32_bf16 v108, s69, v208
    v_dot2c_f32_bf16 v110, v208, v208
    v_dot2c_f32_bf16 v109, s69, v209
    v_dot2c_f32_bf16 v111, v209, v209
    v_dot2c_f32_bf16 v108, s69, v210
    v_dot2c_f32_bf16 v110, v210, v210
    v_dot2c_f32_bf16 v109, s69, v211
    v_dot2c_f32_bf16 v111, v211, v211
    v_dot2c_f32_bf16 v108, s69, v212
    v_dot2c_f32_bf16 v110, v212, v212
    v_dot2c_f32_bf16 v109, s69, v213
    v_dot2c_f32_bf16 v111, v213, v213
    v_dot2c_f32_bf16 v108, s69, v214
    v_dot2c_f32_bf16 v110, v214, v214
    v_dot2c_f32_bf16 v109, s69, v215
    v_dot2c_f32_bf16 v111, v215, v215
    v_dot2c_f32_bf16 v108, s69, v216
    v_dot2c_f32_bf16 v110, v216, v216
    v_dot2c_f32_bf16 v109, s69, v217
    v_dot2c_f32_bf16 v111, v217, v217
    v_dot2c_f32_bf16 v108, s69, v218
    v_dot2c_f32_bf16 v110, v218, v218
    v_dot2c_f32_bf16 v109, s69, v219
    v_dot2c_f32_bf16 v111, v219, v219
    v_dot2c_f32_bf16 v108, s69, v220
    v_dot2c_f32_bf16 v110, v220, v220
    v_dot2c_f32_bf16 v109, s69, v221
    v_dot2c_f32_bf16 v111, v221, v221
    v_dot2c_f32_bf16 v108, s69, v222
    v_dot2c_f32_bf16 v110, v222, v222
    v_dot2c_f32_bf16 v109, s69, v223
    v_dot2c_f32_bf16 v111, v223, v223
    s_waitcnt vmcnt(0)
    ds_read_b128 v[240:243], v100 offset:28672
    ds_read_b128 v[244:247], v101 offset:28672
    ds_read_b128 v[248:251], v102 offset:28672
    ds_read_b128 v[252:255], v103 offset:28672
    s_waitcnt lgkmcnt(4)
    v_dot2c_f32_bf16 v108, s69, v224
    v_dot2c_f32_bf16 v110, v224, v224
    v_dot2c_f32_bf16 v109, s69, v225
    v_dot2c_f32_bf16 v111, v225, v225
    v_dot2c_f32_bf16 v108, s69, v226
    v_dot2c_f32_bf16 v110, v226, v226
    v_dot2c_f32_bf16 v109, s69, v227
    v_dot2c_f32_bf16 v111, v227, v227
    v_dot2c_f32_bf16 v108, s69, v228
    v_dot2c_f32_bf16 v110, v228, v228
    v_dot2c_f32_bf16 v109, s69, v229
    v_dot2c_f32_bf16 v111, v229, v229
    v_dot2c_f32_bf16 v108, s69, v230
    v_dot2c_f32_bf16 v110, v230, v230
    v_dot2c_f32_bf16 v109, s69, v231
    v_dot2c_f32_bf16 v111, v231, v231
    v_dot2c_f32_bf16 v108, s69, v232
    v_dot2c_f32_bf16 v110, v232, v232
    v_dot2c_f32_bf16 v109, s69, v233
    v_dot2c_f32_bf16 v111, v233, v233
    v_dot2c_f32_bf16 v108, s69, v234
    v_dot2c_f32_bf16 v110, v234, v234
    v_dot2c_f32_bf16 v109, s69, v235
    v_dot2c_f32_bf16 v111, v235, v235
    v_dot2c_f32_bf16 v108, s69, v236
    v_dot2c_f32_bf16 v110, v236, v236
    v_dot2c_f32_bf16 v109, s69, v237
    v_dot2c_f32_bf16 v111, v237, v237
    v_dot2c_f32_bf16 v108, s69, v238
    v_dot2c_f32_bf16 v110, v238, v238
    v_dot2c_f32_bf16 v109, s69, v239
    v_dot2c_f32_bf16 v111, v239, v239
    s_waitcnt lgkmcnt(0)
    s_barrier
    ds_read_b64_tr_b16 v[12:13], v3 offset:34816
    ds_read_b64_tr_b16 v[14:15], v3 offset:34944
    ds_read_b64_tr_b16 v[16:17], v3 offset:34848
    ds_read_b64_tr_b16 v[18:19], v3 offset:34976
    ds_read_b64_tr_b16 v[20:21], v3 offset:34880
    ds_read_b64_tr_b16 v[22:23], v3 offset:35008
    ds_read_b64_tr_b16 v[24:25], v3 offset:34912
    ds_read_b64_tr_b16 v[26:27], v3 offset:35040
    v_dot2c_f32_bf16 v108, s69, v240
    v_dot2c_f32_bf16 v110, v240, v240
    v_dot2c_f32_bf16 v109, s69, v241
    v_dot2c_f32_bf16 v111, v241, v241
    v_dot2c_f32_bf16 v108, s69, v242
    v_dot2c_f32_bf16 v110, v242, v242
    v_dot2c_f32_bf16 v109, s69, v243
    v_dot2c_f32_bf16 v111, v243, v243
    v_dot2c_f32_bf16 v108, s69, v244
    v_dot2c_f32_bf16 v110, v244, v244
    v_dot2c_f32_bf16 v109, s69, v245
    v_dot2c_f32_bf16 v111, v245, v245
    v_dot2c_f32_bf16 v108, s69, v246
    v_dot2c_f32_bf16 v110, v246, v246
    v_dot2c_f32_bf16 v109, s69, v247
    v_dot2c_f32_bf16 v111, v247, v247
    v_dot2c_f32_bf16 v108, s69, v248
    v_dot2c_f32_bf16 v110, v248, v248
    v_dot2c_f32_bf16 v109, s69, v249
    v_dot2c_f32_bf16 v111, v249, v249
    v_dot2c_f32_bf16 v108, s69, v250
    v_dot2c_f32_bf16 v110, v250, v250
    v_dot2c_f32_bf16 v109, s69, v251
    v_dot2c_f32_bf16 v111, v251, v251
    v_dot2c_f32_bf16 v108, s69, v252
    v_dot2c_f32_bf16 v110, v252, v252
    v_dot2c_f32_bf16 v109, s69, v253
    v_dot2c_f32_bf16 v111, v253, v253
    v_dot2c_f32_bf16 v108, s69, v254
    v_dot2c_f32_bf16 v110, v254, v254
    v_dot2c_f32_bf16 v109, s69, v255
    v_dot2c_f32_bf16 v111, v255, v255
    s_nop 1
    v_add_f32 v108, v108, v109
    v_add_f32 v110, v110, v111
    v_mov_b32 v109, v108
    v_mov_b32 v111, v110
    s_nop 0
    v_permlane32_swap_b32 v108, v109
    v_permlane32_swap_b32 v110, v111
    v_add_f32 v108, v108, v109
    v_add_f32 v110, v110, v111
    v_mul_f32 v108, 0x3b000000, v108
    v_mul_f32 v110, 0x3b000000, v110
    v_fma_f32 v110, -v108, v108, v110
    v_max_f32 v110, 0, v110
    v_add_f32 v110, 0x3727c5ac, v110
    v_rsq_f32 v5, v110
    s_mov_b32 s67, 0x3e317218
    v_mul_f32 v5, 0x3fb8aa3b, v5
    v_mul_f32 v6, v108, v5
    v_sub_f32 v6, 0, v6
    v_lshlrev_b32 v104, 16, v128
    v_and_b32 v105, s59, v128
    v_fma_f32 v104, v104, v5, v6
    v_fma_f32 v105, v105, v5, v6
    v_lshlrev_b32 v106, 16, v129
    v_and_b32 v107, s59, v129
    v_fma_f32 v106, v106, v5, v6
    v_fma_f32 v107, v107, v5, v6
    v_cvt_pk_bf16_f32 v128, v104, v105
    v_lshlrev_b32 v104, 16, v130
    v_and_b32 v105, s59, v130
    v_fma_f32 v104, v104, v5, v6
    v_fma_f32 v105, v105, v5, v6
    v_cvt_pk_bf16_f32 v129, v106, v107
    v_lshlrev_b32 v106, 16, v131
    v_and_b32 v107, s59, v131
    v_fma_f32 v106, v106, v5, v6
    v_fma_f32 v107, v107, v5, v6
    v_cvt_pk_bf16_f32 v130, v104, v105
    v_lshlrev_b32 v104, 16, v132
    v_and_b32 v105, s59, v132
    v_fma_f32 v104, v104, v5, v6
    v_fma_f32 v105, v105, v5, v6
    v_cvt_pk_bf16_f32 v131, v106, v107
    v_lshlrev_b32 v106, 16, v133
    v_and_b32 v107, s59, v133
    v_fma_f32 v106, v106, v5, v6
    v_fma_f32 v107, v107, v5, v6
    v_cvt_pk_bf16_f32 v132, v104, v105
    s_waitcnt lgkmcnt(4)
    v_mfma_f32_32x32x16_bf16 v[32:47], v[12:15], v[128:131], 0
    ds_read_b64_tr_b16 v[28:29], v3 offset:35328
    ds_read_b64_tr_b16 v[30:31], v3 offset:35456
    v_lshlrev_b32 v104, 16, v134
    v_and_b32 v105, s59, v134
    v_cvt_pk_bf16_f32 v133, v106, v107
    v_fma_f32 v104, v104, v5, v6
    v_fma_f32 v105, v105, v5, v6
    v_mfma_f32_32x32x16_bf16 v[48:63], v[16:19], v[128:131], 0
    ds_read_b64_tr_b16 v[12:13], v3 offset:35360
    ds_read_b64_tr_b16 v[14:15], v3 offset:35488
    v_lshlrev_b32 v106, 16, v135
    v_and_b32 v107, s59, v135
    v_cvt_pk_bf16_f32 v134, v104, v105
    v_fma_f32 v106, v106, v5, v6
    v_fma_f32 v107, v107, v5, v6
    s_waitcnt lgkmcnt(4)
    v_mfma_f32_32x32x16_bf16 v[64:79], v[20:23], v[128:131], 0
    ds_read_b64_tr_b16 v[16:17], v3 offset:35392
    ds_read_b64_tr_b16 v[18:19], v3 offset:35520
    v_lshlrev_b32 v104, 16, v136
    v_and_b32 v105, s59, v136
    v_cvt_pk_bf16_f32 v135, v106, v107
    v_fma_f32 v104, v104, v5, v6
    v_fma_f32 v105, v105, v5, v6
    v_mfma_f32_32x32x16_bf16 v[80:95], v[24:27], v[128:131], 0
    ds_read_b64_tr_b16 v[20:21], v3 offset:35424
    ds_read_b64_tr_b16 v[22:23], v3 offset:35552
    v_lshlrev_b32 v106, 16, v137
    v_and_b32 v107, s59, v137
    v_cvt_pk_bf16_f32 v136, v104, v105
    v_fma_f32 v106, v106, v5, v6
    v_fma_f32 v107, v107, v5, v6
    s_waitcnt lgkmcnt(4)
    v_mfma_f32_32x32x16_bf16 v[32:47], v[28:31], v[132:135], v[32:47]
    s_barrier
    ds_read_b64_tr_b16 v[24:25], v3 offset:43520
    ds_read_b64_tr_b16 v[26:27], v3 offset:43648
    v_lshlrev_b32 v104, 16, v138
    v_and_b32 v105, s59, v138
    v_cvt_pk_bf16_f32 v137, v106, v107
    v_fma_f32 v104, v104, v5, v6
    v_fma_f32 v105, v105, v5, v6
    v_mfma_f32_32x32x16_bf16 v[48:63], v[12:15], v[132:135], v[48:63]
    ds_read_b64_tr_b16 v[28:29], v3 offset:43552
    ds_read_b64_tr_b16 v[30:31], v3 offset:43680
    v_lshlrev_b32 v106, 16, v139
    v_and_b32 v107, s59, v139
    v_cvt_pk_bf16_f32 v138, v104, v105
    v_fma_f32 v106, v106, v5, v6
    v_fma_f32 v107, v107, v5, v6
    s_waitcnt lgkmcnt(4)
    v_mfma_f32_32x32x16_bf16 v[64:79], v[16:19], v[132:135], v[64:79]
    ds_read_b64_tr_b16 v[12:13], v3 offset:43584
    ds_read_b64_tr_b16 v[14:15], v3 offset:43712
    v_lshlrev_b32 v104, 16, v140
    v_and_b32 v105, s59, v140
    v_cvt_pk_bf16_f32 v139, v106, v107
    v_fma_f32 v104, v104, v5, v6
    v_fma_f32 v105, v105, v5, v6
    v_mfma_f32_32x32x16_bf16 v[80:95], v[20:23], v[132:135], v[80:95]
    ds_read_b64_tr_b16 v[16:17], v3 offset:43616
    ds_read_b64_tr_b16 v[18:19], v3 offset:43744
    v_lshlrev_b32 v106, 16, v141
    v_and_b32 v107, s59, v141
    v_cvt_pk_bf16_f32 v140, v104, v105
    v_fma_f32 v106, v106, v5, v6
    v_fma_f32 v107, v107, v5, v6
    s_waitcnt lgkmcnt(4)
    v_mfma_f32_32x32x16_bf16 v[32:47], v[24:27], v[136:139], v[32:47]
    ds_read_b64_tr_b16 v[20:21], v3 offset:44032
    ds_read_b64_tr_b16 v[22:23], v3 offset:44160
    v_lshlrev_b32 v104, 16, v142
    v_and_b32 v105, s59, v142
    v_cvt_pk_bf16_f32 v141, v106, v107
    v_fma_f32 v104, v104, v5, v6
    v_fma_f32 v105, v105, v5, v6
    v_mfma_f32_32x32x16_bf16 v[48:63], v[28:31], v[136:139], v[48:63]
    ds_read_b64_tr_b16 v[24:25], v3 offset:44064
    ds_read_b64_tr_b16 v[26:27], v3 offset:44192
    v_lshlrev_b32 v106, 16, v143
    v_and_b32 v107, s59, v143
    v_cvt_pk_bf16_f32 v142, v104, v105
    v_fma_f32 v106, v106, v5, v6
    v_fma_f32 v107, v107, v5, v6
    s_waitcnt lgkmcnt(4)
    v_mfma_f32_32x32x16_bf16 v[64:79], v[12:15], v[136:139], v[64:79]
    ds_read_b64_tr_b16 v[28:29], v3 offset:44096
    ds_read_b64_tr_b16 v[30:31], v3 offset:44224
    v_lshlrev_b32 v104, 16, v144
    v_and_b32 v105, s59, v144
    v_cvt_pk_bf16_f32 v143, v106, v107
    v_fma_f32 v104, v104, v5, v6
    v_fma_f32 v105, v105, v5, v6
    v_mfma_f32_32x32x16_bf16 v[80:95], v[16:19], v[136:139], v[80:95]
    ds_read_b64_tr_b16 v[12:13], v3 offset:44128
    ds_read_b64_tr_b16 v[14:15], v3 offset:44256
    v_lshlrev_b32 v106, 16, v145
    v_and_b32 v107, s59, v145
    v_cvt_pk_bf16_f32 v144, v104, v105
    v_fma_f32 v106, v106, v5, v6
    v_fma_f32 v107, v107, v5, v6
    s_waitcnt lgkmcnt(4)
    v_mfma_f32_32x32x16_bf16 v[32:47], v[20:23], v[140:143], v[32:47]
    s_barrier
    ds_read_b64_tr_b16 v[16:17], v3 offset:52224
    ds_read_b64_tr_b16 v[18:19], v3 offset:52352
    v_lshlrev_b32 v104, 16, v146
    v_and_b32 v105, s59, v146
    v_cvt_pk_bf16_f32 v145, v106, v107
    v_fma_f32 v104, v104, v5, v6
    v_fma_f32 v105, v105, v5, v6
    v_mfma_f32_32x32x16_bf16 v[48:63], v[24:27], v[140:143], v[48:63]
    ds_read_b64_tr_b16 v[20:21], v3 offset:52256
    ds_read_b64_tr_b16 v[22:23], v3 offset:52384
    v_lshlrev_b32 v106, 16, v147
    v_and_b32 v107, s59, v147
    v_cvt_pk_bf16_f32 v146, v104, v105
    v_fma_f32 v106, v106, v5, v6
    v_fma_f32 v107, v107, v5, v6
    s_waitcnt lgkmcnt(4)
    v_mfma_f32_32x32x16_bf16 v[64:79], v[28:31], v[140:143], v[64:79]
    ds_read_b64_tr_b16 v[24:25], v3 offset:52288
    ds_read_b64_tr_b16 v[26:27], v3 offset:52416
    v_lshlrev_b32 v104, 16, v148
    v_and_b32 v105, s59, v148
    v_cvt_pk_bf16_f32 v147, v106, v107
    v_fma_f32 v104, v104, v5, v6
    v_fma_f32 v105, v105, v5, v6
    v_mfma_f32_32x32x16_bf16 v[80:95], v[12:15], v[140:143], v[80:95]
    ds_read_b64_tr_b16 v[28:29], v3 offset:52320
    ds_read_b64_tr_b16 v[30:31], v3 offset:52448
    v_lshlrev_b32 v106, 16, v149
    v_and_b32 v107, s59, v149
    v_cvt_pk_bf16_f32 v148, v104, v105
    v_fma_f32 v106, v106, v5, v6
    v_fma_f32 v107, v107, v5, v6
    s_waitcnt lgkmcnt(4)
    v_mfma_f32_32x32x16_bf16 v[32:47], v[16:19], v[144:147], v[32:47]
    ds_read_b64_tr_b16 v[12:13], v3 offset:52736
    ds_read_b64_tr_b16 v[14:15], v3 offset:52864
    v_lshlrev_b32 v104, 16, v150
    v_and_b32 v105, s59, v150
    v_cvt_pk_bf16_f32 v149, v106, v107
    v_fma_f32 v104, v104, v5, v6
    v_fma_f32 v105, v105, v5, v6
    v_mfma_f32_32x32x16_bf16 v[48:63], v[20:23], v[144:147], v[48:63]
    ds_read_b64_tr_b16 v[16:17], v3 offset:52768
    ds_read_b64_tr_b16 v[18:19], v3 offset:52896
    v_lshlrev_b32 v106, 16, v151
    v_and_b32 v107, s59, v151
    v_cvt_pk_bf16_f32 v150, v104, v105
    v_fma_f32 v106, v106, v5, v6
    v_fma_f32 v107, v107, v5, v6
    s_waitcnt lgkmcnt(4)
    v_mfma_f32_32x32x16_bf16 v[64:79], v[24:27], v[144:147], v[64:79]
    ds_read_b64_tr_b16 v[20:21], v3 offset:52800
    ds_read_b64_tr_b16 v[22:23], v3 offset:52928
    v_lshlrev_b32 v104, 16, v152
    v_and_b32 v105, s59, v152
    v_cvt_pk_bf16_f32 v151, v106, v107
    v_fma_f32 v104, v104, v5, v6
    v_fma_f32 v105, v105, v5, v6
    v_mfma_f32_32x32x16_bf16 v[80:95], v[28:31], v[144:147], v[80:95]
    ds_read_b64_tr_b16 v[24:25], v3 offset:52832
    ds_read_b64_tr_b16 v[26:27], v3 offset:52960
    v_subrev_u32 v3, 60928, v3
    v_lshlrev_b32 v106, 16, v153
    v_and_b32 v107, s59, v153
    v_cvt_pk_bf16_f32 v152, v104, v105
    v_fma_f32 v106, v106, v5, v6
    v_fma_f32 v107, v107, v5, v6
    s_waitcnt lgkmcnt(4)
    v_mfma_f32_32x32x16_bf16 v[32:47], v[12:15], v[148:151], v[32:47]
    s_barrier
    ds_read_b64_tr_b16 v[28:29], v3 offset:0
    ds_read_b64_tr_b16 v[30:31], v3 offset:128
    v_lshlrev_b32 v104, 16, v154
    v_and_b32 v105, s59, v154
    v_cvt_pk_bf16_f32 v153, v106, v107
    v_fma_f32 v104, v104, v5, v6
    v_fma_f32 v105, v105, v5, v6
    v_mfma_f32_32x32x16_bf16 v[48:63], v[16:19], v[148:151], v[48:63]
    ds_read_b64_tr_b16 v[12:13], v3 offset:32
    ds_read_b64_tr_b16 v[14:15], v3 offset:160
    v_lshlrev_b32 v106, 16, v155
    v_and_b32 v107, s59, v155
    v_cvt_pk_bf16_f32 v154, v104, v105
    v_fma_f32 v106, v106, v5, v6
    v_fma_f32 v107, v107, v5, v6
    s_waitcnt lgkmcnt(4)
    v_mfma_f32_32x32x16_bf16 v[64:79], v[20:23], v[148:151], v[64:79]
    ds_read_b64_tr_b16 v[16:17], v3 offset:64
    ds_read_b64_tr_b16 v[18:19], v3 offset:192
    v_lshlrev_b32 v104, 16, v156
    v_and_b32 v105, s59, v156
    v_cvt_pk_bf16_f32 v155, v106, v107
    v_fma_f32 v104, v104, v5, v6
    v_fma_f32 v105, v105, v5, v6
    v_mfma_f32_32x32x16_bf16 v[80:95], v[24:27], v[148:151], v[80:95]
    ds_read_b64_tr_b16 v[20:21], v3 offset:96
    ds_read_b64_tr_b16 v[22:23], v3 offset:224
    v_lshlrev_b32 v106, 16, v157
    v_and_b32 v107, s59, v157
    v_cvt_pk_bf16_f32 v156, v104, v105
    v_fma_f32 v106, v106, v5, v6
    v_fma_f32 v107, v107, v5, v6
    s_waitcnt lgkmcnt(4)
    v_mfma_f32_32x32x16_bf16 v[32:47], v[28:31], v[152:155], v[32:47]
    ds_read_b64_tr_b16 v[24:25], v3 offset:512
    ds_read_b64_tr_b16 v[26:27], v3 offset:640
    v_lshlrev_b32 v104, 16, v158
    v_and_b32 v105, s59, v158
    v_cvt_pk_bf16_f32 v157, v106, v107
    v_fma_f32 v104, v104, v5, v6
    v_fma_f32 v105, v105, v5, v6
    v_mfma_f32_32x32x16_bf16 v[48:63], v[12:15], v[152:155], v[48:63]
    ds_read_b64_tr_b16 v[28:29], v3 offset:544
    ds_read_b64_tr_b16 v[30:31], v3 offset:672
    v_lshlrev_b32 v106, 16, v159
    v_and_b32 v107, s59, v159
    v_cvt_pk_bf16_f32 v158, v104, v105
    v_fma_f32 v106, v106, v5, v6
    v_fma_f32 v107, v107, v5, v6
    s_waitcnt lgkmcnt(4)
    v_mfma_f32_32x32x16_bf16 v[64:79], v[16:19], v[152:155], v[64:79]
    ds_read_b64_tr_b16 v[12:13], v3 offset:576
    ds_read_b64_tr_b16 v[14:15], v3 offset:704
    v_lshlrev_b32 v104, 16, v160
    v_and_b32 v105, s59, v160
    v_cvt_pk_bf16_f32 v159, v106, v107
    v_fma_f32 v104, v104, v5, v6
    v_fma_f32 v105, v105, v5, v6
    v_mfma_f32_32x32x16_bf16 v[80:95], v[20:23], v[152:155], v[80:95]
    ds_read_b64_tr_b16 v[16:17], v3 offset:608
    ds_read_b64_tr_b16 v[18:19], v3 offset:736
    v_lshlrev_b32 v106, 16, v161
    v_and_b32 v107, s59, v161
    v_cvt_pk_bf16_f32 v160, v104, v105
    v_fma_f32 v106, v106, v5, v6
    v_fma_f32 v107, v107, v5, v6
    s_waitcnt lgkmcnt(4)
    v_mfma_f32_32x32x16_bf16 v[32:47], v[24:27], v[156:159], v[32:47]
    s_barrier
    ds_read_b64_tr_b16 v[20:21], v3 offset:8704
    ds_read_b64_tr_b16 v[22:23], v3 offset:8832
    v_lshlrev_b32 v104, 16, v162
    v_and_b32 v105, s59, v162
    v_cvt_pk_bf16_f32 v161, v106, v107
    v_fma_f32 v104, v104, v5, v6
    v_fma_f32 v105, v105, v5, v6
    v_mfma_f32_32x32x16_bf16 v[48:63], v[28:31], v[156:159], v[48:63]
    ds_read_b64_tr_b16 v[24:25], v3 offset:8736
    ds_read_b64_tr_b16 v[26:27], v3 offset:8864
    v_lshlrev_b32 v106, 16, v163
    v_and_b32 v107, s59, v163
    v_cvt_pk_bf16_f32 v162, v104, v105
    v_fma_f32 v106, v106, v5, v6
    v_fma_f32 v107, v107, v5, v6
    s_waitcnt lgkmcnt(4)
    v_mfma_f32_32x32x16_bf16 v[64:79], v[12:15], v[156:159], v[64:79]
    ds_read_b64_tr_b16 v[28:29], v3 offset:8768
    ds_read_b64_tr_b16 v[30:31], v3 offset:8896
    v_lshlrev_b32 v104, 16, v164
    v_and_b32 v105, s59, v164
    v_cvt_pk_bf16_f32 v163, v106, v107
    v_fma_f32 v104, v104, v5, v6
    v_fma_f32 v105, v105, v5, v6
    v_mfma_f32_32x32x16_bf16 v[80:95], v[16:19], v[156:159], v[80:95]
    ds_read_b64_tr_b16 v[12:13], v3 offset:8800
    ds_read_b64_tr_b16 v[14:15], v3 offset:8928
    v_lshlrev_b32 v106, 16, v165
    v_and_b32 v107, s59, v165
    v_cvt_pk_bf16_f32 v164, v104, v105
    v_fma_f32 v106, v106, v5, v6
    v_fma_f32 v107, v107, v5, v6
    s_waitcnt lgkmcnt(4)
    v_mfma_f32_32x32x16_bf16 v[32:47], v[20:23], v[160:163], v[32:47]
    ds_read_b64_tr_b16 v[16:17], v3 offset:9216
    ds_read_b64_tr_b16 v[18:19], v3 offset:9344
    v_lshlrev_b32 v104, 16, v166
    v_and_b32 v105, s59, v166
    v_cvt_pk_bf16_f32 v165, v106, v107
    v_fma_f32 v104, v104, v5, v6
    v_fma_f32 v105, v105, v5, v6
    v_mfma_f32_32x32x16_bf16 v[48:63], v[24:27], v[160:163], v[48:63]
    ds_read_b64_tr_b16 v[20:21], v3 offset:9248
    ds_read_b64_tr_b16 v[22:23], v3 offset:9376
    v_lshlrev_b32 v106, 16, v167
    v_and_b32 v107, s59, v167
    v_cvt_pk_bf16_f32 v166, v104, v105
    v_fma_f32 v106, v106, v5, v6
    v_fma_f32 v107, v107, v5, v6
    s_waitcnt lgkmcnt(4)
    v_mfma_f32_32x32x16_bf16 v[64:79], v[28:31], v[160:163], v[64:79]
    ds_read_b64_tr_b16 v[24:25], v3 offset:9280
    ds_read_b64_tr_b16 v[26:27], v3 offset:9408
    v_lshlrev_b32 v104, 16, v168
    v_and_b32 v105, s59, v168
    v_cvt_pk_bf16_f32 v167, v106, v107
    v_fma_f32 v104, v104, v5, v6
    v_fma_f32 v105, v105, v5, v6
    v_mfma_f32_32x32x16_bf16 v[80:95], v[12:15], v[160:163], v[80:95]
    ds_read_b64_tr_b16 v[28:29], v3 offset:9312
    ds_read_b64_tr_b16 v[30:31], v3 offset:9440
    v_lshlrev_b32 v106, 16, v169
    v_and_b32 v107, s59, v169
    v_cvt_pk_bf16_f32 v168, v104, v105
    v_fma_f32 v106, v106, v5, v6
    v_fma_f32 v107, v107, v5, v6
    s_waitcnt lgkmcnt(4)
    v_mfma_f32_32x32x16_bf16 v[32:47], v[16:19], v[164:167], v[32:47]
    s_barrier
    ds_read_b64_tr_b16 v[12:13], v3 offset:17408
    ds_read_b64_tr_b16 v[14:15], v3 offset:17536
    v_lshlrev_b32 v104, 16, v170
    v_and_b32 v105, s59, v170
    v_cvt_pk_bf16_f32 v169, v106, v107
    v_fma_f32 v104, v104, v5, v6
    v_fma_f32 v105, v105, v5, v6
    v_mfma_f32_32x32x16_bf16 v[48:63], v[20:23], v[164:167], v[48:63]
    ds_read_b64_tr_b16 v[16:17], v3 offset:17440
    ds_read_b64_tr_b16 v[18:19], v3 offset:17568
    v_lshlrev_b32 v106, 16, v171
    v_and_b32 v107, s59, v171
    v_cvt_pk_bf16_f32 v170, v104, v105
    v_fma_f32 v106, v106, v5, v6
    v_fma_f32 v107, v107, v5, v6
    s_waitcnt lgkmcnt(4)
    v_mfma_f32_32x32x16_bf16 v[64:79], v[24:27], v[164:167], v[64:79]
    ds_read_b64_tr_b16 v[20:21], v3 offset:17472
    ds_read_b64_tr_b16 v[22:23], v3 offset:17600
    v_lshlrev_b32 v104, 16, v172
    v_and_b32 v105, s59, v172
    v_cvt_pk_bf16_f32 v171, v106, v107
    v_fma_f32 v104, v104, v5, v6
    v_fma_f32 v105, v105, v5, v6
    v_mfma_f32_32x32x16_bf16 v[80:95], v[28:31], v[164:167], v[80:95]
    ds_read_b64_tr_b16 v[24:25], v3 offset:17504
    ds_read_b64_tr_b16 v[26:27], v3 offset:17632
    v_lshlrev_b32 v106, 16, v173
    v_and_b32 v107, s59, v173
    v_cvt_pk_bf16_f32 v172, v104, v105
    v_fma_f32 v106, v106, v5, v6
    v_fma_f32 v107, v107, v5, v6
    s_waitcnt lgkmcnt(4)
    v_mfma_f32_32x32x16_bf16 v[32:47], v[12:15], v[168:171], v[32:47]
    ds_read_b64_tr_b16 v[28:29], v3 offset:17920
    ds_read_b64_tr_b16 v[30:31], v3 offset:18048
    v_lshlrev_b32 v104, 16, v174
    v_and_b32 v105, s59, v174
    v_cvt_pk_bf16_f32 v173, v106, v107
    v_fma_f32 v104, v104, v5, v6
    v_fma_f32 v105, v105, v5, v6
    v_mfma_f32_32x32x16_bf16 v[48:63], v[16:19], v[168:171], v[48:63]
    ds_read_b64_tr_b16 v[12:13], v3 offset:17952
    ds_read_b64_tr_b16 v[14:15], v3 offset:18080
    v_lshlrev_b32 v106, 16, v175
    v_and_b32 v107, s59, v175
    v_cvt_pk_bf16_f32 v174, v104, v105
    v_fma_f32 v106, v106, v5, v6
    v_fma_f32 v107, v107, v5, v6
    s_waitcnt lgkmcnt(4)
    v_mfma_f32_32x32x16_bf16 v[64:79], v[20:23], v[168:171], v[64:79]
    ds_read_b64_tr_b16 v[16:17], v3 offset:17984
    ds_read_b64_tr_b16 v[18:19], v3 offset:18112
    v_lshlrev_b32 v104, 16, v176
    v_and_b32 v105, s59, v176
    v_cvt_pk_bf16_f32 v175, v106, v107
    v_fma_f32 v104, v104, v5, v6
    v_fma_f32 v105, v105, v5, v6
    v_mfma_f32_32x32x16_bf16 v[80:95], v[24:27], v[168:171], v[80:95]
    ds_read_b64_tr_b16 v[20:21], v3 offset:18016
    ds_read_b64_tr_b16 v[22:23], v3 offset:18144
    v_lshlrev_b32 v106, 16, v177
    v_and_b32 v107, s59, v177
    v_cvt_pk_bf16_f32 v176, v104, v105
    v_fma_f32 v106, v106, v5, v6
    v_fma_f32 v107, v107, v5, v6
    s_waitcnt lgkmcnt(4)
    v_mfma_f32_32x32x16_bf16 v[32:47], v[28:31], v[172:175], v[32:47]
    s_barrier
    ds_read_b64_tr_b16 v[24:25], v3 offset:26112
    ds_read_b64_tr_b16 v[26:27], v3 offset:26240
    v_lshlrev_b32 v104, 16, v178
    v_and_b32 v105, s59, v178
    v_cvt_pk_bf16_f32 v177, v106, v107
    v_fma_f32 v104, v104, v5, v6
    v_fma_f32 v105, v105, v5, v6
    v_mfma_f32_32x32x16_bf16 v[48:63], v[12:15], v[172:175], v[48:63]
    ds_read_b64_tr_b16 v[28:29], v3 offset:26144
    ds_read_b64_tr_b16 v[30:31], v3 offset:26272
    v_lshlrev_b32 v106, 16, v179
    v_and_b32 v107, s59, v179
    v_cvt_pk_bf16_f32 v178, v104, v105
    v_fma_f32 v106, v106, v5, v6
    v_fma_f32 v107, v107, v5, v6
    s_waitcnt lgkmcnt(4)
    v_mfma_f32_32x32x16_bf16 v[64:79], v[16:19], v[172:175], v[64:79]
    ds_read_b64_tr_b16 v[12:13], v3 offset:26176
    ds_read_b64_tr_b16 v[14:15], v3 offset:26304
    v_lshlrev_b32 v104, 16, v180
    v_and_b32 v105, s59, v180
    v_cvt_pk_bf16_f32 v179, v106, v107
    v_fma_f32 v104, v104, v5, v6
    v_fma_f32 v105, v105, v5, v6
    v_mfma_f32_32x32x16_bf16 v[80:95], v[20:23], v[172:175], v[80:95]
    ds_read_b64_tr_b16 v[16:17], v3 offset:26208
    ds_read_b64_tr_b16 v[18:19], v3 offset:26336
    v_lshlrev_b32 v106, 16, v181
    v_and_b32 v107, s59, v181
    v_cvt_pk_bf16_f32 v180, v104, v105
    v_fma_f32 v106, v106, v5, v6
    v_fma_f32 v107, v107, v5, v6
    s_waitcnt lgkmcnt(4)
    v_mfma_f32_32x32x16_bf16 v[32:47], v[24:27], v[176:179], v[32:47]
    ds_read_b64_tr_b16 v[20:21], v3 offset:26624
    ds_read_b64_tr_b16 v[22:23], v3 offset:26752
    v_lshlrev_b32 v104, 16, v182
    v_and_b32 v105, s59, v182
    v_cvt_pk_bf16_f32 v181, v106, v107
    v_fma_f32 v104, v104, v5, v6
    v_fma_f32 v105, v105, v5, v6
    v_mfma_f32_32x32x16_bf16 v[48:63], v[28:31], v[176:179], v[48:63]
    ds_read_b64_tr_b16 v[24:25], v3 offset:26656
    ds_read_b64_tr_b16 v[26:27], v3 offset:26784
    v_lshlrev_b32 v106, 16, v183
    v_and_b32 v107, s59, v183
    v_cvt_pk_bf16_f32 v182, v104, v105
    v_fma_f32 v106, v106, v5, v6
    v_fma_f32 v107, v107, v5, v6
    s_waitcnt lgkmcnt(4)
    v_mfma_f32_32x32x16_bf16 v[64:79], v[12:15], v[176:179], v[64:79]
    ds_read_b64_tr_b16 v[28:29], v3 offset:26688
    ds_read_b64_tr_b16 v[30:31], v3 offset:26816
    v_lshlrev_b32 v104, 16, v184
    v_and_b32 v105, s59, v184
    v_cvt_pk_bf16_f32 v183, v106, v107
    v_fma_f32 v104, v104, v5, v6
    v_fma_f32 v105, v105, v5, v6
    v_mfma_f32_32x32x16_bf16 v[80:95], v[16:19], v[176:179], v[80:95]
    ds_read_b64_tr_b16 v[12:13], v3 offset:26720
    ds_read_b64_tr_b16 v[14:15], v3 offset:26848
    v_lshlrev_b32 v106, 16, v185
    v_and_b32 v107, s59, v185
    v_cvt_pk_bf16_f32 v184, v104, v105
    v_fma_f32 v106, v106, v5, v6
    v_fma_f32 v107, v107, v5, v6
    s_waitcnt lgkmcnt(4)
    v_mfma_f32_32x32x16_bf16 v[32:47], v[20:23], v[180:183], v[32:47]
    s_barrier
    ds_read_b64_tr_b16 v[16:17], v3 offset:34816
    ds_read_b64_tr_b16 v[18:19], v3 offset:34944
    v_lshlrev_b32 v104, 16, v186
    v_and_b32 v105, s59, v186
    v_cvt_pk_bf16_f32 v185, v106, v107
    v_fma_f32 v104, v104, v5, v6
    v_fma_f32 v105, v105, v5, v6
    v_mfma_f32_32x32x16_bf16 v[48:63], v[24:27], v[180:183], v[48:63]
    ds_read_b64_tr_b16 v[20:21], v3 offset:34848
    ds_read_b64_tr_b16 v[22:23], v3 offset:34976
    v_lshlrev_b32 v106, 16, v187
    v_and_b32 v107, s59, v187
    v_cvt_pk_bf16_f32 v186, v104, v105
    v_fma_f32 v106, v106, v5, v6
    v_fma_f32 v107, v107, v5, v6
    s_waitcnt lgkmcnt(4)
    v_mfma_f32_32x32x16_bf16 v[64:79], v[28:31], v[180:183], v[64:79]
    ds_read_b64_tr_b16 v[24:25], v3 offset:34880
    ds_read_b64_tr_b16 v[26:27], v3 offset:35008
    v_lshlrev_b32 v104, 16, v188
    v_and_b32 v105, s59, v188
    v_cvt_pk_bf16_f32 v187, v106, v107
    v_fma_f32 v104, v104, v5, v6
    v_fma_f32 v105, v105, v5, v6
    v_mfma_f32_32x32x16_bf16 v[80:95], v[12:15], v[180:183], v[80:95]
    ds_read_b64_tr_b16 v[28:29], v3 offset:34912
    ds_read_b64_tr_b16 v[30:31], v3 offset:35040
    v_lshlrev_b32 v106, 16, v189
    v_and_b32 v107, s59, v189
    v_cvt_pk_bf16_f32 v188, v104, v105
    v_fma_f32 v106, v106, v5, v6
    v_fma_f32 v107, v107, v5, v6
    s_waitcnt lgkmcnt(4)
    v_mfma_f32_32x32x16_bf16 v[32:47], v[16:19], v[184:187], v[32:47]
    ds_read_b64_tr_b16 v[12:13], v3 offset:35328
    ds_read_b64_tr_b16 v[14:15], v3 offset:35456
    v_lshlrev_b32 v104, 16, v190
    v_and_b32 v105, s59, v190
    v_cvt_pk_bf16_f32 v189, v106, v107
    v_fma_f32 v104, v104, v5, v6
    v_fma_f32 v105, v105, v5, v6
    v_mfma_f32_32x32x16_bf16 v[48:63], v[20:23], v[184:187], v[48:63]
    ds_read_b64_tr_b16 v[16:17], v3 offset:35360
    ds_read_b64_tr_b16 v[18:19], v3 offset:35488
    v_lshlrev_b32 v106, 16, v191
    v_and_b32 v107, s59, v191
    v_cvt_pk_bf16_f32 v190, v104, v105
    v_fma_f32 v106, v106, v5, v6
    v_fma_f32 v107, v107, v5, v6
    s_waitcnt lgkmcnt(4)
    v_mfma_f32_32x32x16_bf16 v[64:79], v[24:27], v[184:187], v[64:79]
    ds_read_b64_tr_b16 v[20:21], v3 offset:35392
    ds_read_b64_tr_b16 v[22:23], v3 offset:35520
    v_lshlrev_b32 v104, 16, v192
    v_and_b32 v105, s59, v192
    v_cvt_pk_bf16_f32 v191, v106, v107
    v_fma_f32 v104, v104, v5, v6
    v_fma_f32 v105, v105, v5, v6
    v_mfma_f32_32x32x16_bf16 v[80:95], v[28:31], v[184:187], v[80:95]
    ds_read_b64_tr_b16 v[24:25], v3 offset:35424
    ds_read_b64_tr_b16 v[26:27], v3 offset:35552
    v_lshlrev_b32 v106, 16, v193
    v_and_b32 v107, s59, v193
    v_cvt_pk_bf16_f32 v192, v104, v105
    v_fma_f32 v106, v106, v5, v6
    v_fma_f32 v107, v107, v5, v6
    s_waitcnt lgkmcnt(4)
    v_mfma_f32_32x32x16_bf16 v[32:47], v[12:15], v[188:191], v[32:47]
    s_barrier
    ds_read_b64_tr_b16 v[28:29], v3 offset:43520
    ds_read_b64_tr_b16 v[30:31], v3 offset:43648
    v_lshlrev_b32 v104, 16, v194
    v_and_b32 v105, s59, v194
    v_cvt_pk_bf16_f32 v193, v106, v107
    v_fma_f32 v104, v104, v5, v6
    v_fma_f32 v105, v105, v5, v6
    v_mfma_f32_32x32x16_bf16 v[48:63], v[16:19], v[188:191], v[48:63]
    ds_read_b64_tr_b16 v[12:13], v3 offset:43552
    ds_read_b64_tr_b16 v[14:15], v3 offset:43680
    v_lshlrev_b32 v106, 16, v195
    v_and_b32 v107, s59, v195
    v_cvt_pk_bf16_f32 v194, v104, v105
    v_fma_f32 v106, v106, v5, v6
    v_fma_f32 v107, v107, v5, v6
    s_waitcnt lgkmcnt(4)
    v_mfma_f32_32x32x16_bf16 v[64:79], v[20:23], v[188:191], v[64:79]
    ds_read_b64_tr_b16 v[16:17], v3 offset:43584
    ds_read_b64_tr_b16 v[18:19], v3 offset:43712
    v_lshlrev_b32 v104, 16, v196
    v_and_b32 v105, s59, v196
    v_cvt_pk_bf16_f32 v195, v106, v107
    v_fma_f32 v104, v104, v5, v6
    v_fma_f32 v105, v105, v5, v6
    v_mfma_f32_32x32x16_bf16 v[80:95], v[24:27], v[188:191], v[80:95]
    ds_read_b64_tr_b16 v[20:21], v3 offset:43616
    ds_read_b64_tr_b16 v[22:23], v3 offset:43744
    v_lshlrev_b32 v106, 16, v197
    v_and_b32 v107, s59, v197
    v_cvt_pk_bf16_f32 v196, v104, v105
    v_fma_f32 v106, v106, v5, v6
    v_fma_f32 v107, v107, v5, v6
    s_waitcnt lgkmcnt(4)
    v_mfma_f32_32x32x16_bf16 v[32:47], v[28:31], v[192:195], v[32:47]
    ds_read_b64_tr_b16 v[24:25], v3 offset:44032
    ds_read_b64_tr_b16 v[26:27], v3 offset:44160
    v_lshlrev_b32 v104, 16, v198
    v_and_b32 v105, s59, v198
    v_cvt_pk_bf16_f32 v197, v106, v107
    v_fma_f32 v104, v104, v5, v6
    v_fma_f32 v105, v105, v5, v6
    v_mfma_f32_32x32x16_bf16 v[48:63], v[12:15], v[192:195], v[48:63]
    ds_read_b64_tr_b16 v[28:29], v3 offset:44064
    ds_read_b64_tr_b16 v[30:31], v3 offset:44192
    v_lshlrev_b32 v106, 16, v199
    v_and_b32 v107, s59, v199
    v_cvt_pk_bf16_f32 v198, v104, v105
    v_fma_f32 v106, v106, v5, v6
    v_fma_f32 v107, v107, v5, v6
    s_waitcnt lgkmcnt(4)
    v_mfma_f32_32x32x16_bf16 v[64:79], v[16:19], v[192:195], v[64:79]
    ds_read_b64_tr_b16 v[12:13], v3 offset:44096
    ds_read_b64_tr_b16 v[14:15], v3 offset:44224
    v_lshlrev_b32 v104, 16, v200
    v_and_b32 v105, s59, v200
    v_cvt_pk_bf16_f32 v199, v106, v107
    v_fma_f32 v104, v104, v5, v6
    v_fma_f32 v105, v105, v5, v6
    v_mfma_f32_32x32x16_bf16 v[80:95], v[20:23], v[192:195], v[80:95]
    ds_read_b64_tr_b16 v[16:17], v3 offset:44128
    ds_read_b64_tr_b16 v[18:19], v3 offset:44256
    v_lshlrev_b32 v106, 16, v201
    v_and_b32 v107, s59, v201
    v_cvt_pk_bf16_f32 v200, v104, v105
    v_fma_f32 v106, v106, v5, v6
    v_fma_f32 v107, v107, v5, v6
    s_waitcnt lgkmcnt(4)
    v_mfma_f32_32x32x16_bf16 v[32:47], v[24:27], v[196:199], v[32:47]
    s_barrier
    ds_read_b64_tr_b16 v[20:21], v3 offset:52224
    ds_read_b64_tr_b16 v[22:23], v3 offset:52352
    v_lshlrev_b32 v104, 16, v202
    v_and_b32 v105, s59, v202
    v_cvt_pk_bf16_f32 v201, v106, v107
    v_fma_f32 v104, v104, v5, v6
    v_fma_f32 v105, v105, v5, v6
    v_mfma_f32_32x32x16_bf16 v[48:63], v[28:31], v[196:199], v[48:63]
    ds_read_b64_tr_b16 v[24:25], v3 offset:52256
    ds_read_b64_tr_b16 v[26:27], v3 offset:52384
    v_lshlrev_b32 v106, 16, v203
    v_and_b32 v107, s59, v203
    v_cvt_pk_bf16_f32 v202, v104, v105
    v_fma_f32 v106, v106, v5, v6
    v_fma_f32 v107, v107, v5, v6
    s_waitcnt lgkmcnt(4)
    v_mfma_f32_32x32x16_bf16 v[64:79], v[12:15], v[196:199], v[64:79]
    ds_read_b64_tr_b16 v[28:29], v3 offset:52288
    ds_read_b64_tr_b16 v[30:31], v3 offset:52416
    v_lshlrev_b32 v104, 16, v204
    v_and_b32 v105, s59, v204
    v_cvt_pk_bf16_f32 v203, v106, v107
    v_fma_f32 v104, v104, v5, v6
    v_fma_f32 v105, v105, v5, v6
    v_mfma_f32_32x32x16_bf16 v[80:95], v[16:19], v[196:199], v[80:95]
    ds_read_b64_tr_b16 v[12:13], v3 offset:52320
    ds_read_b64_tr_b16 v[14:15], v3 offset:52448
    v_lshlrev_b32 v106, 16, v205
    v_and_b32 v107, s59, v205
    v_cvt_pk_bf16_f32 v204, v104, v105
    v_fma_f32 v106, v106, v5, v6
    v_fma_f32 v107, v107, v5, v6
    s_waitcnt lgkmcnt(4)
    v_mfma_f32_32x32x16_bf16 v[32:47], v[20:23], v[200:203], v[32:47]
    ds_read_b64_tr_b16 v[16:17], v3 offset:52736
    ds_read_b64_tr_b16 v[18:19], v3 offset:52864
    v_lshlrev_b32 v104, 16, v206
    v_and_b32 v105, s59, v206
    v_cvt_pk_bf16_f32 v205, v106, v107
    v_fma_f32 v104, v104, v5, v6
    v_fma_f32 v105, v105, v5, v6
    v_mfma_f32_32x32x16_bf16 v[48:63], v[24:27], v[200:203], v[48:63]
    ds_read_b64_tr_b16 v[20:21], v3 offset:52768
    ds_read_b64_tr_b16 v[22:23], v3 offset:52896
    v_lshlrev_b32 v106, 16, v207
    v_and_b32 v107, s59, v207
    v_cvt_pk_bf16_f32 v206, v104, v105
    v_fma_f32 v106, v106, v5, v6
    v_fma_f32 v107, v107, v5, v6
    s_waitcnt lgkmcnt(4)
    v_mfma_f32_32x32x16_bf16 v[64:79], v[28:31], v[200:203], v[64:79]
    ds_read_b64_tr_b16 v[24:25], v3 offset:52800
    ds_read_b64_tr_b16 v[26:27], v3 offset:52928
    v_lshlrev_b32 v104, 16, v208
    v_and_b32 v105, s59, v208
    v_cvt_pk_bf16_f32 v207, v106, v107
    v_fma_f32 v104, v104, v5, v6
    v_fma_f32 v105, v105, v5, v6
    v_mfma_f32_32x32x16_bf16 v[80:95], v[12:15], v[200:203], v[80:95]
    ds_read_b64_tr_b16 v[28:29], v3 offset:52832
    ds_read_b64_tr_b16 v[30:31], v3 offset:52960
    v_add_u32 v3, 60928, v3
    v_lshlrev_b32 v106, 16, v209
    v_and_b32 v107, s59, v209
    v_cvt_pk_bf16_f32 v208, v104, v105
    v_fma_f32 v106, v106, v5, v6
    v_fma_f32 v107, v107, v5, v6
    s_waitcnt lgkmcnt(4)
    v_mfma_f32_32x32x16_bf16 v[32:47], v[16:19], v[204:207], v[32:47]
    s_barrier
    ds_read_b64_tr_b16 v[12:13], v3 offset:0
    ds_read_b64_tr_b16 v[14:15], v3 offset:128
    v_lshlrev_b32 v104, 16, v210
    v_and_b32 v105, s59, v210
    v_cvt_pk_bf16_f32 v209, v106, v107
    v_fma_f32 v104, v104, v5, v6
    v_fma_f32 v105, v105, v5, v6
    v_mfma_f32_32x32x16_bf16 v[48:63], v[20:23], v[204:207], v[48:63]
    ds_read_b64_tr_b16 v[16:17], v3 offset:32
    ds_read_b64_tr_b16 v[18:19], v3 offset:160
    v_lshlrev_b32 v106, 16, v211
    v_and_b32 v107, s59, v211
    v_cvt_pk_bf16_f32 v210, v104, v105
    v_fma_f32 v106, v106, v5, v6
    v_fma_f32 v107, v107, v5, v6
    s_waitcnt lgkmcnt(4)
    v_mfma_f32_32x32x16_bf16 v[64:79], v[24:27], v[204:207], v[64:79]
    ds_read_b64_tr_b16 v[20:21], v3 offset:64
    ds_read_b64_tr_b16 v[22:23], v3 offset:192
    v_lshlrev_b32 v104, 16, v212
    v_and_b32 v105, s59, v212
    v_cvt_pk_bf16_f32 v211, v106, v107
    v_fma_f32 v104, v104, v5, v6
    v_fma_f32 v105, v105, v5, v6
    v_mfma_f32_32x32x16_bf16 v[80:95], v[28:31], v[204:207], v[80:95]
    ds_read_b64_tr_b16 v[24:25], v3 offset:96
    ds_read_b64_tr_b16 v[26:27], v3 offset:224
    v_lshlrev_b32 v106, 16, v213
    v_and_b32 v107, s59, v213
    v_cvt_pk_bf16_f32 v212, v104, v105
    v_fma_f32 v106, v106, v5, v6
    v_fma_f32 v107, v107, v5, v6
    s_waitcnt lgkmcnt(4)
    v_mfma_f32_32x32x16_bf16 v[32:47], v[12:15], v[208:211], v[32:47]
    ds_read_b64_tr_b16 v[28:29], v3 offset:512
    ds_read_b64_tr_b16 v[30:31], v3 offset:640
    v_lshlrev_b32 v104, 16, v214
    v_and_b32 v105, s59, v214
    v_cvt_pk_bf16_f32 v213, v106, v107
    v_fma_f32 v104, v104, v5, v6
    v_fma_f32 v105, v105, v5, v6
    v_mfma_f32_32x32x16_bf16 v[48:63], v[16:19], v[208:211], v[48:63]
    ds_read_b64_tr_b16 v[12:13], v3 offset:544
    ds_read_b64_tr_b16 v[14:15], v3 offset:672
    v_lshlrev_b32 v106, 16, v215
    v_and_b32 v107, s59, v215
    v_cvt_pk_bf16_f32 v214, v104, v105
    v_fma_f32 v106, v106, v5, v6
    v_fma_f32 v107, v107, v5, v6
    s_waitcnt lgkmcnt(4)
    v_mfma_f32_32x32x16_bf16 v[64:79], v[20:23], v[208:211], v[64:79]
    ds_read_b64_tr_b16 v[16:17], v3 offset:576
    ds_read_b64_tr_b16 v[18:19], v3 offset:704
    v_lshlrev_b32 v104, 16, v216
    v_and_b32 v105, s59, v216
    v_cvt_pk_bf16_f32 v215, v106, v107
    v_fma_f32 v104, v104, v5, v6
    v_fma_f32 v105, v105, v5, v6
    v_mfma_f32_32x32x16_bf16 v[80:95], v[24:27], v[208:211], v[80:95]
    ds_read_b64_tr_b16 v[20:21], v3 offset:608
    ds_read_b64_tr_b16 v[22:23], v3 offset:736
    v_lshlrev_b32 v106, 16, v217
    v_and_b32 v107, s59, v217
    v_cvt_pk_bf16_f32 v216, v104, v105
    v_fma_f32 v106, v106, v5, v6
    v_fma_f32 v107, v107, v5, v6
    s_waitcnt lgkmcnt(4)
    v_mfma_f32_32x32x16_bf16 v[32:47], v[28:31], v[212:215], v[32:47]
    s_barrier
    ds_read_b64_tr_b16 v[24:25], v3 offset:8704
    ds_read_b64_tr_b16 v[26:27], v3 offset:8832
    v_lshlrev_b32 v104, 16, v218
    v_and_b32 v105, s59, v218
    v_cvt_pk_bf16_f32 v217, v106, v107
    v_fma_f32 v104, v104, v5, v6
    v_fma_f32 v105, v105, v5, v6
    v_mfma_f32_32x32x16_bf16 v[48:63], v[12:15], v[212:215], v[48:63]
    ds_read_b64_tr_b16 v[28:29], v3 offset:8736
    ds_read_b64_tr_b16 v[30:31], v3 offset:8864
    v_lshlrev_b32 v106, 16, v219
    v_and_b32 v107, s59, v219
    v_cvt_pk_bf16_f32 v218, v104, v105
    v_fma_f32 v106, v106, v5, v6
    v_fma_f32 v107, v107, v5, v6
    s_waitcnt lgkmcnt(4)
    v_mfma_f32_32x32x16_bf16 v[64:79], v[16:19], v[212:215], v[64:79]
    ds_read_b64_tr_b16 v[12:13], v3 offset:8768
    ds_read_b64_tr_b16 v[14:15], v3 offset:8896
    v_lshlrev_b32 v104, 16, v220
    v_and_b32 v105, s59, v220
    v_cvt_pk_bf16_f32 v219, v106, v107
    v_fma_f32 v104, v104, v5, v6
    v_fma_f32 v105, v105, v5, v6
    v_mfma_f32_32x32x16_bf16 v[80:95], v[20:23], v[212:215], v[80:95]
    ds_read_b64_tr_b16 v[16:17], v3 offset:8800
    ds_read_b64_tr_b16 v[18:19], v3 offset:8928
    v_lshlrev_b32 v106, 16, v221
    v_and_b32 v107, s59, v221
    v_cvt_pk_bf16_f32 v220, v104, v105
    v_fma_f32 v106, v106, v5, v6
    v_fma_f32 v107, v107, v5, v6
    s_waitcnt lgkmcnt(4)
    v_mfma_f32_32x32x16_bf16 v[32:47], v[24:27], v[216:219], v[32:47]
    ds_read_b64_tr_b16 v[20:21], v3 offset:9216
    ds_read_b64_tr_b16 v[22:23], v3 offset:9344
    v_lshlrev_b32 v104, 16, v222
    v_and_b32 v105, s59, v222
    v_cvt_pk_bf16_f32 v221, v106, v107
    v_fma_f32 v104, v104, v5, v6
    v_fma_f32 v105, v105, v5, v6
    v_mfma_f32_32x32x16_bf16 v[48:63], v[28:31], v[216:219], v[48:63]
    ds_read_b64_tr_b16 v[24:25], v3 offset:9248
    ds_read_b64_tr_b16 v[26:27], v3 offset:9376
    v_lshlrev_b32 v106, 16, v223
    v_and_b32 v107, s59, v223
    v_cvt_pk_bf16_f32 v222, v104, v105
    v_fma_f32 v106, v106, v5, v6
    v_fma_f32 v107, v107, v5, v6
    s_waitcnt lgkmcnt(4)
    v_mfma_f32_32x32x16_bf16 v[64:79], v[12:15], v[216:219], v[64:79]
    ds_read_b64_tr_b16 v[28:29], v3 offset:9280
    ds_read_b64_tr_b16 v[30:31], v3 offset:9408
    v_lshlrev_b32 v104, 16, v224
    v_and_b32 v105, s59, v224
    v_cvt_pk_bf16_f32 v223, v106, v107
    v_fma_f32 v104, v104, v5, v6
    v_fma_f32 v105, v105, v5, v6
    v_mfma_f32_32x32x16_bf16 v[80:95], v[16:19], v[216:219], v[80:95]
    ds_read_b64_tr_b16 v[12:13], v3 offset:9312
    ds_read_b64_tr_b16 v[14:15], v3 offset:9440
    v_lshlrev_b32 v106, 16, v225
    v_and_b32 v107, s59, v225
    v_cvt_pk_bf16_f32 v224, v104, v105
    v_fma_f32 v106, v106, v5, v6
    v_fma_f32 v107, v107, v5, v6
    s_waitcnt lgkmcnt(4)
    v_mfma_f32_32x32x16_bf16 v[32:47], v[20:23], v[220:223], v[32:47]
    s_barrier
    ds_read_b64_tr_b16 v[16:17], v3 offset:17408
    ds_read_b64_tr_b16 v[18:19], v3 offset:17536
    v_lshlrev_b32 v104, 16, v226
    v_and_b32 v105, s59, v226
    v_cvt_pk_bf16_f32 v225, v106, v107
    v_fma_f32 v104, v104, v5, v6
    v_fma_f32 v105, v105, v5, v6
    v_mfma_f32_32x32x16_bf16 v[48:63], v[24:27], v[220:223], v[48:63]
    ds_read_b64_tr_b16 v[20:21], v3 offset:17440
    ds_read_b64_tr_b16 v[22:23], v3 offset:17568
    v_lshlrev_b32 v106, 16, v227
    v_and_b32 v107, s59, v227
    v_cvt_pk_bf16_f32 v226, v104, v105
    v_fma_f32 v106, v106, v5, v6
    v_fma_f32 v107, v107, v5, v6
    s_waitcnt lgkmcnt(4)
    v_mfma_f32_32x32x16_bf16 v[64:79], v[28:31], v[220:223], v[64:79]
    ds_read_b64_tr_b16 v[24:25], v3 offset:17472
    ds_read_b64_tr_b16 v[26:27], v3 offset:17600
    v_lshlrev_b32 v104, 16, v228
    v_and_b32 v105, s59, v228
    v_cvt_pk_bf16_f32 v227, v106, v107
    v_fma_f32 v104, v104, v5, v6
    v_fma_f32 v105, v105, v5, v6
    v_mfma_f32_32x32x16_bf16 v[80:95], v[12:15], v[220:223], v[80:95]
    ds_read_b64_tr_b16 v[28:29], v3 offset:17504
    ds_read_b64_tr_b16 v[30:31], v3 offset:17632
    v_lshlrev_b32 v106, 16, v229
    v_and_b32 v107, s59, v229
    v_cvt_pk_bf16_f32 v228, v104, v105
    v_fma_f32 v106, v106, v5, v6
    v_fma_f32 v107, v107, v5, v6
    s_waitcnt lgkmcnt(4)
    v_mfma_f32_32x32x16_bf16 v[32:47], v[16:19], v[224:227], v[32:47]
    ds_read_b64_tr_b16 v[12:13], v3 offset:17920
    ds_read_b64_tr_b16 v[14:15], v3 offset:18048
    v_lshlrev_b32 v104, 16, v230
    v_and_b32 v105, s59, v230
    v_cvt_pk_bf16_f32 v229, v106, v107
    v_fma_f32 v104, v104, v5, v6
    v_fma_f32 v105, v105, v5, v6
    v_mfma_f32_32x32x16_bf16 v[48:63], v[20:23], v[224:227], v[48:63]
    ds_read_b64_tr_b16 v[16:17], v3 offset:17952
    ds_read_b64_tr_b16 v[18:19], v3 offset:18080
    v_lshlrev_b32 v106, 16, v231
    v_and_b32 v107, s59, v231
    v_cvt_pk_bf16_f32 v230, v104, v105
    v_fma_f32 v106, v106, v5, v6
    v_fma_f32 v107, v107, v5, v6
    s_waitcnt lgkmcnt(4)
    v_mfma_f32_32x32x16_bf16 v[64:79], v[24:27], v[224:227], v[64:79]
    ds_read_b64_tr_b16 v[20:21], v3 offset:17984
    ds_read_b64_tr_b16 v[22:23], v3 offset:18112
    v_lshlrev_b32 v104, 16, v232
    v_and_b32 v105, s59, v232
    v_cvt_pk_bf16_f32 v231, v106, v107
    v_fma_f32 v104, v104, v5, v6
    v_fma_f32 v105, v105, v5, v6
    v_mfma_f32_32x32x16_bf16 v[80:95], v[28:31], v[224:227], v[80:95]
    ds_read_b64_tr_b16 v[24:25], v3 offset:18016
    ds_read_b64_tr_b16 v[26:27], v3 offset:18144
    v_lshlrev_b32 v106, 16, v233
    v_and_b32 v107, s59, v233
    v_cvt_pk_bf16_f32 v232, v104, v105
    v_fma_f32 v106, v106, v5, v6
    v_fma_f32 v107, v107, v5, v6
    s_waitcnt lgkmcnt(4)
    v_mfma_f32_32x32x16_bf16 v[32:47], v[12:15], v[228:231], v[32:47]
    s_barrier
    ds_read_b64_tr_b16 v[28:29], v3 offset:26112
    ds_read_b64_tr_b16 v[30:31], v3 offset:26240
    v_lshlrev_b32 v104, 16, v234
    v_and_b32 v105, s59, v234
    v_cvt_pk_bf16_f32 v233, v106, v107
    v_fma_f32 v104, v104, v5, v6
    v_fma_f32 v105, v105, v5, v6
    v_mfma_f32_32x32x16_bf16 v[48:63], v[16:19], v[228:231], v[48:63]
    ds_read_b64_tr_b16 v[12:13], v3 offset:26144
    ds_read_b64_tr_b16 v[14:15], v3 offset:26272
    v_lshlrev_b32 v106, 16, v235
    v_and_b32 v107, s59, v235
    v_cvt_pk_bf16_f32 v234, v104, v105
    v_fma_f32 v106, v106, v5, v6
    v_fma_f32 v107, v107, v5, v6
    s_waitcnt lgkmcnt(4)
    v_mfma_f32_32x32x16_bf16 v[64:79], v[20:23], v[228:231], v[64:79]
    ds_read_b64_tr_b16 v[16:17], v3 offset:26176
    ds_read_b64_tr_b16 v[18:19], v3 offset:26304
    v_lshlrev_b32 v104, 16, v236
    v_and_b32 v105, s59, v236
    v_cvt_pk_bf16_f32 v235, v106, v107
    v_fma_f32 v104, v104, v5, v6
    v_fma_f32 v105, v105, v5, v6
    v_mfma_f32_32x32x16_bf16 v[80:95], v[24:27], v[228:231], v[80:95]
    ds_read_b64_tr_b16 v[20:21], v3 offset:26208
    ds_read_b64_tr_b16 v[22:23], v3 offset:26336
    v_lshlrev_b32 v106, 16, v237
    v_and_b32 v107, s59, v237
    v_cvt_pk_bf16_f32 v236, v104, v105
    v_fma_f32 v106, v106, v5, v6
    v_fma_f32 v107, v107, v5, v6
    s_waitcnt lgkmcnt(4)
    v_mfma_f32_32x32x16_bf16 v[32:47], v[28:31], v[232:235], v[32:47]
    ds_read_b64_tr_b16 v[24:25], v3 offset:26624
    ds_read_b64_tr_b16 v[26:27], v3 offset:26752
    v_lshlrev_b32 v104, 16, v238
    v_and_b32 v105, s59, v238
    v_cvt_pk_bf16_f32 v237, v106, v107
    v_fma_f32 v104, v104, v5, v6
    v_fma_f32 v105, v105, v5, v6
    v_mfma_f32_32x32x16_bf16 v[48:63], v[12:15], v[232:235], v[48:63]
    ds_read_b64_tr_b16 v[28:29], v3 offset:26656
    ds_read_b64_tr_b16 v[30:31], v3 offset:26784
    v_lshlrev_b32 v106, 16, v239
    v_and_b32 v107, s59, v239
    v_cvt_pk_bf16_f32 v238, v104, v105
    v_fma_f32 v106, v106, v5, v6
    v_fma_f32 v107, v107, v5, v6
    s_waitcnt lgkmcnt(4)
    v_mfma_f32_32x32x16_bf16 v[64:79], v[16:19], v[232:235], v[64:79]
    ds_read_b64_tr_b16 v[12:13], v3 offset:26688
    ds_read_b64_tr_b16 v[14:15], v3 offset:26816
    v_lshlrev_b32 v104, 16, v240
    v_and_b32 v105, s59, v240
    v_cvt_pk_bf16_f32 v239, v106, v107
    v_fma_f32 v104, v104, v5, v6
    v_fma_f32 v105, v105, v5, v6
    v_mfma_f32_32x32x16_bf16 v[80:95], v[20:23], v[232:235], v[80:95]
    ds_read_b64_tr_b16 v[16:17], v3 offset:26720
    ds_read_b64_tr_b16 v[18:19], v3 offset:26848
    v_lshlrev_b32 v106, 16, v241
    v_and_b32 v107, s59, v241
    v_cvt_pk_bf16_f32 v240, v104, v105
    v_fma_f32 v106, v106, v5, v6
    v_fma_f32 v107, v107, v5, v6
    s_waitcnt lgkmcnt(4)
    v_mfma_f32_32x32x16_bf16 v[32:47], v[24:27], v[236:239], v[32:47]
    s_barrier
    ds_read_b64_tr_b16 v[20:21], v3 offset:34816
    ds_read_b64_tr_b16 v[22:23], v3 offset:34944
    v_lshlrev_b32 v104, 16, v242
    v_and_b32 v105, s59, v242
    v_cvt_pk_bf16_f32 v241, v106, v107
    v_fma_f32 v104, v104, v5, v6
    v_fma_f32 v105, v105, v5, v6
    v_mfma_f32_32x32x16_bf16 v[48:63], v[28:31], v[236:239], v[48:63]
    ds_read_b64_tr_b16 v[24:25], v3 offset:34848
    ds_read_b64_tr_b16 v[26:27], v3 offset:34976
    v_lshlrev_b32 v106, 16, v243
    v_and_b32 v107, s59, v243
    v_cvt_pk_bf16_f32 v242, v104, v105
    v_fma_f32 v106, v106, v5, v6
    v_fma_f32 v107, v107, v5, v6
    s_waitcnt lgkmcnt(4)
    v_mfma_f32_32x32x16_bf16 v[64:79], v[12:15], v[236:239], v[64:79]
    ds_read_b64_tr_b16 v[28:29], v3 offset:34880
    ds_read_b64_tr_b16 v[30:31], v3 offset:35008
    v_lshlrev_b32 v104, 16, v244
    v_and_b32 v105, s59, v244
    v_cvt_pk_bf16_f32 v243, v106, v107
    v_fma_f32 v104, v104, v5, v6
    v_fma_f32 v105, v105, v5, v6
    v_mfma_f32_32x32x16_bf16 v[80:95], v[16:19], v[236:239], v[80:95]
    ds_read_b64_tr_b16 v[12:13], v3 offset:34912
    ds_read_b64_tr_b16 v[14:15], v3 offset:35040
    v_lshlrev_b32 v106, 16, v245
    v_and_b32 v107, s59, v245
    v_cvt_pk_bf16_f32 v244, v104, v105
    v_fma_f32 v106, v106, v5, v6
    v_fma_f32 v107, v107, v5, v6
    s_waitcnt lgkmcnt(4)
    v_mfma_f32_32x32x16_bf16 v[32:47], v[20:23], v[240:243], v[32:47]
    ds_read_b64_tr_b16 v[16:17], v3 offset:35328
    ds_read_b64_tr_b16 v[18:19], v3 offset:35456
    v_lshlrev_b32 v104, 16, v246
    v_and_b32 v105, s59, v246
    v_cvt_pk_bf16_f32 v245, v106, v107
    v_fma_f32 v104, v104, v5, v6
    v_fma_f32 v105, v105, v5, v6
    v_mfma_f32_32x32x16_bf16 v[48:63], v[24:27], v[240:243], v[48:63]
    ds_read_b64_tr_b16 v[20:21], v3 offset:35360
    ds_read_b64_tr_b16 v[22:23], v3 offset:35488
    v_lshlrev_b32 v106, 16, v247
    v_and_b32 v107, s59, v247
    v_cvt_pk_bf16_f32 v246, v104, v105
    v_fma_f32 v106, v106, v5, v6
    v_fma_f32 v107, v107, v5, v6
    s_waitcnt lgkmcnt(4)
    v_mfma_f32_32x32x16_bf16 v[64:79], v[28:31], v[240:243], v[64:79]
    ds_read_b64_tr_b16 v[24:25], v3 offset:35392
    ds_read_b64_tr_b16 v[26:27], v3 offset:35520
    v_lshlrev_b32 v104, 16, v248
    v_and_b32 v105, s59, v248
    v_cvt_pk_bf16_f32 v247, v106, v107
    v_fma_f32 v104, v104, v5, v6
    v_fma_f32 v105, v105, v5, v6
    v_mfma_f32_32x32x16_bf16 v[80:95], v[12:15], v[240:243], v[80:95]
    ds_read_b64_tr_b16 v[28:29], v3 offset:35424
    ds_read_b64_tr_b16 v[30:31], v3 offset:35552
    v_lshlrev_b32 v106, 16, v249
    v_and_b32 v107, s59, v249
    v_cvt_pk_bf16_f32 v248, v104, v105
    v_fma_f32 v106, v106, v5, v6
    v_fma_f32 v107, v107, v5, v6
    s_waitcnt lgkmcnt(4)
    v_mfma_f32_32x32x16_bf16 v[32:47], v[16:19], v[244:247], v[32:47]
    s_barrier
    ds_read_b64_tr_b16 v[12:13], v3 offset:43520
    ds_read_b64_tr_b16 v[14:15], v3 offset:43648
    v_lshlrev_b32 v104, 16, v250
    v_and_b32 v105, s59, v250
    v_cvt_pk_bf16_f32 v249, v106, v107
    v_fma_f32 v104, v104, v5, v6
    v_fma_f32 v105, v105, v5, v6
    v_mfma_f32_32x32x16_bf16 v[48:63], v[20:23], v[244:247], v[48:63]
    ds_read_b64_tr_b16 v[16:17], v3 offset:43552
    ds_read_b64_tr_b16 v[18:19], v3 offset:43680
    v_lshlrev_b32 v106, 16, v251
    v_and_b32 v107, s59, v251
    v_cvt_pk_bf16_f32 v250, v104, v105
    v_fma_f32 v106, v106, v5, v6
    v_fma_f32 v107, v107, v5, v6
    s_waitcnt lgkmcnt(4)
    v_mfma_f32_32x32x16_bf16 v[64:79], v[24:27], v[244:247], v[64:79]
    ds_read_b64_tr_b16 v[20:21], v3 offset:43584
    ds_read_b64_tr_b16 v[22:23], v3 offset:43712
    v_lshlrev_b32 v104, 16, v252
    v_and_b32 v105, s59, v252
    v_cvt_pk_bf16_f32 v251, v106, v107
    v_fma_f32 v104, v104, v5, v6
    v_fma_f32 v105, v105, v5, v6
    v_mfma_f32_32x32x16_bf16 v[80:95], v[28:31], v[244:247], v[80:95]
    ds_read_b64_tr_b16 v[24:25], v3 offset:43616
    ds_read_b64_tr_b16 v[26:27], v3 offset:43744
    v_lshlrev_b32 v106, 16, v253
    v_and_b32 v107, s59, v253
    v_cvt_pk_bf16_f32 v252, v104, v105
    v_fma_f32 v106, v106, v5, v6
    v_fma_f32 v107, v107, v5, v6
    s_waitcnt lgkmcnt(4)
    v_mfma_f32_32x32x16_bf16 v[32:47], v[12:15], v[248:251], v[32:47]
    ds_read_b64_tr_b16 v[28:29], v3 offset:44032
    ds_read_b64_tr_b16 v[30:31], v3 offset:44160
    v_lshlrev_b32 v104, 16, v254
    v_and_b32 v105, s59, v254
    v_cvt_pk_bf16_f32 v253, v106, v107
    v_fma_f32 v104, v104, v5, v6
    v_fma_f32 v105, v105, v5, v6
    v_mfma_f32_32x32x16_bf16 v[48:63], v[16:19], v[248:251], v[48:63]
    ds_read_b64_tr_b16 v[12:13], v3 offset:44064
    ds_read_b64_tr_b16 v[14:15], v3 offset:44192
    v_lshlrev_b32 v106, 16, v255
    v_and_b32 v107, s59, v255
    v_cvt_pk_bf16_f32 v254, v104, v105
    v_fma_f32 v106, v106, v5, v6
    v_fma_f32 v107, v107, v5, v6
    s_waitcnt lgkmcnt(4)
    v_mfma_f32_32x32x16_bf16 v[64:79], v[20:23], v[248:251], v[64:79]
    ds_read_b64_tr_b16 v[16:17], v3 offset:44096
    ds_read_b64_tr_b16 v[18:19], v3 offset:44224
    v_cvt_pk_bf16_f32 v255, v106, v107
    v_mfma_f32_32x32x16_bf16 v[80:95], v[24:27], v[248:251], v[80:95]
    ds_read_b64_tr_b16 v[20:21], v3 offset:44128
    ds_read_b64_tr_b16 v[22:23], v3 offset:44256
    s_waitcnt lgkmcnt(4)
    v_mfma_f32_32x32x16_bf16 v[32:47], v[28:31], v[252:255], v[32:47]
    s_barrier
    ds_read_b64_tr_b16 v[24:25], v4 offset:52224
    ds_read_b64_tr_b16 v[26:27], v4 offset:52352
    v_mfma_f32_32x32x16_bf16 v[48:63], v[12:15], v[252:255], v[48:63]
    ds_read_b64_tr_b16 v[28:29], v4 offset:52288
    ds_read_b64_tr_b16 v[30:31], v4 offset:52416
    s_waitcnt lgkmcnt(4)
    v_mfma_f32_32x32x16_bf16 v[64:79], v[16:19], v[252:255], v[64:79]
    ds_read_b64_tr_b16 v[12:13], v4 offset:52736
    ds_read_b64_tr_b16 v[14:15], v4 offset:52864
    v_mfma_f32_32x32x16_bf16 v[80:95], v[20:23], v[252:255], v[80:95]
    ds_read_b64_tr_b16 v[16:17], v4 offset:52800
    ds_read_b64_tr_b16 v[18:19], v4 offset:52928
    s_cmp_eq_u32 s53, 0
    s_cbranch_scc1 L_p2_q
    s_cmp_eq_u32 s53, 1
    s_cbranch_scc1 L_p2_k
    s_waitcnt lgkmcnt(4)
    v_mfma_f32_32x32x16_bf16 v[96:111], v[128:131], v[24:27], 0
    ds_read_b64_tr_b16 v[20:21], v4 offset:56576
    ds_read_b64_tr_b16 v[22:23], v4 offset:56704
    v_mfma_f32_32x32x16_bf16 v[112:127], v[128:131], v[28:31], 0
    ds_read_b64_tr_b16 v[24:25], v4 offset:56640
    ds_read_b64_tr_b16 v[26:27], v4 offset:56768
    s_waitcnt lgkmcnt(4)
    v_mfma_f32_32x32x16_bf16 v[96:111], v[132:135], v[12:15], v[96:111]
    ds_read_b64_tr_b16 v[28:29], v4 offset:57088
    ds_read_b64_tr_b16 v[30:31], v4 offset:57216
    v_mul_f32 v40, v32, v40
    v_mul_f32 v41, v33, v41
    v_mfma_f32_32x32x16_bf16 v[112:127], v[132:135], v[16:19], v[112:127]
    ds_read_b64_tr_b16 v[12:13], v4 offset:57152
    ds_read_b64_tr_b16 v[14:15], v4 offset:57280
    v_subrev_u32 v4, 60928, v4
    v_exp_f32 v32, -v32
    s_waitcnt lgkmcnt(4)
    v_mfma_f32_32x32x16_bf16 v[96:111], v[136:139], v[20:23], v[96:111]
    s_barrier
    ds_read_b64_tr_b16 v[16:17], v4 offset:0
    ds_read_b64_tr_b16 v[18:19], v4 offset:128
    v_mfma_f32_32x32x16_bf16 v[112:127], v[136:139], v[24:27], v[112:127]
    ds_read_b64_tr_b16 v[20:21], v4 offset:64
    ds_read_b64_tr_b16 v[22:23], v4 offset:192
    v_exp_f32 v33, -v33
    v_add_f32 v32, 1.0, v32
    s_waitcnt lgkmcnt(4)
    v_mfma_f32_32x32x16_bf16 v[96:111], v[140:143], v[28:31], v[96:111]
    ds_read_b64_tr_b16 v[24:25], v4 offset:512
    ds_read_b64_tr_b16 v[26:27], v4 offset:640
    v_add_f32 v33, 1.0, v33
    v_mfma_f32_32x32x16_bf16 v[112:127], v[140:143], v[12:15], v[112:127]
    ds_read_b64_tr_b16 v[28:29], v4 offset:576
    ds_read_b64_tr_b16 v[30:31], v4 offset:704
    v_rcp_f32 v32, v32
    v_rcp_f32 v33, v33
    s_waitcnt lgkmcnt(4)
    v_mfma_f32_32x32x16_bf16 v[96:111], v[144:147], v[16:19], v[96:111]
    ds_read_b64_tr_b16 v[12:13], v4 offset:4352
    ds_read_b64_tr_b16 v[14:15], v4 offset:4480
    v_mul_f32 v32, v32, v40
    v_mul_f32 v33, v33, v41
    v_mfma_f32_32x32x16_bf16 v[112:127], v[144:147], v[20:23], v[112:127]
    ds_read_b64_tr_b16 v[16:17], v4 offset:4416
    ds_read_b64_tr_b16 v[18:19], v4 offset:4544
    v_cvt_pk_bf16_f32 v40, v32, v33
    v_mul_f32 v42, v34, v42
    v_mul_f32 v43, v35, v43
    s_waitcnt lgkmcnt(4)
    v_mfma_f32_32x32x16_bf16 v[96:111], v[148:151], v[24:27], v[96:111]
    ds_read_b64_tr_b16 v[20:21], v4 offset:4864
    ds_read_b64_tr_b16 v[22:23], v4 offset:4992
    v_exp_f32 v34, -v34
    v_mfma_f32_32x32x16_bf16 v[112:127], v[148:151], v[28:31], v[112:127]
    ds_read_b64_tr_b16 v[24:25], v4 offset:4928
    ds_read_b64_tr_b16 v[26:27], v4 offset:5056
    v_exp_f32 v35, -v35
    v_add_f32 v34, 1.0, v34
    s_waitcnt lgkmcnt(4)
    v_mfma_f32_32x32x16_bf16 v[96:111], v[152:155], v[12:15], v[96:111]
    s_barrier
    ds_read_b64_tr_b16 v[28:29], v4 offset:8704
    ds_read_b64_tr_b16 v[30:31], v4 offset:8832
    v_mfma_f32_32x32x16_bf16 v[112:127], v[152:155], v[16:19], v[112:127]
    ds_read_b64_tr_b16 v[12:13], v4 offset:8768
    ds_read_b64_tr_b16 v[14:15], v4 offset:8896
    v_add_f32 v35, 1.0, v35
    v_rcp_f32 v34, v34
    s_waitcnt lgkmcnt(4)
    v_mfma_f32_32x32x16_bf16 v[96:111], v[156:159], v[20:23], v[96:111]
    ds_read_b64_tr_b16 v[16:17], v4 offset:9216
    ds_read_b64_tr_b16 v[18:19], v4 offset:9344
    v_rcp_f32 v35, v35
    v_mfma_f32_32x32x16_bf16 v[112:127], v[156:159], v[24:27], v[112:127]
    ds_read_b64_tr_b16 v[20:21], v4 offset:9280
    ds_read_b64_tr_b16 v[22:23], v4 offset:9408
    v_mul_f32 v34, v34, v42
    v_mul_f32 v35, v35, v43
    v_cvt_pk_bf16_f32 v41, v34, v35
    s_waitcnt lgkmcnt(4)
    v_mfma_f32_32x32x16_bf16 v[96:111], v[160:163], v[28:31], v[96:111]
    ds_read_b64_tr_b16 v[24:25], v4 offset:13056
    ds_read_b64_tr_b16 v[26:27], v4 offset:13184
    v_mul_f32 v44, v36, v44
    v_mul_f32 v45, v37, v45
    v_mfma_f32_32x32x16_bf16 v[112:127], v[160:163], v[12:15], v[112:127]
    ds_read_b64_tr_b16 v[28:29], v4 offset:13120
    ds_read_b64_tr_b16 v[30:31], v4 offset:13248
    v_exp_f32 v36, -v36
    s_waitcnt lgkmcnt(4)
    v_mfma_f32_32x32x16_bf16 v[96:111], v[164:167], v[16:19], v[96:111]
    ds_read_b64_tr_b16 v[12:13], v4 offset:13568
    ds_read_b64_tr_b16 v[14:15], v4 offset:13696
    v_exp_f32 v37, -v37
    v_add_f32 v36, 1.0, v36
    v_mfma_f32_32x32x16_bf16 v[112:127], v[164:167], v[20:23], v[112:127]
    ds_read_b64_tr_b16 v[16:17], v4 offset:13632
    ds_read_b64_tr_b16 v[18:19], v4 offset:13760
    v_add_f32 v37, 1.0, v37
    v_rcp_f32 v36, v36
    s_waitcnt lgkmcnt(4)
    v_mfma_f32_32x32x16_bf16 v[96:111], v[168:171], v[24:27], v[96:111]
    s_barrier
    ds_read_b64_tr_b16 v[20:21], v4 offset:17408
    ds_read_b64_tr_b16 v[22:23], v4 offset:17536
    v_mfma_f32_32x32x16_bf16 v[112:127], v[168:171], v[28:31], v[112:127]
    ds_read_b64_tr_b16 v[24:25], v4 offset:17472
    ds_read_b64_tr_b16 v[26:27], v4 offset:17600
    v_rcp_f32 v37, v37
    v_mul_f32 v36, v36, v44
    s_waitcnt lgkmcnt(4)
    v_mfma_f32_32x32x16_bf16 v[96:111], v[172:175], v[12:15], v[96:111]
    ds_read_b64_tr_b16 v[28:29], v4 offset:17920
    ds_read_b64_tr_b16 v[30:31], v4 offset:18048
    v_mul_f32 v37, v37, v45
    v_cvt_pk_bf16_f32 v42, v36, v37
    v_mfma_f32_32x32x16_bf16 v[112:127], v[172:175], v[16:19], v[112:127]
    ds_read_b64_tr_b16 v[12:13], v4 offset:17984
    ds_read_b64_tr_b16 v[14:15], v4 offset:18112
    v_mul_f32 v46, v38, v46
    v_mul_f32 v47, v39, v47
    s_waitcnt lgkmcnt(4)
    v_mfma_f32_32x32x16_bf16 v[96:111], v[176:179], v[20:23], v[96:111]
    ds_read_b64_tr_b16 v[16:17], v4 offset:21760
    ds_read_b64_tr_b16 v[18:19], v4 offset:21888
    v_exp_f32 v38, -v38
    v_mfma_f32_32x32x16_bf16 v[112:127], v[176:179], v[24:27], v[112:127]
    ds_read_b64_tr_b16 v[20:21], v4 offset:21824
    ds_read_b64_tr_b16 v[22:23], v4 offset:21952
    v_exp_f32 v39, -v39
    v_add_f32 v38, 1.0, v38
    v_add_f32 v39, 1.0, v39
    s_waitcnt lgkmcnt(4)
    v_mfma_f32_32x32x16_bf16 v[96:111], v[180:183], v[28:31], v[96:111]
    ds_read_b64_tr_b16 v[24:25], v4 offset:22272
    ds_read_b64_tr_b16 v[26:27], v4 offset:22400
    v_rcp_f32 v38, v38
    v_mfma_f32_32x32x16_bf16 v[112:127], v[180:183], v[12:15], v[112:127]
    ds_read_b64_tr_b16 v[28:29], v4 offset:22336
    ds_read_b64_tr_b16 v[30:31], v4 offset:22464
    v_rcp_f32 v39, v39
    v_mul_f32 v38, v38, v46
    s_waitcnt lgkmcnt(4)
    v_mfma_f32_32x32x16_bf16 v[96:111], v[184:187], v[16:19], v[96:111]
    s_barrier
    ds_read_b64_tr_b16 v[12:13], v4 offset:26112
    ds_read_b64_tr_b16 v[14:15], v4 offset:26240
    v_mfma_f32_32x32x16_bf16 v[112:127], v[184:187], v[20:23], v[112:127]
    ds_read_b64_tr_b16 v[16:17], v4 offset:26176
    ds_read_b64_tr_b16 v[18:19], v4 offset:26304
    v_mul_f32 v39, v39, v47
    v_cvt_pk_bf16_f32 v43, v38, v39
    s_waitcnt lgkmcnt(4)
    v_mfma_f32_32x32x16_bf16 v[96:111], v[188:191], v[24:27], v[96:111]
    ds_read_b64_tr_b16 v[20:21], v4 offset:26624
    ds_read_b64_tr_b16 v[22:23], v4 offset:26752
    buffer_store_dwordx4 v[40:43], v1, s[24:27], s61 offen offset:0 sc1
    v_mul_f32 v56, v48, v56
    v_mfma_f32_32x32x16_bf16 v[112:127], v[188:191], v[28:31], v[112:127]
    ds_read_b64_tr_b16 v[24:25], v4 offset:26688
    ds_read_b64_tr_b16 v[26:27], v4 offset:26816
    v_mul_f32 v57, v49, v57
    v_exp_f32 v48, -v48
    s_waitcnt lgkmcnt(4)
    v_mfma_f32_32x32x16_bf16 v[96:111], v[192:195], v[12:15], v[96:111]
    ds_read_b64_tr_b16 v[28:29], v4 offset:30464
    ds_read_b64_tr_b16 v[30:31], v4 offset:30592
    v_exp_f32 v49, -v49
    v_mfma_f32_32x32x16_bf16 v[112:127], v[192:195], v[16:19], v[112:127]
    ds_read_b64_tr_b16 v[12:13], v4 offset:30528
    ds_read_b64_tr_b16 v[14:15], v4 offset:30656
    v_add_f32 v48, 1.0, v48
    v_add_f32 v49, 1.0, v49
    s_waitcnt lgkmcnt(4)
    v_mfma_f32_32x32x16_bf16 v[96:111], v[196:199], v[20:23], v[96:111]
    ds_read_b64_tr_b16 v[16:17], v4 offset:30976
    ds_read_b64_tr_b16 v[18:19], v4 offset:31104
    v_rcp_f32 v48, v48
    v_mfma_f32_32x32x16_bf16 v[112:127], v[196:199], v[24:27], v[112:127]
    ds_read_b64_tr_b16 v[20:21], v4 offset:31040
    ds_read_b64_tr_b16 v[22:23], v4 offset:31168
    v_rcp_f32 v49, v49
    v_mul_f32 v48, v48, v56
    v_mul_f32 v49, v49, v57
    s_waitcnt lgkmcnt(4)
    v_mfma_f32_32x32x16_bf16 v[96:111], v[200:203], v[28:31], v[96:111]
    s_barrier
    ds_read_b64_tr_b16 v[24:25], v4 offset:34816
    ds_read_b64_tr_b16 v[26:27], v4 offset:34944
    v_mfma_f32_32x32x16_bf16 v[112:127], v[200:203], v[12:15], v[112:127]
    ds_read_b64_tr_b16 v[28:29], v4 offset:34880
    ds_read_b64_tr_b16 v[30:31], v4 offset:35008
    v_cvt_pk_bf16_f32 v56, v48, v49
    v_mul_f32 v58, v50, v58
    v_mul_f32 v59, v51, v59
    s_waitcnt lgkmcnt(4)
    v_mfma_f32_32x32x16_bf16 v[96:111], v[204:207], v[16:19], v[96:111]
    ds_read_b64_tr_b16 v[12:13], v4 offset:35328
    ds_read_b64_tr_b16 v[14:15], v4 offset:35456
    v_exp_f32 v50, -v50
    v_mfma_f32_32x32x16_bf16 v[112:127], v[204:207], v[20:23], v[112:127]
    ds_read_b64_tr_b16 v[16:17], v4 offset:35392
    ds_read_b64_tr_b16 v[18:19], v4 offset:35520
    v_exp_f32 v51, -v51
    v_add_f32 v50, 1.0, v50
    s_waitcnt lgkmcnt(4)
    v_mfma_f32_32x32x16_bf16 v[96:111], v[208:211], v[24:27], v[96:111]
    ds_read_b64_tr_b16 v[20:21], v4 offset:39168
    ds_read_b64_tr_b16 v[22:23], v4 offset:39296
    v_add_f32 v51, 1.0, v51
    v_mfma_f32_32x32x16_bf16 v[112:127], v[208:211], v[28:31], v[112:127]
    ds_read_b64_tr_b16 v[24:25], v4 offset:39232
    ds_read_b64_tr_b16 v[26:27], v4 offset:39360
    v_rcp_f32 v50, v50
    v_rcp_f32 v51, v51
    s_waitcnt lgkmcnt(4)
    v_mfma_f32_32x32x16_bf16 v[96:111], v[212:215], v[12:15], v[96:111]
    ds_read_b64_tr_b16 v[28:29], v4 offset:39680
    ds_read_b64_tr_b16 v[30:31], v4 offset:39808
    v_mul_f32 v50, v50, v58
    v_mul_f32 v51, v51, v59
    v_mfma_f32_32x32x16_bf16 v[112:127], v[212:215], v[16:19], v[112:127]
    ds_read_b64_tr_b16 v[12:13], v4 offset:39744
    ds_read_b64_tr_b16 v[14:15], v4 offset:39872
    v_cvt_pk_bf16_f32 v57, v50, v51
    v_mul_f32 v60, v52, v60
    v_mul_f32 v61, v53, v61
    s_waitcnt lgkmcnt(4)
    v_mfma_f32_32x32x16_bf16 v[96:111], v[216:219], v[20:23], v[96:111]
    s_barrier
    ds_read_b64_tr_b16 v[16:17], v4 offset:43520
    ds_read_b64_tr_b16 v[18:19], v4 offset:43648
    v_mfma_f32_32x32x16_bf16 v[112:127], v[216:219], v[24:27], v[112:127]
    ds_read_b64_tr_b16 v[20:21], v4 offset:43584
    ds_read_b64_tr_b16 v[22:23], v4 offset:43712
    v_exp_f32 v52, -v52
    s_waitcnt lgkmcnt(4)
    v_mfma_f32_32x32x16_bf16 v[96:111], v[220:223], v[28:31], v[96:111]
    ds_read_b64_tr_b16 v[24:25], v4 offset:44032
    ds_read_b64_tr_b16 v[26:27], v4 offset:44160
    v_exp_f32 v53, -v53
    v_add_f32 v52, 1.0, v52
    v_mfma_f32_32x32x16_bf16 v[112:127], v[220:223], v[12:15], v[112:127]
    ds_read_b64_tr_b16 v[28:29], v4 offset:44096
    ds_read_b64_tr_b16 v[30:31], v4 offset:44224
    v_add_f32 v53, 1.0, v53
    v_rcp_f32 v52, v52
    s_waitcnt lgkmcnt(4)
    v_mfma_f32_32x32x16_bf16 v[96:111], v[224:227], v[16:19], v[96:111]
    ds_read_b64_tr_b16 v[12:13], v4 offset:47872
    ds_read_b64_tr_b16 v[14:15], v4 offset:48000
    v_rcp_f32 v53, v53
    v_mfma_f32_32x32x16_bf16 v[112:127], v[224:227], v[20:23], v[112:127]
    ds_read_b64_tr_b16 v[16:17], v4 offset:47936
    ds_read_b64_tr_b16 v[18:19], v4 offset:48064
    v_mul_f32 v52, v52, v60
    v_mul_f32 v53, v53, v61
    v_cvt_pk_bf16_f32 v58, v52, v53
    s_waitcnt lgkmcnt(4)
    v_mfma_f32_32x32x16_bf16 v[96:111], v[228:231], v[24:27], v[96:111]
    ds_read_b64_tr_b16 v[20:21], v4 offset:48384
    ds_read_b64_tr_b16 v[22:23], v4 offset:48512
    v_mul_f32 v62, v54, v62
    v_mul_f32 v63, v55, v63
    v_mfma_f32_32x32x16_bf16 v[112:127], v[228:231], v[28:31], v[112:127]
    ds_read_b64_tr_b16 v[24:25], v4 offset:48448
    ds_read_b64_tr_b16 v[26:27], v4 offset:48576
    v_exp_f32 v54, -v54
    s_waitcnt lgkmcnt(4)
    v_mfma_f32_32x32x16_bf16 v[96:111], v[232:235], v[12:15], v[96:111]
    s_barrier
    ds_read_b64_tr_b16 v[28:29], v4 offset:52224
    ds_read_b64_tr_b16 v[30:31], v4 offset:52352
    v_mfma_f32_32x32x16_bf16 v[112:127], v[232:235], v[16:19], v[112:127]
    ds_read_b64_tr_b16 v[12:13], v4 offset:52288
    ds_read_b64_tr_b16 v[14:15], v4 offset:52416
    v_exp_f32 v55, -v55
    v_add_f32 v54, 1.0, v54
    v_add_f32 v55, 1.0, v55
    s_waitcnt lgkmcnt(4)
    v_mfma_f32_32x32x16_bf16 v[96:111], v[236:239], v[20:23], v[96:111]
    ds_read_b64_tr_b16 v[16:17], v4 offset:52736
    ds_read_b64_tr_b16 v[18:19], v4 offset:52864
    v_rcp_f32 v54, v54
    v_mfma_f32_32x32x16_bf16 v[112:127], v[236:239], v[24:27], v[112:127]
    ds_read_b64_tr_b16 v[20:21], v4 offset:52800
    ds_read_b64_tr_b16 v[22:23], v4 offset:52928
    v_rcp_f32 v55, v55
    v_mul_f32 v54, v54, v62
    s_waitcnt lgkmcnt(4)
    v_mfma_f32_32x32x16_bf16 v[96:111], v[240:243], v[28:31], v[96:111]
    ds_read_b64_tr_b16 v[24:25], v4 offset:56576
    ds_read_b64_tr_b16 v[26:27], v4 offset:56704
    v_mul_f32 v55, v55, v63
    v_cvt_pk_bf16_f32 v59, v54, v55
    v_mfma_f32_32x32x16_bf16 v[112:127], v[240:243], v[12:15], v[112:127]
    ds_read_b64_tr_b16 v[28:29], v4 offset:56640
    ds_read_b64_tr_b16 v[30:31], v4 offset:56768
    buffer_store_dwordx4 v[56:59], v1, s[24:27], s61 offen offset:1024 sc1
    s_waitcnt lgkmcnt(4)
    v_mfma_f32_32x32x16_bf16 v[96:111], v[244:247], v[16:19], v[96:111]
    ds_read_b64_tr_b16 v[12:13], v4 offset:57088
    ds_read_b64_tr_b16 v[14:15], v4 offset:57216
    v_mfma_f32_32x32x16_bf16 v[112:127], v[244:247], v[20:23], v[112:127]
    ds_read_b64_tr_b16 v[16:17], v4 offset:57152
    ds_read_b64_tr_b16 v[18:19], v4 offset:57280
    s_waitcnt lgkmcnt(4)
    v_mfma_f32_32x32x16_bf16 v[96:111], v[248:251], v[24:27], v[96:111]
    s_barrier
    ds_read_b64_tr_b16 v[20:21], v3 offset:0
    ds_read_b64_tr_b16 v[22:23], v3 offset:128
    v_mfma_f32_32x32x16_bf16 v[112:127], v[248:251], v[28:31], v[112:127]
    ds_read_b64_tr_b16 v[24:25], v3 offset:32
    ds_read_b64_tr_b16 v[26:27], v3 offset:160
    s_waitcnt lgkmcnt(4)
    v_mfma_f32_32x32x16_bf16 v[96:111], v[252:255], v[12:15], v[96:111]
    ds_read_b64_tr_b16 v[28:29], v3 offset:512
    ds_read_b64_tr_b16 v[30:31], v3 offset:640
    v_mfma_f32_32x32x16_bf16 v[112:127], v[252:255], v[16:19], v[112:127]
    ds_read_b64_tr_b16 v[12:13], v3 offset:544
    ds_read_b64_tr_b16 v[14:15], v3 offset:672
    s_branch L_p3
L_p2_q:
    s_nop 4
    s_waitcnt lgkmcnt(4)
    v_mfma_f32_32x32x16_bf16 v[96:111], v[24:27], v[128:131], 0
    ds_read_b64_tr_b16 v[20:21], v4 offset:56576
    ds_read_b64_tr_b16 v[22:23], v4 offset:56704
    v_mfma_f32_32x32x16_bf16 v[112:127], v[28:31], v[128:131], 0
    ds_read_b64_tr_b16 v[24:25], v4 offset:56640
    ds_read_b64_tr_b16 v[26:27], v4 offset:56768
    s_waitcnt lgkmcnt(4)
    v_mfma_f32_32x32x16_bf16 v[96:111], v[12:15], v[132:135], v[96:111]
    ds_read_b64_tr_b16 v[28:29], v4 offset:57088
    ds_read_b64_tr_b16 v[30:31], v4 offset:57216
    v_mul_f32 v32, s67, v32
    v_mul_f32 v33, s67, v33
    v_mfma_f32_32x32x16_bf16 v[112:127], v[16:19], v[132:135], v[112:127]
    ds_read_b64_tr_b16 v[12:13], v4 offset:57152
    ds_read_b64_tr_b16 v[14:15], v4 offset:57280
    v_subrev_u32 v4, 60928, v4
    v_mul_f32 v34, s67, v34
    v_mul_f32 v35, s67, v35
    s_waitcnt lgkmcnt(4)
    v_mfma_f32_32x32x16_bf16 v[96:111], v[20:23], v[136:139], v[96:111]
    s_barrier
    ds_read_b64_tr_b16 v[16:17], v4 offset:0
    ds_read_b64_tr_b16 v[18:19], v4 offset:128
    v_mfma_f32_32x32x16_bf16 v[112:127], v[24:27], v[136:139], v[112:127]
    ds_read_b64_tr_b16 v[20:21], v4 offset:64
    ds_read_b64_tr_b16 v[22:23], v4 offset:192
    v_mul_f32 v36, s67, v36
    v_mul_f32 v37, s67, v37
    v_mul_f32 v38, s67, v38
    v_mul_f32 v39, s67, v39
    s_waitcnt lgkmcnt(4)
    v_mfma_f32_32x32x16_bf16 v[96:111], v[28:31], v[140:143], v[96:111]
    ds_read_b64_tr_b16 v[24:25], v4 offset:512
    ds_read_b64_tr_b16 v[26:27], v4 offset:640
    v_cvt_pk_bf16_f32 v32, v32, v33
    v_cvt_pk_bf16_f32 v33, v34, v35
    v_mfma_f32_32x32x16_bf16 v[112:127], v[12:15], v[140:143], v[112:127]
    ds_read_b64_tr_b16 v[28:29], v4 offset:576
    ds_read_b64_tr_b16 v[30:31], v4 offset:704
    v_cvt_pk_bf16_f32 v34, v36, v37
    v_cvt_pk_bf16_f32 v35, v38, v39
    s_add_u32 s71, s70, 0
    s_waitcnt lgkmcnt(4)
    v_mfma_f32_32x32x16_bf16 v[96:111], v[16:19], v[144:147], v[96:111]
    ds_read_b64_tr_b16 v[12:13], v4 offset:4352
    ds_read_b64_tr_b16 v[14:15], v4 offset:4480
    buffer_store_dwordx4 v[32:35], v1, s[24:27], s71 offen sc1
    v_mul_f32 v40, s67, v40
    v_mfma_f32_32x32x16_bf16 v[112:127], v[20:23], v[144:147], v[112:127]
    ds_read_b64_tr_b16 v[16:17], v4 offset:4416
    ds_read_b64_tr_b16 v[18:19], v4 offset:4544
    v_mul_f32 v41, s67, v41
    v_mul_f32 v42, s67, v42
    v_mul_f32 v43, s67, v43
    s_waitcnt lgkmcnt(4)
    v_mfma_f32_32x32x16_bf16 v[96:111], v[24:27], v[148:151], v[96:111]
    ds_read_b64_tr_b16 v[20:21], v4 offset:4864
    ds_read_b64_tr_b16 v[22:23], v4 offset:4992
    v_mul_f32 v44, s67, v44
    v_mul_f32 v45, s67, v45
    v_mul_f32 v46, s67, v46
    v_mfma_f32_32x32x16_bf16 v[112:127], v[28:31], v[148:151], v[112:127]
    ds_read_b64_tr_b16 v[24:25], v4 offset:4928
    ds_read_b64_tr_b16 v[26:27], v4 offset:5056
    v_mul_f32 v47, s67, v47
    v_cvt_pk_bf16_f32 v40, v40, v41
    v_cvt_pk_bf16_f32 v41, v42, v43
    s_waitcnt lgkmcnt(4)
    v_mfma_f32_32x32x16_bf16 v[96:111], v[12:15], v[152:155], v[96:111]
    s_barrier
    ds_read_b64_tr_b16 v[28:29], v4 offset:8704
    ds_read_b64_tr_b16 v[30:31], v4 offset:8832
    v_mfma_f32_32x32x16_bf16 v[112:127], v[16:19], v[152:155], v[112:127]
    ds_read_b64_tr_b16 v[12:13], v4 offset:8768
    ds_read_b64_tr_b16 v[14:15], v4 offset:8896
    v_cvt_pk_bf16_f32 v42, v44, v45
    v_cvt_pk_bf16_f32 v43, v46, v47
    s_add_u32 s71, s70, 262144
    s_waitcnt lgkmcnt(4)
    v_mfma_f32_32x32x16_bf16 v[96:111], v[20:23], v[156:159], v[96:111]
    ds_read_b64_tr_b16 v[16:17], v4 offset:9216
    ds_read_b64_tr_b16 v[18:19], v4 offset:9344
    buffer_store_dwordx4 v[40:43], v1, s[24:27], s71 offen sc1
    v_mul_f32 v48, s67, v48
    v_mfma_f32_32x32x16_bf16 v[112:127], v[24:27], v[156:159], v[112:127]
    ds_read_b64_tr_b16 v[20:21], v4 offset:9280
    ds_read_b64_tr_b16 v[22:23], v4 offset:9408
    v_mul_f32 v49, s67, v49
    v_mul_f32 v50, s67, v50
    v_mul_f32 v51, s67, v51
    s_waitcnt lgkmcnt(4)
    v_mfma_f32_32x32x16_bf16 v[96:111], v[28:31], v[160:163], v[96:111]
    ds_read_b64_tr_b16 v[24:25], v4 offset:13056
    ds_read_b64_tr_b16 v[26:27], v4 offset:13184
    v_mul_f32 v52, s67, v52
    v_mul_f32 v53, s67, v53
    v_mul_f32 v54, s67, v54
    v_mfma_f32_32x32x16_bf16 v[112:127], v[12:15], v[160:163], v[112:127]
    ds_read_b64_tr_b16 v[28:29], v4 offset:13120
    ds_read_b64_tr_b16 v[30:31], v4 offset:13248
    v_mul_f32 v55, s67, v55
    v_cvt_pk_bf16_f32 v48, v48, v49
    v_cvt_pk_bf16_f32 v49, v50, v51
    s_waitcnt lgkmcnt(4)
    v_mfma_f32_32x32x16_bf16 v[96:111], v[16:19], v[164:167], v[96:111]
    ds_read_b64_tr_b16 v[12:13], v4 offset:13568
    ds_read_b64_tr_b16 v[14:15], v4 offset:13696
    v_cvt_pk_bf16_f32 v50, v52, v53
    v_cvt_pk_bf16_f32 v51, v54, v55
    s_add_u32 s71, s70, 65536
    v_mfma_f32_32x32x16_bf16 v[112:127], v[20:23], v[164:167], v[112:127]
    ds_read_b64_tr_b16 v[16:17], v4 offset:13632
    ds_read_b64_tr_b16 v[18:19], v4 offset:13760
    buffer_store_dwordx4 v[48:51], v1, s[24:27], s71 offen sc1
    v_mul_f32 v56, s67, v56
    s_waitcnt lgkmcnt(4)
    v_mfma_f32_32x32x16_bf16 v[96:111], v[24:27], v[168:171], v[96:111]
    s_barrier
    ds_read_b64_tr_b16 v[20:21], v4 offset:17408
    ds_read_b64_tr_b16 v[22:23], v4 offset:17536
    v_mfma_f32_32x32x16_bf16 v[112:127], v[28:31], v[168:171], v[112:127]
    ds_read_b64_tr_b16 v[24:25], v4 offset:17472
    ds_read_b64_tr_b16 v[26:27], v4 offset:17600
    v_mul_f32 v57, s67, v57
    v_mul_f32 v58, s67, v58
    v_mul_f32 v59, s67, v59
    s_waitcnt lgkmcnt(4)
    v_mfma_f32_32x32x16_bf16 v[96:111], v[12:15], v[172:175], v[96:111]
    ds_read_b64_tr_b16 v[28:29], v4 offset:17920
    ds_read_b64_tr_b16 v[30:31], v4 offset:18048
    v_mul_f32 v60, s67, v60
    v_mul_f32 v61, s67, v61
    v_mul_f32 v62, s67, v62
    v_mfma_f32_32x32x16_bf16 v[112:127], v[16:19], v[172:175], v[112:127]
    ds_read_b64_tr_b16 v[12:13], v4 offset:17984
    ds_read_b64_tr_b16 v[14:15], v4 offset:18112
    v_mul_f32 v63, s67, v63
    v_cvt_pk_bf16_f32 v56, v56, v57
    v_cvt_pk_bf16_f32 v57, v58, v59
    s_waitcnt lgkmcnt(4)
    v_mfma_f32_32x32x16_bf16 v[96:111], v[20:23], v[176:179], v[96:111]
    ds_read_b64_tr_b16 v[16:17], v4 offset:21760
    ds_read_b64_tr_b16 v[18:19], v4 offset:21888
    v_cvt_pk_bf16_f32 v58, v60, v61
    v_cvt_pk_bf16_f32 v59, v62, v63
    s_add_u32 s71, s70, 327680
    v_mfma_f32_32x32x16_bf16 v[112:127], v[24:27], v[176:179], v[112:127]
    ds_read_b64_tr_b16 v[20:21], v4 offset:21824
    ds_read_b64_tr_b16 v[22:23], v4 offset:21952
    buffer_store_dwordx4 v[56:59], v1, s[24:27], s71 offen sc1
    v_mul_f32 v64, s67, v64
    s_waitcnt lgkmcnt(4)
    v_mfma_f32_32x32x16_bf16 v[96:111], v[28:31], v[180:183], v[96:111]
    ds_read_b64_tr_b16 v[24:25], v4 offset:22272
    ds_read_b64_tr_b16 v[26:27], v4 offset:22400
    v_mul_f32 v65, s67, v65
    v_mul_f32 v66, s67, v66
    v_mfma_f32_32x32x16_bf16 v[112:127], v[12:15], v[180:183], v[112:127]
    ds_read_b64_tr_b16 v[28:29], v4 offset:22336
    ds_read_b64_tr_b16 v[30:31], v4 offset:22464
    v_mul_f32 v67, s67, v67
    v_mul_f32 v68, s67, v68
    v_mul_f32 v69, s67, v69
    v_mul_f32 v70, s67, v70
    s_waitcnt lgkmcnt(4)
    v_mfma_f32_32x32x16_bf16 v[96:111], v[16:19], v[184:187], v[96:111]
    s_barrier
    ds_read_b64_tr_b16 v[12:13], v4 offset:26112
    ds_read_b64_tr_b16 v[14:15], v4 offset:26240
    v_mfma_f32_32x32x16_bf16 v[112:127], v[20:23], v[184:187], v[112:127]
    ds_read_b64_tr_b16 v[16:17], v4 offset:26176
    ds_read_b64_tr_b16 v[18:19], v4 offset:26304
    v_mul_f32 v71, s67, v71
    v_cvt_pk_bf16_f32 v64, v64, v65
    v_cvt_pk_bf16_f32 v65, v66, v67
    s_waitcnt lgkmcnt(4)
    v_mfma_f32_32x32x16_bf16 v[96:111], v[24:27], v[188:191], v[96:111]
    ds_read_b64_tr_b16 v[20:21], v4 offset:26624
    ds_read_b64_tr_b16 v[22:23], v4 offset:26752
    v_cvt_pk_bf16_f32 v66, v68, v69
    v_cvt_pk_bf16_f32 v67, v70, v71
    s_add_u32 s71, s70, 131072
    v_mfma_f32_32x32x16_bf16 v[112:127], v[28:31], v[188:191], v[112:127]
    ds_read_b64_tr_b16 v[24:25], v4 offset:26688
    ds_read_b64_tr_b16 v[26:27], v4 offset:26816
    buffer_store_dwordx4 v[64:67], v1, s[24:27], s71 offen sc1
    v_mul_f32 v72, s67, v72
    s_waitcnt lgkmcnt(4)
    v_mfma_f32_32x32x16_bf16 v[96:111], v[12:15], v[192:195], v[96:111]
    ds_read_b64_tr_b16 v[28:29], v4 offset:30464
    ds_read_b64_tr_b16 v[30:31], v4 offset:30592
    v_mul_f32 v73, s67, v73
    v_mul_f32 v74, s67, v74
    v_mfma_f32_32x32x16_bf16 v[112:127], v[16:19], v[192:195], v[112:127]
    ds_read_b64_tr_b16 v[12:13], v4 offset:30528
    ds_read_b64_tr_b16 v[14:15], v4 offset:30656
    v_mul_f32 v75, s67, v75
    v_mul_f32 v76, s67, v76
    v_mul_f32 v77, s67, v77
    v_mul_f32 v78, s67, v78
    s_waitcnt lgkmcnt(4)
    v_mfma_f32_32x32x16_bf16 v[96:111], v[20:23], v[196:199], v[96:111]
    ds_read_b64_tr_b16 v[16:17], v4 offset:30976
    ds_read_b64_tr_b16 v[18:19], v4 offset:31104
    v_mul_f32 v79, s67, v79
    v_cvt_pk_bf16_f32 v72, v72, v73
    v_mfma_f32_32x32x16_bf16 v[112:127], v[24:27], v[196:199], v[112:127]
    ds_read_b64_tr_b16 v[20:21], v4 offset:31040
    ds_read_b64_tr_b16 v[22:23], v4 offset:31168
    v_cvt_pk_bf16_f32 v73, v74, v75
    v_cvt_pk_bf16_f32 v74, v76, v77
    v_cvt_pk_bf16_f32 v75, v78, v79
    s_add_u32 s71, s70, 393216
    s_waitcnt lgkmcnt(4)
    v_mfma_f32_32x32x16_bf16 v[96:111], v[28:31], v[200:203], v[96:111]
    s_barrier
    ds_read_b64_tr_b16 v[24:25], v4 offset:34816
    ds_read_b64_tr_b16 v[26:27], v4 offset:34944
    v_mfma_f32_32x32x16_bf16 v[112:127], v[12:15], v[200:203], v[112:127]
    ds_read_b64_tr_b16 v[28:29], v4 offset:34880
    ds_read_b64_tr_b16 v[30:31], v4 offset:35008
    buffer_store_dwordx4 v[72:75], v1, s[24:27], s71 offen sc1
    v_mul_f32 v80, s67, v80
    s_waitcnt lgkmcnt(4)
    v_mfma_f32_32x32x16_bf16 v[96:111], v[16:19], v[204:207], v[96:111]
    ds_read_b64_tr_b16 v[12:13], v4 offset:35328
    ds_read_b64_tr_b16 v[14:15], v4 offset:35456
    v_mul_f32 v81, s67, v81
    v_mul_f32 v82, s67, v82
    v_mfma_f32_32x32x16_bf16 v[112:127], v[20:23], v[204:207], v[112:127]
    ds_read_b64_tr_b16 v[16:17], v4 offset:35392
    ds_read_b64_tr_b16 v[18:19], v4 offset:35520
    v_mul_f32 v83, s67, v83
    v_mul_f32 v84, s67, v84
    v_mul_f32 v85, s67, v85
    v_mul_f32 v86, s67, v86
    s_waitcnt lgkmcnt(4)
    v_mfma_f32_32x32x16_bf16 v[96:111], v[24:27], v[208:211], v[96:111]
    ds_read_b64_tr_b16 v[20:21], v4 offset:39168
    ds_read_b64_tr_b16 v[22:23], v4 offset:39296
    v_mul_f32 v87, s67, v87
    v_cvt_pk_bf16_f32 v80, v80, v81
    v_mfma_f32_32x32x16_bf16 v[112:127], v[28:31], v[208:211], v[112:127]
    ds_read_b64_tr_b16 v[24:25], v4 offset:39232
    ds_read_b64_tr_b16 v[26:27], v4 offset:39360
    v_cvt_pk_bf16_f32 v81, v82, v83
    v_cvt_pk_bf16_f32 v82, v84, v85
    v_cvt_pk_bf16_f32 v83, v86, v87
    s_add_u32 s71, s70, 196608
    s_waitcnt lgkmcnt(4)
    v_mfma_f32_32x32x16_bf16 v[96:111], v[12:15], v[212:215], v[96:111]
    ds_read_b64_tr_b16 v[28:29], v4 offset:39680
    ds_read_b64_tr_b16 v[30:31], v4 offset:39808
    buffer_store_dwordx4 v[80:83], v1, s[24:27], s71 offen sc1
    v_mfma_f32_32x32x16_bf16 v[112:127], v[16:19], v[212:215], v[112:127]
    ds_read_b64_tr_b16 v[12:13], v4 offset:39744
    ds_read_b64_tr_b16 v[14:15], v4 offset:39872
    v_mul_f32 v88, s67, v88
    v_mul_f32 v89, s67, v89
    v_mul_f32 v90, s67, v90
    s_waitcnt lgkmcnt(4)
    v_mfma_f32_32x32x16_bf16 v[96:111], v[20:23], v[216:219], v[96:111]
    s_barrier
    ds_read_b64_tr_b16 v[16:17], v4 offset:43520
    ds_read_b64_tr_b16 v[18:19], v4 offset:43648
    v_mfma_f32_32x32x16_bf16 v[112:127], v[24:27], v[216:219], v[112:127]
    ds_read_b64_tr_b16 v[20:21], v4 offset:43584
    ds_read_b64_tr_b16 v[22:23], v4 offset:43712
    v_mul_f32 v91, s67, v91
    v_mul_f32 v92, s67, v92
    v_mul_f32 v93, s67, v93
    v_mul_f32 v94, s67, v94
    s_waitcnt lgkmcnt(4)
    v_mfma_f32_32x32x16_bf16 v[96:111], v[28:31], v[220:223], v[96:111]
    ds_read_b64_tr_b16 v[24:25], v4 offset:44032
    ds_read_b64_tr_b16 v[26:27], v4 offset:44160
    v_mul_f32 v95, s67, v95
    v_cvt_pk_bf16_f32 v88, v88, v89
    v_mfma_f32_32x32x16_bf16 v[112:127], v[12:15], v[220:223], v[112:127]
    ds_read_b64_tr_b16 v[28:29], v4 offset:44096
    ds_read_b64_tr_b16 v[30:31], v4 offset:44224
    v_cvt_pk_bf16_f32 v89, v90, v91
    v_cvt_pk_bf16_f32 v90, v92, v93
    v_cvt_pk_bf16_f32 v91, v94, v95
    s_add_u32 s71, s70, 458752
    s_waitcnt lgkmcnt(4)
    v_mfma_f32_32x32x16_bf16 v[96:111], v[16:19], v[224:227], v[96:111]
    ds_read_b64_tr_b16 v[12:13], v4 offset:47872
    ds_read_b64_tr_b16 v[14:15], v4 offset:48000
    buffer_store_dwordx4 v[88:91], v1, s[24:27], s71 offen sc1
    v_mfma_f32_32x32x16_bf16 v[112:127], v[20:23], v[224:227], v[112:127]
    ds_read_b64_tr_b16 v[16:17], v4 offset:47936
    ds_read_b64_tr_b16 v[18:19], v4 offset:48064
    s_waitcnt lgkmcnt(4)
    v_mfma_f32_32x32x16_bf16 v[96:111], v[24:27], v[228:231], v[96:111]
    ds_read_b64_tr_b16 v[20:21], v4 offset:48384
    ds_read_b64_tr_b16 v[22:23], v4 offset:48512
    v_mfma_f32_32x32x16_bf16 v[112:127], v[28:31], v[228:231], v[112:127]
    ds_read_b64_tr_b16 v[24:25], v4 offset:48448
    ds_read_b64_tr_b16 v[26:27], v4 offset:48576
    s_waitcnt lgkmcnt(4)
    v_mfma_f32_32x32x16_bf16 v[96:111], v[12:15], v[232:235], v[96:111]
    s_barrier
    ds_read_b64_tr_b16 v[28:29], v4 offset:52224
    ds_read_b64_tr_b16 v[30:31], v4 offset:52352
    v_mfma_f32_32x32x16_bf16 v[112:127], v[16:19], v[232:235], v[112:127]
    ds_read_b64_tr_b16 v[12:13], v4 offset:52288
    ds_read_b64_tr_b16 v[14:15], v4 offset:52416
    s_waitcnt lgkmcnt(4)
    v_mfma_f32_32x32x16_bf16 v[96:111], v[20:23], v[236:239], v[96:111]
    ds_read_b64_tr_b16 v[16:17], v4 offset:52736
    ds_read_b64_tr_b16 v[18:19], v4 offset:52864
    v_mfma_f32_32x32x16_bf16 v[112:127], v[24:27], v[236:239], v[112:127]
    ds_read_b64_tr_b16 v[20:21], v4 offset:52800
    ds_read_b64_tr_b16 v[22:23], v4 offset:52928
    s_waitcnt lgkmcnt(4)
    v_mfma_f32_32x32x16_bf16 v[96:111], v[28:31], v[240:243], v[96:111]
    ds_read_b64_tr_b16 v[24:25], v4 offset:56576
    ds_read_b64_tr_b16 v[26:27], v4 offset:56704
    v_mfma_f32_32x32x16_bf16 v[112:127], v[12:15], v[240:243], v[112:127]
    ds_read_b64_tr_b16 v[28:29], v4 offset:56640
    ds_read_b64_tr_b16 v[30:31], v4 offset:56768
    s_waitcnt lgkmcnt(4)
    v_mfma_f32_32x32x16_bf16 v[96:111], v[16:19], v[244:247], v[96:111]
    ds_read_b64_tr_b16 v[12:13], v4 offset:57088
    ds_read_b64_tr_b16 v[14:15], v4 offset:57216
    v_mfma_f32_32x32x16_bf16 v[112:127], v[20:23], v[244:247], v[112:127]
    ds_read_b64_tr_b16 v[16:17], v4 offset:57152
    ds_read_b64_tr_b16 v[18:19], v4 offset:57280
    s_waitcnt lgkmcnt(4)
    v_mfma_f32_32x32x16_bf16 v[96:111], v[24:27], v[248:251], v[96:111]
    s_barrier
    ds_read_b64_tr_b16 v[20:21], v3 offset:0
    ds_read_b64_tr_b16 v[22:23], v3 offset:128
    v_mfma_f32_32x32x16_bf16 v[112:127], v[28:31], v[248:251], v[112:127]
    ds_read_b64_tr_b16 v[24:25], v3 offset:32
    ds_read_b64_tr_b16 v[26:27], v3 offset:160
    s_waitcnt lgkmcnt(4)
    v_mfma_f32_32x32x16_bf16 v[96:111], v[12:15], v[252:255], v[96:111]
    ds_read_b64_tr_b16 v[28:29], v3 offset:512
    ds_read_b64_tr_b16 v[30:31], v3 offset:640
    v_mfma_f32_32x32x16_bf16 v[112:127], v[16:19], v[252:255], v[112:127]
    ds_read_b64_tr_b16 v[12:13], v3 offset:544
    ds_read_b64_tr_b16 v[14:15], v3 offset:672
    s_waitcnt lgkmcnt(4)
    v_mfma_f32_32x32x16_bf16 v[32:47], v[20:23], v[128:131], 0
    s_barrier
    ds_read_b64_tr_b16 v[16:17], v3 offset:8704
    ds_read_b64_tr_b16 v[18:19], v3 offset:8832
    v_mfma_f32_32x32x16_bf16 v[48:63], v[24:27], v[128:131], 0
    ds_read_b64_tr_b16 v[20:21], v3 offset:8736
    ds_read_b64_tr_b16 v[22:23], v3 offset:8864
    s_waitcnt lgkmcnt(4)
    v_mfma_f32_32x32x16_bf16 v[32:47], v[28:31], v[132:135], v[32:47]
    ds_read_b64_tr_b16 v[24:25], v3 offset:9216
    ds_read_b64_tr_b16 v[26:27], v3 offset:9344
    v_mfma_f32_32x32x16_bf16 v[48:63], v[12:15], v[132:135], v[48:63]
    ds_read_b64_tr_b16 v[28:29], v3 offset:9248
    ds_read_b64_tr_b16 v[30:31], v3 offset:9376
    v_cvt_pk_bf16_f32 v96, v96, v97
    v_cvt_pk_bf16_f32 v97, v98, v99
    v_cvt_pk_bf16_f32 v98, v100, v101
    v_cvt_pk_bf16_f32 v99, v102, v103
    s_waitcnt lgkmcnt(4)
    v_mfma_f32_32x32x16_bf16 v[32:47], v[16:19], v[136:139], v[32:47]
    s_barrier
    ds_read_b64_tr_b16 v[12:13], v3 offset:17408
    ds_read_b64_tr_b16 v[14:15], v3 offset:17536
    v_mfma_f32_32x32x16_bf16 v[48:63], v[20:23], v[136:139], v[48:63]
    ds_read_b64_tr_b16 v[16:17], v3 offset:17440
    ds_read_b64_tr_b16 v[18:19], v3 offset:17568
    buffer_store_dwordx4 v[96:99], v2, s[24:27], s63 offen sc1
    v_cvt_pk_bf16_f32 v104, v104, v105
    v_cvt_pk_bf16_f32 v105, v106, v107
    v_cvt_pk_bf16_f32 v106, v108, v109
    s_waitcnt lgkmcnt(4)
    v_mfma_f32_32x32x16_bf16 v[32:47], v[24:27], v[140:143], v[32:47]
    ds_read_b64_tr_b16 v[20:21], v3 offset:17920
    ds_read_b64_tr_b16 v[22:23], v3 offset:18048
    v_cvt_pk_bf16_f32 v107, v110, v111
    buffer_store_dwordx4 v[104:107], v2, s[24:27], s64 offen sc1
    v_cvt_pk_bf16_f32 v112, v112, v113
    v_mfma_f32_32x32x16_bf16 v[48:63], v[28:31], v[140:143], v[48:63]
    ds_read_b64_tr_b16 v[24:25], v3 offset:17952
    ds_read_b64_tr_b16 v[26:27], v3 offset:18080
    v_mov_b32 v4, v3
    v_cvt_pk_bf16_f32 v113, v114, v115
    v_cvt_pk_bf16_f32 v114, v116, v117
    v_cvt_pk_bf16_f32 v115, v118, v119
    s_waitcnt lgkmcnt(4)
    v_mfma_f32_32x32x16_bf16 v[32:47], v[12:15], v[144:147], v[32:47]
    ds_read_b64_tr_b16 v[28:29], v4 offset:64
    ds_read_b64_tr_b16 v[30:31], v4 offset:192
    buffer_store_dwordx4 v[112:115], v2, s[24:27], s65 offen sc1
    v_cvt_pk_bf16_f32 v120, v120, v121
    v_cvt_pk_bf16_f32 v121, v122, v123
    v_mfma_f32_32x32x16_bf16 v[48:63], v[16:19], v[144:147], v[48:63]
    ds_read_b64_tr_b16 v[12:13], v4 offset:96
    ds_read_b64_tr_b16 v[14:15], v4 offset:224
    v_cvt_pk_bf16_f32 v122, v124, v125
    v_cvt_pk_bf16_f32 v123, v126, v127
    buffer_store_dwordx4 v[120:123], v2, s[24:27], s66 offen sc1
    s_waitcnt lgkmcnt(4)
    v_mfma_f32_32x32x16_bf16 v[32:47], v[20:23], v[148:151], v[32:47]
    s_barrier
    ds_read_b64_tr_b16 v[16:17], v3 offset:26112
    ds_read_b64_tr_b16 v[18:19], v3 offset:26240
    v_mfma_f32_32x32x16_bf16 v[48:63], v[24:27], v[148:151], v[48:63]
    ds_read_b64_tr_b16 v[20:21], v3 offset:26144
    ds_read_b64_tr_b16 v[22:23], v3 offset:26272
    s_waitcnt lgkmcnt(4)
    v_mfma_f32_32x32x16_bf16 v[96:111], v[28:31], v[128:131], 0
    ds_read_b64_tr_b16 v[24:25], v4 offset:576
    ds_read_b64_tr_b16 v[26:27], v4 offset:704
    v_mfma_f32_32x32x16_bf16 v[112:127], v[12:15], v[128:131], 0
    ds_read_b64_tr_b16 v[28:29], v4 offset:608
    ds_read_b64_tr_b16 v[30:31], v4 offset:736
    s_waitcnt lgkmcnt(4)
    v_mfma_f32_32x32x16_bf16 v[32:47], v[16:19], v[152:155], v[32:47]
    ds_read_b64_tr_b16 v[12:13], v3 offset:26624
    ds_read_b64_tr_b16 v[14:15], v3 offset:26752
    v_mfma_f32_32x32x16_bf16 v[48:63], v[20:23], v[152:155], v[48:63]
    ds_read_b64_tr_b16 v[16:17], v3 offset:26656
    ds_read_b64_tr_b16 v[18:19], v3 offset:26784
    s_waitcnt lgkmcnt(4)
    v_mfma_f32_32x32x16_bf16 v[96:111], v[24:27], v[132:135], v[96:111]
    ds_read_b64_tr_b16 v[20:21], v4 offset:8768
    ds_read_b64_tr_b16 v[22:23], v4 offset:8896
    v_mfma_f32_32x32x16_bf16 v[112:127], v[28:31], v[132:135], v[112:127]
    ds_read_b64_tr_b16 v[24:25], v4 offset:8800
    ds_read_b64_tr_b16 v[26:27], v4 offset:8928
    s_waitcnt lgkmcnt(4)
    v_mfma_f32_32x32x16_bf16 v[32:47], v[12:15], v[156:159], v[32:47]
    s_barrier
    ds_read_b64_tr_b16 v[28:29], v3 offset:34816
    ds_read_b64_tr_b16 v[30:31], v3 offset:34944
    v_mfma_f32_32x32x16_bf16 v[48:63], v[16:19], v[156:159], v[48:63]
    ds_read_b64_tr_b16 v[12:13], v3 offset:34848
    ds_read_b64_tr_b16 v[14:15], v3 offset:34976
    s_waitcnt lgkmcnt(4)
    v_mfma_f32_32x32x16_bf16 v[96:111], v[20:23], v[136:139], v[96:111]
    ds_read_b64_tr_b16 v[16:17], v4 offset:9280
    ds_read_b64_tr_b16 v[18:19], v4 offset:9408
    v_mfma_f32_32x32x16_bf16 v[112:127], v[24:27], v[136:139], v[112:127]
    ds_read_b64_tr_b16 v[20:21], v4 offset:9312
    ds_read_b64_tr_b16 v[22:23], v4 offset:9440
    s_waitcnt lgkmcnt(4)
    v_mfma_f32_32x32x16_bf16 v[32:47], v[28:31], v[160:163], v[32:47]
    ds_read_b64_tr_b16 v[24:25], v3 offset:35328
    ds_read_b64_tr_b16 v[26:27], v3 offset:35456
    v_mfma_f32_32x32x16_bf16 v[48:63], v[12:15], v[160:163], v[48:63]
    ds_read_b64_tr_b16 v[28:29], v3 offset:35360
    ds_read_b64_tr_b16 v[30:31], v3 offset:35488
    s_waitcnt lgkmcnt(4)
    v_mfma_f32_32x32x16_bf16 v[96:111], v[16:19], v[140:143], v[96:111]
    ds_read_b64_tr_b16 v[12:13], v4 offset:17472
    ds_read_b64_tr_b16 v[14:15], v4 offset:17600
    v_mfma_f32_32x32x16_bf16 v[112:127], v[20:23], v[140:143], v[112:127]
    ds_read_b64_tr_b16 v[16:17], v4 offset:17504
    ds_read_b64_tr_b16 v[18:19], v4 offset:17632
    s_waitcnt lgkmcnt(4)
    v_mfma_f32_32x32x16_bf16 v[32:47], v[24:27], v[164:167], v[32:47]
    s_barrier
    ds_read_b64_tr_b16 v[20:21], v3 offset:43520
    ds_read_b64_tr_b16 v[22:23], v3 offset:43648
    v_mfma_f32_32x32x16_bf16 v[48:63], v[28:31], v[164:167], v[48:63]
    ds_read_b64_tr_b16 v[24:25], v3 offset:43552
    ds_read_b64_tr_b16 v[26:27], v3 offset:43680
    s_waitcnt lgkmcnt(4)
    v_mfma_f32_32x32x16_bf16 v[96:111], v[12:15], v[144:147], v[96:111]
    ds_read_b64_tr_b16 v[28:29], v4 offset:17984
    ds_read_b64_tr_b16 v[30:31], v4 offset:18112
    v_mfma_f32_32x32x16_bf16 v[112:127], v[16:19], v[144:147], v[112:127]
    ds_read_b64_tr_b16 v[12:13], v4 offset:18016
    ds_read_b64_tr_b16 v[14:15], v4 offset:18144
    s_waitcnt lgkmcnt(4)
    v_mfma_f32_32x32x16_bf16 v[32:47], v[20:23], v[168:171], v[32:47]
    ds_read_b64_tr_b16 v[16:17], v3 offset:44032
    ds_read_b64_tr_b16 v[18:19], v3 offset:44160
    v_mfma_f32_32x32x16_bf16 v[48:63], v[24:27], v[168:171], v[48:63]
    ds_read_b64_tr_b16 v[20:21], v3 offset:44064
    ds_read_b64_tr_b16 v[22:23], v3 offset:44192
    s_waitcnt lgkmcnt(4)
    v_mfma_f32_32x32x16_bf16 v[96:111], v[28:31], v[148:151], v[96:111]
    ds_read_b64_tr_b16 v[24:25], v4 offset:26176
    ds_read_b64_tr_b16 v[26:27], v4 offset:26304
    v_mfma_f32_32x32x16_bf16 v[112:127], v[12:15], v[148:151], v[112:127]
    ds_read_b64_tr_b16 v[28:29], v4 offset:26208
    ds_read_b64_tr_b16 v[30:31], v4 offset:26336
    s_waitcnt lgkmcnt(4)
    v_mfma_f32_32x32x16_bf16 v[32:47], v[16:19], v[172:175], v[32:47]
    s_barrier
    ds_read_b64_tr_b16 v[12:13], v3 offset:52224
    ds_read_b64_tr_b16 v[14:15], v3 offset:52352
    v_mfma_f32_32x32x16_bf16 v[48:63], v[20:23], v[172:175], v[48:63]
    ds_read_b64_tr_b16 v[16:17], v3 offset:52256
    ds_read_b64_tr_b16 v[18:19], v3 offset:52384
    s_waitcnt lgkmcnt(4)
    v_mfma_f32_32x32x16_bf16 v[96:111], v[24:27], v[152:155], v[96:111]
    ds_read_b64_tr_b16 v[20:21], v4 offset:26688
    ds_read_b64_tr_b16 v[22:23], v4 offset:26816
    v_mfma_f32_32x32x16_bf16 v[112:127], v[28:31], v[152:155], v[112:127]
    ds_read_b64_tr_b16 v[24:25], v4 offset:26720
    ds_read_b64_tr_b16 v[26:27], v4 offset:26848
    s_waitcnt lgkmcnt(4)
    v_mfma_f32_32x32x16_bf16 v[32:47], v[12:15], v[176:179], v[32:47]
    ds_read_b64_tr_b16 v[28:29], v3 offset:52736
    ds_read_b64_tr_b16 v[30:31], v3 offset:52864
    v_mfma_f32_32x32x16_bf16 v[48:63], v[16:19], v[176:179], v[48:63]
    ds_read_b64_tr_b16 v[12:13], v3 offset:52768
    ds_read_b64_tr_b16 v[14:15], v3 offset:52896
    s_waitcnt lgkmcnt(4)
    v_mfma_f32_32x32x16_bf16 v[96:111], v[20:23], v[156:159], v[96:111]
    ds_read_b64_tr_b16 v[16:17], v4 offset:34880
    ds_read_b64_tr_b16 v[18:19], v4 offset:35008
    v_mfma_f32_32x32x16_bf16 v[112:127], v[24:27], v[156:159], v[112:127]
    ds_read_b64_tr_b16 v[20:21], v4 offset:34912
    ds_read_b64_tr_b16 v[22:23], v4 offset:35040
    v_subrev_u32 v3, 60928, v3
    s_waitcnt lgkmcnt(4)
    v_mfma_f32_32x32x16_bf16 v[32:47], v[28:31], v[180:183], v[32:47]
    s_barrier
    ds_read_b64_tr_b16 v[24:25], v3 offset:0
    ds_read_b64_tr_b16 v[26:27], v3 offset:128
    v_mfma_f32_32x32x16_bf16 v[48:63], v[12:15], v[180:183], v[48:63]
    ds_read_b64_tr_b16 v[28:29], v3 offset:32
    ds_read_b64_tr_b16 v[30:31], v3 offset:160
    s_waitcnt lgkmcnt(4)
    v_mfma_f32_32x32x16_bf16 v[96:111], v[16:19], v[160:163], v[96:111]
    ds_read_b64_tr_b16 v[12:13], v4 offset:35392
    ds_read_b64_tr_b16 v[14:15], v4 offset:35520
    v_mov_b32 v7, 1
    s_waitcnt vmcnt(0)
    buffer_store_dword v7, v1, s[32:35], 0 offen sc1
    v_mfma_f32_32x32x16_bf16 v[112:127], v[20:23], v[160:163], v[112:127]
    ds_read_b64_tr_b16 v[16:17], v4 offset:35424
    ds_read_b64_tr_b16 v[18:19], v4 offset:35552
    s_waitcnt lgkmcnt(4)
    v_mfma_f32_32x32x16_bf16 v[32:47], v[24:27], v[184:187], v[32:47]
    ds_read_b64_tr_b16 v[20:21], v3 offset:512
    ds_read_b64_tr_b16 v[22:23], v3 offset:640
    v_mfma_f32_32x32x16_bf16 v[48:63], v[28:31], v[184:187], v[48:63]
    ds_read_b64_tr_b16 v[24:25], v3 offset:544
    ds_read_b64_tr_b16 v[26:27], v3 offset:672
    s_waitcnt lgkmcnt(4)
    v_mfma_f32_32x32x16_bf16 v[96:111], v[12:15], v[164:167], v[96:111]
    ds_read_b64_tr_b16 v[28:29], v4 offset:43584
    ds_read_b64_tr_b16 v[30:31], v4 offset:43712
    v_mfma_f32_32x32x16_bf16 v[112:127], v[16:19], v[164:167], v[112:127]
    ds_read_b64_tr_b16 v[12:13], v4 offset:43616
    ds_read_b64_tr_b16 v[14:15], v4 offset:43744
    s_waitcnt lgkmcnt(4)
    v_mfma_f32_32x32x16_bf16 v[32:47], v[20:23], v[188:191], v[32:47]
    s_barrier
    ds_read_b64_tr_b16 v[16:17], v3 offset:8704
    ds_read_b64_tr_b16 v[18:19], v3 offset:8832
    v_mfma_f32_32x32x16_bf16 v[48:63], v[24:27], v[188:191], v[48:63]
    ds_read_b64_tr_b16 v[20:21], v3 offset:8736
    ds_read_b64_tr_b16 v[22:23], v3 offset:8864
    s_waitcnt lgkmcnt(4)
    v_mfma_f32_32x32x16_bf16 v[96:111], v[28:31], v[168:171], v[96:111]
    ds_read_b64_tr_b16 v[24:25], v4 offset:44096
    ds_read_b64_tr_b16 v[26:27], v4 offset:44224
    v_mfma_f32_32x32x16_bf16 v[112:127], v[12:15], v[168:171], v[112:127]
    ds_read_b64_tr_b16 v[28:29], v4 offset:44128
    ds_read_b64_tr_b16 v[30:31], v4 offset:44256
    s_waitcnt lgkmcnt(4)
    v_mfma_f32_32x32x16_bf16 v[32:47], v[16:19], v[192:195], v[32:47]
    ds_read_b64_tr_b16 v[12:13], v3 offset:9216
    ds_read_b64_tr_b16 v[14:15], v3 offset:9344
    v_mfma_f32_32x32x16_bf16 v[48:63], v[20:23], v[192:195], v[48:63]
    ds_read_b64_tr_b16 v[16:17], v3 offset:9248
    ds_read_b64_tr_b16 v[18:19], v3 offset:9376
    s_waitcnt lgkmcnt(4)
    v_mfma_f32_32x32x16_bf16 v[96:111], v[24:27], v[172:175], v[96:111]
    ds_read_b64_tr_b16 v[20:21], v4 offset:52288
    ds_read_b64_tr_b16 v[22:23], v4 offset:52416
    v_mfma_f32_32x32x16_bf16 v[112:127], v[28:31], v[172:175], v[112:127]
    ds_read_b64_tr_b16 v[24:25], v4 offset:52320
    ds_read_b64_tr_b16 v[26:27], v4 offset:52448
    s_waitcnt lgkmcnt(4)
    v_mfma_f32_32x32x16_bf16 v[32:47], v[12:15], v[196:199], v[32:47]
    s_barrier
    ds_read_b64_tr_b16 v[28:29], v3 offset:17408
    ds_read_b64_tr_b16 v[30:31], v3 offset:17536
    v_mfma_f32_32x32x16_bf16 v[48:63], v[16:19], v[196:199], v[48:63]
    ds_read_b64_tr_b16 v[12:13], v3 offset:17440
    ds_read_b64_tr_b16 v[14:15], v3 offset:17568
    s_waitcnt lgkmcnt(4)
    v_mfma_f32_32x32x16_bf16 v[96:111], v[20:23], v[176:179], v[96:111]
    ds_read_b64_tr_b16 v[16:17], v4 offset:52800
    ds_read_b64_tr_b16 v[18:19], v4 offset:52928
    v_mfma_f32_32x32x16_bf16 v[112:127], v[24:27], v[176:179], v[112:127]
    ds_read_b64_tr_b16 v[20:21], v4 offset:52832
    ds_read_b64_tr_b16 v[22:23], v4 offset:52960
    s_waitcnt lgkmcnt(4)
    v_mfma_f32_32x32x16_bf16 v[32:47], v[28:31], v[200:203], v[32:47]
    ds_read_b64_tr_b16 v[24:25], v3 offset:17920
    ds_read_b64_tr_b16 v[26:27], v3 offset:18048
    v_mfma_f32_32x32x16_bf16 v[48:63], v[12:15], v[200:203], v[48:63]
    ds_read_b64_tr_b16 v[28:29], v3 offset:17952
    ds_read_b64_tr_b16 v[30:31], v3 offset:18080
    v_subrev_u32 v4, 60928, v4
    s_waitcnt lgkmcnt(4)
    v_mfma_f32_32x32x16_bf16 v[96:111], v[16:19], v[180:183], v[96:111]
    ds_read_b64_tr_b16 v[12:13], v4 offset:64
    ds_read_b64_tr_b16 v[14:15], v4 offset:192
    v_mfma_f32_32x32x16_bf16 v[112:127], v[20:23], v[180:183], v[112:127]
    ds_read_b64_tr_b16 v[16:17], v4 offset:96
    ds_read_b64_tr_b16 v[18:19], v4 offset:224
    s_waitcnt lgkmcnt(4)
    v_mfma_f32_32x32x16_bf16 v[32:47], v[24:27], v[204:207], v[32:47]
    s_barrier
    ds_read_b64_tr_b16 v[20:21], v3 offset:26112
    ds_read_b64_tr_b16 v[22:23], v3 offset:26240
    v_mfma_f32_32x32x16_bf16 v[48:63], v[28:31], v[204:207], v[48:63]
    ds_read_b64_tr_b16 v[24:25], v3 offset:26144
    ds_read_b64_tr_b16 v[26:27], v3 offset:26272
    s_waitcnt lgkmcnt(4)
    v_mfma_f32_32x32x16_bf16 v[96:111], v[12:15], v[184:187], v[96:111]
    ds_read_b64_tr_b16 v[28:29], v4 offset:576
    ds_read_b64_tr_b16 v[30:31], v4 offset:704
    v_mfma_f32_32x32x16_bf16 v[112:127], v[16:19], v[184:187], v[112:127]
    ds_read_b64_tr_b16 v[12:13], v4 offset:608
    ds_read_b64_tr_b16 v[14:15], v4 offset:736
    s_waitcnt lgkmcnt(4)
    v_mfma_f32_32x32x16_bf16 v[32:47], v[20:23], v[208:211], v[32:47]
    ds_read_b64_tr_b16 v[16:17], v3 offset:26624
    ds_read_b64_tr_b16 v[18:19], v3 offset:26752
    v_mfma_f32_32x32x16_bf16 v[48:63], v[24:27], v[208:211], v[48:63]
    ds_read_b64_tr_b16 v[20:21], v3 offset:26656
    ds_read_b64_tr_b16 v[22:23], v3 offset:26784
    s_waitcnt lgkmcnt(4)
    v_mfma_f32_32x32x16_bf16 v[96:111], v[28:31], v[188:191], v[96:111]
    ds_read_b64_tr_b16 v[24:25], v4 offset:8768
    ds_read_b64_tr_b16 v[26:27], v4 offset:8896
    v_mfma_f32_32x32x16_bf16 v[112:127], v[12:15], v[188:191], v[112:127]
    ds_read_b64_tr_b16 v[28:29], v4 offset:8800
    ds_read_b64_tr_b16 v[30:31], v4 offset:8928
    s_waitcnt lgkmcnt(4)
    v_mfma_f32_32x32x16_bf16 v[32:47], v[16:19], v[212:215], v[32:47]
    s_barrier
    ds_read_b64_tr_b16 v[12:13], v3 offset:34816
    ds_read_b64_tr_b16 v[14:15], v3 offset:34944
    v_mfma_f32_32x32x16_bf16 v[48:63], v[20:23], v[212:215], v[48:63]
    ds_read_b64_tr_b16 v[16:17], v3 offset:34848
    ds_read_b64_tr_b16 v[18:19], v3 offset:34976
    v_mov_b32 v128, 0
    v_mov_b32 v129, 0
    v_mov_b32 v130, 0
    s_waitcnt lgkmcnt(4)
    v_mfma_f32_32x32x16_bf16 v[96:111], v[24:27], v[192:195], v[96:111]
    ds_read_b64_tr_b16 v[20:21], v4 offset:9280
    ds_read_b64_tr_b16 v[22:23], v4 offset:9408
    v_mov_b32 v131, 0
    v_mov_b32 v132, 0
    v_mov_b32 v133, 0
    v_mfma_f32_32x32x16_bf16 v[112:127], v[28:31], v[192:195], v[112:127]
    ds_read_b64_tr_b16 v[24:25], v4 offset:9312
    ds_read_b64_tr_b16 v[26:27], v4 offset:9440
    v_mov_b32 v134, 0
    v_mov_b32 v135, 0
    v_mov_b32 v136, 0
    s_waitcnt lgkmcnt(4)
    v_mfma_f32_32x32x16_bf16 v[32:47], v[12:15], v[216:219], v[32:47]
    ds_read_b64_tr_b16 v[28:29], v3 offset:35328
    ds_read_b64_tr_b16 v[30:31], v3 offset:35456
    v_mov_b32 v137, 0
    v_mov_b32 v138, 0
    v_mov_b32 v139, 0
    v_mfma_f32_32x32x16_bf16 v[48:63], v[16:19], v[216:219], v[48:63]
    ds_read_b64_tr_b16 v[12:13], v3 offset:35360
    ds_read_b64_tr_b16 v[14:15], v3 offset:35488
    v_mov_b32 v140, 0
    v_mov_b32 v141, 0
    v_mov_b32 v142, 0
    v_mov_b32 v143, 0
    s_waitcnt lgkmcnt(4)
    v_mfma_f32_32x32x16_bf16 v[96:111], v[20:23], v[196:199], v[96:111]
    ds_read_b64_tr_b16 v[16:17], v4 offset:17472
    ds_read_b64_tr_b16 v[18:19], v4 offset:17600
    v_mov_b32 v144, 0
    v_mov_b32 v145, 0
    v_mfma_f32_32x32x16_bf16 v[112:127], v[24:27], v[196:199], v[112:127]
    ds_read_b64_tr_b16 v[20:21], v4 offset:17504
    ds_read_b64_tr_b16 v[22:23], v4 offset:17632
    v_mov_b32 v146, 0
    v_mov_b32 v147, 0
    v_mov_b32 v148, 0
    v_mov_b32 v149, 0
    s_waitcnt lgkmcnt(4)
    v_mfma_f32_32x32x16_bf16 v[32:47], v[28:31], v[220:223], v[32:47]
    s_barrier
    ds_read_b64_tr_b16 v[24:25], v3 offset:43520
    ds_read_b64_tr_b16 v[26:27], v3 offset:43648
    v_mfma_f32_32x32x16_bf16 v[48:63], v[12:15], v[220:223], v[48:63]
    ds_read_b64_tr_b16 v[28:29], v3 offset:43552
    ds_read_b64_tr_b16 v[30:31], v3 offset:43680
    v_mov_b32 v150, 0
    v_mov_b32 v151, 0
    v_mov_b32 v152, 0
    s_waitcnt lgkmcnt(4)
    v_mfma_f32_32x32x16_bf16 v[96:111], v[16:19], v[200:203], v[96:111]
    ds_read_b64_tr_b16 v[12:13], v4 offset:17984
    ds_read_b64_tr_b16 v[14:15], v4 offset:18112
    v_mov_b32 v153, 0
    v_mov_b32 v154, 0
    v_mov_b32 v155, 0
    v_mfma_f32_32x32x16_bf16 v[112:127], v[20:23], v[200:203], v[112:127]
    ds_read_b64_tr_b16 v[16:17], v4 offset:18016
    ds_read_b64_tr_b16 v[18:19], v4 offset:18144
    v_mov_b32 v156, 0
    v_mov_b32 v157, 0
    v_mov_b32 v158, 0
    v_mov_b32 v159, 0
    s_waitcnt lgkmcnt(4)
    v_mfma_f32_32x32x16_bf16 v[32:47], v[24:27], v[224:227], v[32:47]
    ds_read_b64_tr_b16 v[20:21], v3 offset:44032
    ds_read_b64_tr_b16 v[22:23], v3 offset:44160
    v_mov_b32 v168, 0
    v_mov_b32 v169, 0
    v_mfma_f32_32x32x16_bf16 v[48:63], v[28:31], v[224:227], v[48:63]
    ds_read_b64_tr_b16 v[24:25], v3 offset:44064
    ds_read_b64_tr_b16 v[26:27], v3 offset:44192
    v_mov_b32 v170, 0
    v_mov_b32 v171, 0
    v_mov_b32 v172, 0
    v_mov_b32 v173, 0
    s_waitcnt lgkmcnt(4)
    v_mfma_f32_32x32x16_bf16 v[96:111], v[12:15], v[204:207], v[96:111]
    ds_read_b64_tr_b16 v[28:29], v4 offset:26176
    ds_read_b64_tr_b16 v[30:31], v4 offset:26304
    v_mov_b32 v174, 0
    v_mov_b32 v175, 0
    v_mfma_f32_32x32x16_bf16 v[112:127], v[16:19], v[204:207], v[112:127]
    ds_read_b64_tr_b16 v[12:13], v4 offset:26208
    ds_read_b64_tr_b16 v[14:15], v4 offset:26336
    v_and_b32 v7, 51, v0
    v_and_b32 v10, 4, v0
    v_lshl_add_u32 v7, v10, 1, v7
    v_and_b32 v10, 8, v0
    s_waitcnt lgkmcnt(4)
    v_mfma_f32_32x32x16_bf16 v[32:47], v[20:23], v[228:231], v[32:47]
    s_barrier
    ds_read_b64_tr_b16 v[16:17], v3 offset:52224
    ds_read_b64_tr_b16 v[18:19], v3 offset:52352
    v_mfma_f32_32x32x16_bf16 v[48:63], v[24:27], v[228:231], v[48:63]
    ds_read_b64_tr_b16 v[20:21], v3 offset:52256
    ds_read_b64_tr_b16 v[22:23], v3 offset:52384
    v_lshrrev_b32 v10, 1, v10
    v_add_lshl_u32 v7, v7, v10, 4
    v_lshrrev_b32 v10, 5, v0
    v_lshlrev_b32 v10, 8, v10
    s_waitcnt lgkmcnt(4)
    v_mfma_f32_32x32x16_bf16 v[96:111], v[28:31], v[208:211], v[96:111]
    ds_read_b64_tr_b16 v[24:25], v4 offset:26688
    ds_read_b64_tr_b16 v[26:27], v4 offset:26816
    v_and_b32 v8, 15, v0
    v_lshl_add_u32 v10, v8, 4, v10
    v_mfma_f32_32x32x16_bf16 v[112:127], v[12:15], v[208:211], v[112:127]
    ds_read_b64_tr_b16 v[28:29], v4 offset:26720
    ds_read_b64_tr_b16 v[30:31], v4 offset:26848
    v_add_u32 v8, 1024, v10
    v_add_u32 v9, 1536, v10
    v_and_b32 v10, 27, v0
    v_cmp_eq_u32 vcc, 16, v10
    s_waitcnt lgkmcnt(4)
    v_mfma_f32_32x32x16_bf16 v[32:47], v[16:19], v[232:235], v[32:47]
    ds_read_b64_tr_b16 v[12:13], v3 offset:52736
    ds_read_b64_tr_b16 v[14:15], v3 offset:52864
    v_mov_b32 v10, 2064
    v_mov_b32 v11, 2048
    v_mfma_f32_32x32x16_bf16 v[48:63], v[20:23], v[232:235], v[48:63]
    ds_read_b64_tr_b16 v[16:17], v3 offset:52768
    ds_read_b64_tr_b16 v[18:19], v3 offset:52896
    v_cndmask_b32 v10, v10, v11, vcc
    v_and_b32 v11, 16, v0
    v_cmp_eq_u32 vcc, 0, v11
    s_nop 0
    s_waitcnt lgkmcnt(4)
    v_mfma_f32_32x32x16_bf16 v[96:111], v[24:27], v[212:215], v[96:111]
    ds_read_b64_tr_b16 v[20:21], v4 offset:34880
    ds_read_b64_tr_b16 v[22:23], v4 offset:35008
    s_nop 0
    v_cndmask_b32 v8, v10, v8, vcc
    v_cndmask_b32 v9, v10, v9, vcc
    v_mfma_f32_32x32x16_bf16 v[112:127], v[28:31], v[212:215], v[112:127]
    ds_read_b64_tr_b16 v[24:25], v4 offset:34912
    ds_read_b64_tr_b16 v[26:27], v4 offset:35040
    v_add_u32 v3, 60928, v3
    s_lshl_b32 s57, s58, 4
    s_add_u32 s57, s57, s51
    s_waitcnt lgkmcnt(4)
    v_mfma_f32_32x32x16_bf16 v[32:47], v[12:15], v[236:239], v[32:47]
    ds_read_b64_tr_b16 v[28:29], v3 offset:0
    ds_read_b64_tr_b16 v[30:31], v3 offset:128
    s_lshl_b32 s57, s57, 7
    s_add_u32 s57, s57, 16908288
    s_add_u32 s32, s22, s57
    s_addc_u32 s33, s23, 0
    v_mfma_f32_32x32x16_bf16 v[48:63], v[16:19], v[236:239], v[48:63]
    ds_read_b64_tr_b16 v[12:13], v3 offset:32
    ds_read_b64_tr_b16 v[14:15], v3 offset:160
    s_lshl_b32 s70, s54, 6
    s_lshl_b32 s57, s55, 3
    s_add_u32 s70, s70, s57
    s_waitcnt lgkmcnt(4)
    v_mfma_f32_32x32x16_bf16 v[96:111], v[20:23], v[216:219], v[96:111]
    ds_read_b64_tr_b16 v[16:17], v4 offset:35392
    ds_read_b64_tr_b16 v[18:19], v4 offset:35520
    s_lshl_b32 s57, s56, 1
    s_add_u32 s70, s70, s57
    s_lshl_b32 s70, s70, 10
    v_mfma_f32_32x32x16_bf16 v[112:127], v[24:27], v[216:219], v[112:127]
    ds_read_b64_tr_b16 v[20:21], v4 offset:35424
    ds_read_b64_tr_b16 v[22:23], v4 offset:35552
    s_add_u32 s70, s70, 4194304
    s_lshl_b32 s57, s55, 2
    s_add_u32 s57, s57, s56
    s_lshl_b32 s10, s57, 6
    s_waitcnt lgkmcnt(4)
    v_mfma_f32_32x32x16_bf16 v[32:47], v[28:31], v[240:243], v[32:47]
    ds_read_b64_tr_b16 v[24:25], v3 offset:512
    ds_read_b64_tr_b16 v[26:27], v3 offset:640
    s_add_u32 s10, s10, s54
    s_lshl_b32 s10, s10, 10
    v_mfma_f32_32x32x16_bf16 v[48:63], v[12:15], v[240:243], v[48:63]
    ds_read_b64_tr_b16 v[28:29], v3 offset:544
    ds_read_b64_tr_b16 v[30:31], v3 offset:672
    s_add_u32 s10, s10, 6291456
    s_add_u32 s11, s10, 32768
    s_lshl_b32 s57, s57, 5
    s_add_u32 s57, s57, s54
    s_waitcnt lgkmcnt(4)
    v_mfma_f32_32x32x16_bf16 v[96:111], v[16:19], v[220:223], v[96:111]
    ds_read_b64_tr_b16 v[12:13], v4 offset:43584
    ds_read_b64_tr_b16 v[14:15], v4 offset:43712
    s_lshl_b32 s57, s57, 7
    s_add_u32 s57, s57, 17039360
    v_mfma_f32_32x32x16_bf16 v[112:127], v[20:23], v[220:223], v[112:127]
    ds_read_b64_tr_b16 v[16:17], v4 offset:43616
    ds_read_b64_tr_b16 v[18:19], v4 offset:43744
    s_add_u32 s36, s22, s57
    s_addc_u32 s37, s23, 0
    s_mov_b32 s38, 4
    s_mov_b32 s39, 0x00020000
    s_mov_b32 s63, 0x7e800000
    s_waitcnt lgkmcnt(4)
    v_mfma_f32_32x32x16_bf16 v[32:47], v[24:27], v[244:247], v[32:47]
    ds_read_b64_tr_b16 v[20:21], v3 offset:8704
    ds_read_b64_tr_b16 v[22:23], v3 offset:8832
    s_mov_b32 s64, 0xd800000
    v_mfma_f32_32x32x16_bf16 v[48:63], v[28:31], v[244:247], v[48:63]
    ds_read_b64_tr_b16 v[24:25], v3 offset:8736
    ds_read_b64_tr_b16 v[26:27], v3 offset:8864
    s_waitcnt lgkmcnt(4)
    v_mfma_f32_32x32x16_bf16 v[96:111], v[12:15], v[224:227], v[96:111]
    ds_read_b64_tr_b16 v[28:29], v4 offset:44096
    ds_read_b64_tr_b16 v[30:31], v4 offset:44224
    v_mfma_f32_32x32x16_bf16 v[112:127], v[16:19], v[224:227], v[112:127]
    ds_read_b64_tr_b16 v[12:13], v4 offset:44128
    ds_read_b64_tr_b16 v[14:15], v4 offset:44256
    s_waitcnt lgkmcnt(4)
    v_mfma_f32_32x32x16_bf16 v[32:47], v[20:23], v[248:251], v[32:47]
    ds_read_b64_tr_b16 v[16:17], v3 offset:9216
    ds_read_b64_tr_b16 v[18:19], v3 offset:9344
    v_mfma_f32_32x32x16_bf16 v[48:63], v[24:27], v[248:251], v[48:63]
    ds_read_b64_tr_b16 v[20:21], v3 offset:9248
    ds_read_b64_tr_b16 v[22:23], v3 offset:9376
    s_waitcnt lgkmcnt(4)
    v_mfma_f32_32x32x16_bf16 v[96:111], v[28:31], v[228:231], v[96:111]
    ds_read_b64_tr_b16 v[24:25], v4 offset:52288
    ds_read_b64_tr_b16 v[26:27], v4 offset:52416
    v_mfma_f32_32x32x16_bf16 v[112:127], v[12:15], v[228:231], v[112:127]
    ds_read_b64_tr_b16 v[28:29], v4 offset:52320
    ds_read_b64_tr_b16 v[30:31], v4 offset:52448
    s_waitcnt lgkmcnt(4)
    v_mfma_f32_32x32x16_bf16 v[32:47], v[16:19], v[252:255], v[32:47]
    ds_read_b64_tr_b16 v[12:13], v4 offset:52800
    ds_read_b64_tr_b16 v[14:15], v4 offset:52928
    v_mfma_f32_32x32x16_bf16 v[48:63], v[20:23], v[252:255], v[48:63]
    ds_read_b64_tr_b16 v[16:17], v4 offset:52832
    ds_read_b64_tr_b16 v[18:19], v4 offset:52960
    v_add_u32 v4, 60928, v4
    s_waitcnt lgkmcnt(4)
    v_mfma_f32_32x32x16_bf16 v[96:111], v[24:27], v[232:235], v[96:111]
    ds_read_b64_tr_b16 v[20:21], v4 offset:64
    ds_read_b64_tr_b16 v[22:23], v4 offset:192
    v_mfma_f32_32x32x16_bf16 v[112:127], v[28:31], v[232:235], v[112:127]
    ds_read_b64_tr_b16 v[24:25], v4 offset:96
    ds_read_b64_tr_b16 v[26:27], v4 offset:224
    s_waitcnt lgkmcnt(4)
    v_mfma_f32_32x32x16_bf16 v[96:111], v[12:15], v[236:239], v[96:111]
    ds_read_b64_tr_b16 v[28:29], v4 offset:576
    ds_read_b64_tr_b16 v[30:31], v4 offset:704
    v_mfma_f32_32x32x16_bf16 v[112:127], v[16:19], v[236:239], v[112:127]
    ds_read_b64_tr_b16 v[12:13], v4 offset:608
    ds_read_b64_tr_b16 v[14:15], v4 offset:736
    v_mul_f32 v40, v32, v40
    v_mul_f32 v41, v33, v41
    v_exp_f32 v32, -v32
    s_waitcnt lgkmcnt(4)
    v_mfma_f32_32x32x16_bf16 v[96:111], v[20:23], v[240:243], v[96:111]
    ds_read_b64_tr_b16 v[16:17], v4 offset:8768
    ds_read_b64_tr_b16 v[18:19], v4 offset:8896
    v_exp_f32 v33, -v33
    v_add_f32 v32, 1.0, v32
    v_add_f32 v33, 1.0, v33
    v_mfma_f32_32x32x16_bf16 v[112:127], v[24:27], v[240:243], v[112:127]
    ds_read_b64_tr_b16 v[20:21], v4 offset:8800
    ds_read_b64_tr_b16 v[22:23], v4 offset:8928
    v_rcp_f32 v32, v32
    v_rcp_f32 v33, v33
    s_waitcnt lgkmcnt(4)
    v_mfma_f32_32x32x16_bf16 v[96:111], v[28:31], v[244:247], v[96:111]
    ds_read_b64_tr_b16 v[24:25], v4 offset:9280
    ds_read_b64_tr_b16 v[26:27], v4 offset:9408
    v_mul_f32 v32, v32, v40
    v_mul_f32 v33, v33, v41
    v_cvt_pk_bf16_f32 v40, v32, v33
    v_mul_f32 v42, v34, v42
    v_mfma_f32_32x32x16_bf16 v[112:127], v[12:15], v[244:247], v[112:127]
    ds_read_b64_tr_b16 v[28:29], v4 offset:9312
    ds_read_b64_tr_b16 v[30:31], v4 offset:9440
    v_mul_f32 v43, v35, v43
    v_exp_f32 v34, -v34
    s_waitcnt lgkmcnt(4)
    v_mfma_f32_32x32x16_bf16 v[96:111], v[16:19], v[248:251], v[96:111]
    v_exp_f32 v35, -v35
    v_add_f32 v34, 1.0, v34
    v_add_f32 v35, 1.0, v35
    v_mfma_f32_32x32x16_bf16 v[112:127], v[20:23], v[248:251], v[112:127]
    v_rcp_f32 v34, v34
    v_rcp_f32 v35, v35
    v_mul_f32 v34, v34, v42
    s_waitcnt lgkmcnt(0)
    v_mfma_f32_32x32x16_bf16 v[96:111], v[24:27], v[252:255], v[96:111]
    v_mul_f32 v35, v35, v43
    v_cvt_pk_bf16_f32 v41, v34, v35
    v_mul_f32 v44, v36, v44
    v_mfma_f32_32x32x16_bf16 v[112:127], v[28:31], v[252:255], v[112:127]
    v_mul_f32 v45, v37, v45
    v_exp_f32 v36, -v36
    v_exp_f32 v37, -v37
    s_barrier
    buffer_load_dwordx4 v[200:203], v1, s[24:27], s70 offen sc1
    buffer_load_dwordx4 v[204:207], v1, s[24:27], s70 offen offset:1024 sc1
    s_branch L_tail
L_p2_k:
    s_nop 4
    s_waitcnt lgkmcnt(4)
    v_mfma_f32_32x32x16_bf16 v[96:111], v[24:27], v[128:131], 0
    ds_read_b64_tr_b16 v[20:21], v4 offset:56576
    ds_read_b64_tr_b16 v[22:23], v4 offset:56704
    v_mfma_f32_32x32x16_bf16 v[112:127], v[28:31], v[128:131], 0
    ds_read_b64_tr_b16 v[24:25], v4 offset:56640
    ds_read_b64_tr_b16 v[26:27], v4 offset:56768
    s_waitcnt lgkmcnt(4)
    v_mfma_f32_32x32x16_bf16 v[96:111], v[12:15], v[132:135], v[96:111]
    ds_read_b64_tr_b16 v[28:29], v4 offset:57088
    ds_read_b64_tr_b16 v[30:31], v4 offset:57216
    v_mul_f32 v40, v32, v40
    v_mul_f32 v41, v33, v41
    v_mfma_f32_32x32x16_bf16 v[112:127], v[16:19], v[132:135], v[112:127]
    ds_read_b64_tr_b16 v[12:13], v4 offset:57152
    ds_read_b64_tr_b16 v[14:15], v4 offset:57280
    v_subrev_u32 v4, 60928, v4
    v_exp_f32 v32, -v32
    s_waitcnt lgkmcnt(4)
    v_mfma_f32_32x32x16_bf16 v[96:111], v[20:23], v[136:139], v[96:111]
    s_barrier
    ds_read_b64_tr_b16 v[16:17], v4 offset:0
    ds_read_b64_tr_b16 v[18:19], v4 offset:128
    v_mfma_f32_32x32x16_bf16 v[112:127], v[24:27], v[136:139], v[112:127]
    ds_read_b64_tr_b16 v[20:21], v4 offset:64
    ds_read_b64_tr_b16 v[22:23], v4 offset:192
    v_exp_f32 v33, -v33
    v_add_f32 v32, 1.0, v32
    s_waitcnt lgkmcnt(4)
    v_mfma_f32_32x32x16_bf16 v[96:111], v[28:31], v[140:143], v[96:111]
    ds_read_b64_tr_b16 v[24:25], v4 offset:512
    ds_read_b64_tr_b16 v[26:27], v4 offset:640
    v_add_f32 v33, 1.0, v33
    v_mfma_f32_32x32x16_bf16 v[112:127], v[12:15], v[140:143], v[112:127]
    ds_read_b64_tr_b16 v[28:29], v4 offset:576
    ds_read_b64_tr_b16 v[30:31], v4 offset:704
    v_rcp_f32 v32, v32
    v_rcp_f32 v33, v33
    s_waitcnt lgkmcnt(4)
    v_mfma_f32_32x32x16_bf16 v[96:111], v[16:19], v[144:147], v[96:111]
    ds_read_b64_tr_b16 v[12:13], v4 offset:4352
    ds_read_b64_tr_b16 v[14:15], v4 offset:4480
    v_mul_f32 v32, v32, v40
    v_mul_f32 v33, v33, v41
    v_mfma_f32_32x32x16_bf16 v[112:127], v[20:23], v[144:147], v[112:127]
    ds_read_b64_tr_b16 v[16:17], v4 offset:4416
    ds_read_b64_tr_b16 v[18:19], v4 offset:4544
    v_cvt_pk_bf16_f32 v40, v32, v33
    v_mul_f32 v42, v34, v42
    v_mul_f32 v43, v35, v43
    s_waitcnt lgkmcnt(4)
    v_mfma_f32_32x32x16_bf16 v[96:111], v[24:27], v[148:151], v[96:111]
    ds_read_b64_tr_b16 v[20:21], v4 offset:4864
    ds_read_b64_tr_b16 v[22:23], v4 offset:4992
    v_exp_f32 v34, -v34
    v_mfma_f32_32x32x16_bf16 v[112:127], v[28:31], v[148:151], v[112:127]
    ds_read_b64_tr_b16 v[24:25], v4 offset:4928
    ds_read_b64_tr_b16 v[26:27], v4 offset:5056
    v_exp_f32 v35, -v35
    v_add_f32 v34, 1.0, v34
    s_waitcnt lgkmcnt(4)
    v_mfma_f32_32x32x16_bf16 v[96:111], v[12:15], v[152:155], v[96:111]
    s_barrier
    ds_read_b64_tr_b16 v[28:29], v4 offset:8704
    ds_read_b64_tr_b16 v[30:31], v4 offset:8832
    v_mfma_f32_32x32x16_bf16 v[112:127], v[16:19], v[152:155], v[112:127]
    ds_read_b64_tr_b16 v[12:13], v4 offset:8768
    ds_read_b64_tr_b16 v[14:15], v4 offset:8896
    v_add_f32 v35, 1.0, v35
    v_rcp_f32 v34, v34
    s_waitcnt lgkmcnt(4)
    v_mfma_f32_32x32x16_bf16 v[96:111], v[20:23], v[156:159], v[96:111]
    ds_read_b64_tr_b16 v[16:17], v4 offset:9216
    ds_read_b64_tr_b16 v[18:19], v4 offset:9344
    v_rcp_f32 v35, v35
    v_mfma_f32_32x32x16_bf16 v[112:127], v[24:27], v[156:159], v[112:127]
    ds_read_b64_tr_b16 v[20:21], v4 offset:9280
    ds_read_b64_tr_b16 v[22:23], v4 offset:9408
    v_mul_f32 v34, v34, v42
    v_mul_f32 v35, v35, v43
    v_cvt_pk_bf16_f32 v41, v34, v35
    s_waitcnt lgkmcnt(4)
    v_mfma_f32_32x32x16_bf16 v[96:111], v[28:31], v[160:163], v[96:111]
    ds_read_b64_tr_b16 v[24:25], v4 offset:13056
    ds_read_b64_tr_b16 v[26:27], v4 offset:13184
    v_mul_f32 v44, v36, v44
    v_mul_f32 v45, v37, v45
    v_mfma_f32_32x32x16_bf16 v[112:127], v[12:15], v[160:163], v[112:127]
    ds_read_b64_tr_b16 v[28:29], v4 offset:13120
    ds_read_b64_tr_b16 v[30:31], v4 offset:13248
    v_exp_f32 v36, -v36
    s_waitcnt lgkmcnt(4)
    v_mfma_f32_32x32x16_bf16 v[96:111], v[16:19], v[164:167], v[96:111]
    ds_read_b64_tr_b16 v[12:13], v4 offset:13568
    ds_read_b64_tr_b16 v[14:15], v4 offset:13696
    v_exp_f32 v37, -v37
    v_add_f32 v36, 1.0, v36
    v_mfma_f32_32x32x16_bf16 v[112:127], v[20:23], v[164:167], v[112:127]
    ds_read_b64_tr_b16 v[16:17], v4 offset:13632
    ds_read_b64_tr_b16 v[18:19], v4 offset:13760
    v_add_f32 v37, 1.0, v37
    v_rcp_f32 v36, v36
    s_waitcnt lgkmcnt(4)
    v_mfma_f32_32x32x16_bf16 v[96:111], v[24:27], v[168:171], v[96:111]
    s_barrier
    ds_read_b64_tr_b16 v[20:21], v4 offset:17408
    ds_read_b64_tr_b16 v[22:23], v4 offset:17536
    v_mfma_f32_32x32x16_bf16 v[112:127], v[28:31], v[168:171], v[112:127]
    ds_read_b64_tr_b16 v[24:25], v4 offset:17472
    ds_read_b64_tr_b16 v[26:27], v4 offset:17600
    v_rcp_f32 v37, v37
    v_mul_f32 v36, v36, v44
    s_waitcnt lgkmcnt(4)
    v_mfma_f32_32x32x16_bf16 v[96:111], v[12:15], v[172:175], v[96:111]
    ds_read_b64_tr_b16 v[28:29], v4 offset:17920
    ds_read_b64_tr_b16 v[30:31], v4 offset:18048
    v_mul_f32 v37, v37, v45
    v_cvt_pk_bf16_f32 v42, v36, v37
    v_mfma_f32_32x32x16_bf16 v[112:127], v[16:19], v[172:175], v[112:127]
    ds_read_b64_tr_b16 v[12:13], v4 offset:17984
    ds_read_b64_tr_b16 v[14:15], v4 offset:18112
    v_mul_f32 v46, v38, v46
    v_mul_f32 v47, v39, v47
    s_waitcnt lgkmcnt(4)
    v_mfma_f32_32x32x16_bf16 v[96:111], v[20:23], v[176:179], v[96:111]
    ds_read_b64_tr_b16 v[16:17], v4 offset:21760
    ds_read_b64_tr_b16 v[18:19], v4 offset:21888
    v_exp_f32 v38, -v38
    v_mfma_f32_32x32x16_bf16 v[112:127], v[24:27], v[176:179], v[112:127]
    ds_read_b64_tr_b16 v[20:21], v4 offset:21824
    ds_read_b64_tr_b16 v[22:23], v4 offset:21952
    v_exp_f32 v39, -v39
    v_add_f32 v38, 1.0, v38
    v_add_f32 v39, 1.0, v39
    s_waitcnt lgkmcnt(4)
    v_mfma_f32_32x32x16_bf16 v[96:111], v[28:31], v[180:183], v[96:111]
    ds_read_b64_tr_b16 v[24:25], v4 offset:22272
    ds_read_b64_tr_b16 v[26:27], v4 offset:22400
    v_rcp_f32 v38, v38
    v_mfma_f32_32x32x16_bf16 v[112:127], v[12:15], v[180:183], v[112:127]
    ds_read_b64_tr_b16 v[28:29], v4 offset:22336
    ds_read_b64_tr_b16 v[30:31], v4 offset:22464
    v_rcp_f32 v39, v39
    v_mul_f32 v38, v38, v46
    s_waitcnt lgkmcnt(4)
    v_mfma_f32_32x32x16_bf16 v[96:111], v[16:19], v[184:187], v[96:111]
    s_barrier
    ds_read_b64_tr_b16 v[12:13], v4 offset:26112
    ds_read_b64_tr_b16 v[14:15], v4 offset:26240
    v_mfma_f32_32x32x16_bf16 v[112:127], v[20:23], v[184:187], v[112:127]
    ds_read_b64_tr_b16 v[16:17], v4 offset:26176
    ds_read_b64_tr_b16 v[18:19], v4 offset:26304
    v_mul_f32 v39, v39, v47
    v_cvt_pk_bf16_f32 v43, v38, v39
    s_waitcnt lgkmcnt(4)
    v_mfma_f32_32x32x16_bf16 v[96:111], v[24:27], v[188:191], v[96:111]
    ds_read_b64_tr_b16 v[20:21], v4 offset:26624
    ds_read_b64_tr_b16 v[22:23], v4 offset:26752
    buffer_store_dwordx4 v[40:43], v1, s[24:27], s61 offen offset:0 sc1
    v_mul_f32 v56, v48, v56
    v_mfma_f32_32x32x16_bf16 v[112:127], v[28:31], v[188:191], v[112:127]
    ds_read_b64_tr_b16 v[24:25], v4 offset:26688
    ds_read_b64_tr_b16 v[26:27], v4 offset:26816
    v_mul_f32 v57, v49, v57
    v_exp_f32 v48, -v48
    s_waitcnt lgkmcnt(4)
    v_mfma_f32_32x32x16_bf16 v[96:111], v[12:15], v[192:195], v[96:111]
    ds_read_b64_tr_b16 v[28:29], v4 offset:30464
    ds_read_b64_tr_b16 v[30:31], v4 offset:30592
    v_exp_f32 v49, -v49
    v_mfma_f32_32x32x16_bf16 v[112:127], v[16:19], v[192:195], v[112:127]
    ds_read_b64_tr_b16 v[12:13], v4 offset:30528
    ds_read_b64_tr_b16 v[14:15], v4 offset:30656
    v_add_f32 v48, 1.0, v48
    v_add_f32 v49, 1.0, v49
    s_waitcnt lgkmcnt(4)
    v_mfma_f32_32x32x16_bf16 v[96:111], v[20:23], v[196:199], v[96:111]
    ds_read_b64_tr_b16 v[16:17], v4 offset:30976
    ds_read_b64_tr_b16 v[18:19], v4 offset:31104
    v_rcp_f32 v48, v48
    v_mfma_f32_32x32x16_bf16 v[112:127], v[24:27], v[196:199], v[112:127]
    ds_read_b64_tr_b16 v[20:21], v4 offset:31040
    ds_read_b64_tr_b16 v[22:23], v4 offset:31168
    v_rcp_f32 v49, v49
    v_mul_f32 v48, v48, v56
    v_mul_f32 v49, v49, v57
    s_waitcnt lgkmcnt(4)
    v_mfma_f32_32x32x16_bf16 v[96:111], v[28:31], v[200:203], v[96:111]
    s_barrier
    ds_read_b64_tr_b16 v[24:25], v4 offset:34816
    ds_read_b64_tr_b16 v[26:27], v4 offset:34944
    v_mfma_f32_32x32x16_bf16 v[112:127], v[12:15], v[200:203], v[112:127]
    ds_read_b64_tr_b16 v[28:29], v4 offset:34880
    ds_read_b64_tr_b16 v[30:31], v4 offset:35008
    v_cvt_pk_bf16_f32 v56, v48, v49
    v_mul_f32 v58, v50, v58
    v_mul_f32 v59, v51, v59
    s_waitcnt lgkmcnt(4)
    v_mfma_f32_32x32x16_bf16 v[96:111], v[16:19], v[204:207], v[96:111]
    ds_read_b64_tr_b16 v[12:13], v4 offset:35328
    ds_read_b64_tr_b16 v[14:15], v4 offset:35456
    v_exp_f32 v50, -v50
    v_mfma_f32_32x32x16_bf16 v[112:127], v[20:23], v[204:207], v[112:127]
    ds_read_b64_tr_b16 v[16:17], v4 offset:35392
    ds_read_b64_tr_b16 v[18:19], v4 offset:35520
    v_exp_f32 v51, -v51
    v_add_f32 v50, 1.0, v50
    s_waitcnt lgkmcnt(4)
    v_mfma_f32_32x32x16_bf16 v[96:111], v[24:27], v[208:211], v[96:111]
    ds_read_b64_tr_b16 v[20:21], v4 offset:39168
    ds_read_b64_tr_b16 v[22:23], v4 offset:39296
    v_add_f32 v51, 1.0, v51
    v_mfma_f32_32x32x16_bf16 v[112:127], v[28:31], v[208:211], v[112:127]
    ds_read_b64_tr_b16 v[24:25], v4 offset:39232
    ds_read_b64_tr_b16 v[26:27], v4 offset:39360
    v_rcp_f32 v50, v50
    v_rcp_f32 v51, v51
    s_waitcnt lgkmcnt(4)
    v_mfma_f32_32x32x16_bf16 v[96:111], v[12:15], v[212:215], v[96:111]
    ds_read_b64_tr_b16 v[28:29], v4 offset:39680
    ds_read_b64_tr_b16 v[30:31], v4 offset:39808
    v_mul_f32 v50, v50, v58
    v_mul_f32 v51, v51, v59
    v_mfma_f32_32x32x16_bf16 v[112:127], v[16:19], v[212:215], v[112:127]
    ds_read_b64_tr_b16 v[12:13], v4 offset:39744
    ds_read_b64_tr_b16 v[14:15], v4 offset:39872
    v_cvt_pk_bf16_f32 v57, v50, v51
    v_mul_f32 v60, v52, v60
    v_mul_f32 v61, v53, v61
    s_waitcnt lgkmcnt(4)
    v_mfma_f32_32x32x16_bf16 v[96:111], v[20:23], v[216:219], v[96:111]
    s_barrier
    ds_read_b64_tr_b16 v[16:17], v4 offset:43520
    ds_read_b64_tr_b16 v[18:19], v4 offset:43648
    v_mfma_f32_32x32x16_bf16 v[112:127], v[24:27], v[216:219], v[112:127]
    ds_read_b64_tr_b16 v[20:21], v4 offset:43584
    ds_read_b64_tr_b16 v[22:23], v4 offset:43712
    v_exp_f32 v52, -v52
    s_waitcnt lgkmcnt(4)
    v_mfma_f32_32x32x16_bf16 v[96:111], v[28:31], v[220:223], v[96:111]
    ds_read_b64_tr_b16 v[24:25], v4 offset:44032
    ds_read_b64_tr_b16 v[26:27], v4 offset:44160
    v_exp_f32 v53, -v53
    v_add_f32 v52, 1.0, v52
    v_mfma_f32_32x32x16_bf16 v[112:127], v[12:15], v[220:223], v[112:127]
    ds_read_b64_tr_b16 v[28:29], v4 offset:44096
    ds_read_b64_tr_b16 v[30:31], v4 offset:44224
    v_add_f32 v53, 1.0, v53
    v_rcp_f32 v52, v52
    s_waitcnt lgkmcnt(4)
    v_mfma_f32_32x32x16_bf16 v[96:111], v[16:19], v[224:227], v[96:111]
    ds_read_b64_tr_b16 v[12:13], v4 offset:47872
    ds_read_b64_tr_b16 v[14:15], v4 offset:48000
    v_rcp_f32 v53, v53
    v_mfma_f32_32x32x16_bf16 v[112:127], v[20:23], v[224:227], v[112:127]
    ds_read_b64_tr_b16 v[16:17], v4 offset:47936
    ds_read_b64_tr_b16 v[18:19], v4 offset:48064
    v_mul_f32 v52, v52, v60
    v_mul_f32 v53, v53, v61
    v_cvt_pk_bf16_f32 v58, v52, v53
    s_waitcnt lgkmcnt(4)
    v_mfma_f32_32x32x16_bf16 v[96:111], v[24:27], v[228:231], v[96:111]
    ds_read_b64_tr_b16 v[20:21], v4 offset:48384
    ds_read_b64_tr_b16 v[22:23], v4 offset:48512
    v_mul_f32 v62, v54, v62
    v_mul_f32 v63, v55, v63
    v_mfma_f32_32x32x16_bf16 v[112:127], v[28:31], v[228:231], v[112:127]
    ds_read_b64_tr_b16 v[24:25], v4 offset:48448
    ds_read_b64_tr_b16 v[26:27], v4 offset:48576
    v_exp_f32 v54, -v54
    s_waitcnt lgkmcnt(4)
    v_mfma_f32_32x32x16_bf16 v[96:111], v[12:15], v[232:235], v[96:111]
    s_barrier
    ds_read_b64_tr_b16 v[28:29], v4 offset:52224
    ds_read_b64_tr_b16 v[30:31], v4 offset:52352
    v_mfma_f32_32x32x16_bf16 v[112:127], v[16:19], v[232:235], v[112:127]
    ds_read_b64_tr_b16 v[12:13], v4 offset:52288
    ds_read_b64_tr_b16 v[14:15], v4 offset:52416
    v_exp_f32 v55, -v55
    v_add_f32 v54, 1.0, v54
    v_add_f32 v55, 1.0, v55
    s_waitcnt lgkmcnt(4)
    v_mfma_f32_32x32x16_bf16 v[96:111], v[20:23], v[236:239], v[96:111]
    ds_read_b64_tr_b16 v[16:17], v4 offset:52736
    ds_read_b64_tr_b16 v[18:19], v4 offset:52864
    v_rcp_f32 v54, v54
    v_mfma_f32_32x32x16_bf16 v[112:127], v[24:27], v[236:239], v[112:127]
    ds_read_b64_tr_b16 v[20:21], v4 offset:52800
    ds_read_b64_tr_b16 v[22:23], v4 offset:52928
    v_rcp_f32 v55, v55
    v_mul_f32 v54, v54, v62
    s_waitcnt lgkmcnt(4)
    v_mfma_f32_32x32x16_bf16 v[96:111], v[28:31], v[240:243], v[96:111]
    ds_read_b64_tr_b16 v[24:25], v4 offset:56576
    ds_read_b64_tr_b16 v[26:27], v4 offset:56704
    v_mul_f32 v55, v55, v63
    v_cvt_pk_bf16_f32 v59, v54, v55
    v_mfma_f32_32x32x16_bf16 v[112:127], v[12:15], v[240:243], v[112:127]
    ds_read_b64_tr_b16 v[28:29], v4 offset:56640
    ds_read_b64_tr_b16 v[30:31], v4 offset:56768
    buffer_store_dwordx4 v[56:59], v1, s[24:27], s61 offen offset:1024 sc1
    s_waitcnt lgkmcnt(4)
    v_mfma_f32_32x32x16_bf16 v[96:111], v[16:19], v[244:247], v[96:111]
    ds_read_b64_tr_b16 v[12:13], v4 offset:57088
    ds_read_b64_tr_b16 v[14:15], v4 offset:57216
    v_mfma_f32_32x32x16_bf16 v[112:127], v[20:23], v[244:247], v[112:127]
    ds_read_b64_tr_b16 v[16:17], v4 offset:57152
    ds_read_b64_tr_b16 v[18:19], v4 offset:57280
    s_waitcnt lgkmcnt(4)
    v_mfma_f32_32x32x16_bf16 v[96:111], v[24:27], v[248:251], v[96:111]
    s_barrier
    ds_read_b64_tr_b16 v[20:21], v3 offset:0
    ds_read_b64_tr_b16 v[22:23], v3 offset:128
    v_mfma_f32_32x32x16_bf16 v[112:127], v[28:31], v[248:251], v[112:127]
    ds_read_b64_tr_b16 v[24:25], v3 offset:32
    ds_read_b64_tr_b16 v[26:27], v3 offset:160
    s_waitcnt lgkmcnt(4)
    v_mfma_f32_32x32x16_bf16 v[96:111], v[12:15], v[252:255], v[96:111]
    ds_read_b64_tr_b16 v[28:29], v3 offset:512
    ds_read_b64_tr_b16 v[30:31], v3 offset:640
    v_mfma_f32_32x32x16_bf16 v[112:127], v[16:19], v[252:255], v[112:127]
    ds_read_b64_tr_b16 v[12:13], v3 offset:544
    ds_read_b64_tr_b16 v[14:15], v3 offset:672
L_p3:
    s_nop 1
    s_waitcnt lgkmcnt(4)
    v_mfma_f32_32x32x16_bf16 v[32:47], v[20:23], v[128:131], 0
    s_barrier
    ds_read_b64_tr_b16 v[16:17], v3 offset:8704
    ds_read_b64_tr_b16 v[18:19], v3 offset:8832
    v_mfma_f32_32x32x16_bf16 v[48:63], v[24:27], v[128:131], 0
    ds_read_b64_tr_b16 v[20:21], v3 offset:8736
    ds_read_b64_tr_b16 v[22:23], v3 offset:8864
    s_waitcnt lgkmcnt(4)
    v_mfma_f32_32x32x16_bf16 v[32:47], v[28:31], v[132:135], v[32:47]
    ds_read_b64_tr_b16 v[24:25], v3 offset:9216
    ds_read_b64_tr_b16 v[26:27], v3 offset:9344
    v_mfma_f32_32x32x16_bf16 v[48:63], v[12:15], v[132:135], v[48:63]
    ds_read_b64_tr_b16 v[28:29], v3 offset:9248
    ds_read_b64_tr_b16 v[30:31], v3 offset:9376
    v_cvt_pk_bf16_f32 v96, v96, v97
    v_cvt_pk_bf16_f32 v97, v98, v99
    v_cvt_pk_bf16_f32 v98, v100, v101
    v_cvt_pk_bf16_f32 v99, v102, v103
    s_waitcnt lgkmcnt(4)
    v_mfma_f32_32x32x16_bf16 v[32:47], v[16:19], v[136:139], v[32:47]
    s_barrier
    ds_read_b64_tr_b16 v[12:13], v3 offset:17408
    ds_read_b64_tr_b16 v[14:15], v3 offset:17536
    v_mfma_f32_32x32x16_bf16 v[48:63], v[20:23], v[136:139], v[48:63]
    ds_read_b64_tr_b16 v[16:17], v3 offset:17440
    ds_read_b64_tr_b16 v[18:19], v3 offset:17568
    buffer_store_dwordx4 v[96:99], v2, s[24:27], s63 offen sc1
    v_cvt_pk_bf16_f32 v104, v104, v105
    v_cvt_pk_bf16_f32 v105, v106, v107
    v_cvt_pk_bf16_f32 v106, v108, v109
    s_waitcnt lgkmcnt(4)
    v_mfma_f32_32x32x16_bf16 v[32:47], v[24:27], v[140:143], v[32:47]
    ds_read_b64_tr_b16 v[20:21], v3 offset:17920
    ds_read_b64_tr_b16 v[22:23], v3 offset:18048
    v_cvt_pk_bf16_f32 v107, v110, v111
    buffer_store_dwordx4 v[104:107], v2, s[24:27], s64 offen sc1
    v_cvt_pk_bf16_f32 v112, v112, v113
    v_mfma_f32_32x32x16_bf16 v[48:63], v[28:31], v[140:143], v[48:63]
    ds_read_b64_tr_b16 v[24:25], v3 offset:17952
    ds_read_b64_tr_b16 v[26:27], v3 offset:18080
    v_mov_b32 v4, v3
    v_cvt_pk_bf16_f32 v113, v114, v115
    v_cvt_pk_bf16_f32 v114, v116, v117
    v_cvt_pk_bf16_f32 v115, v118, v119
    s_waitcnt lgkmcnt(4)
    v_mfma_f32_32x32x16_bf16 v[32:47], v[12:15], v[144:147], v[32:47]
    ds_read_b64_tr_b16 v[28:29], v4 offset:64
    ds_read_b64_tr_b16 v[30:31], v4 offset:192
    buffer_store_dwordx4 v[112:115], v2, s[24:27], s65 offen sc1
    v_cvt_pk_bf16_f32 v120, v120, v121
    v_cvt_pk_bf16_f32 v121, v122, v123
    v_mfma_f32_32x32x16_bf16 v[48:63], v[16:19], v[144:147], v[48:63]
    ds_read_b64_tr_b16 v[12:13], v4 offset:96
    ds_read_b64_tr_b16 v[14:15], v4 offset:224
    v_cvt_pk_bf16_f32 v122, v124, v125
    v_cvt_pk_bf16_f32 v123, v126, v127
    buffer_store_dwordx4 v[120:123], v2, s[24:27], s66 offen sc1
    s_waitcnt lgkmcnt(4)
    v_mfma_f32_32x32x16_bf16 v[32:47], v[20:23], v[148:151], v[32:47]
    s_barrier
    ds_read_b64_tr_b16 v[16:17], v3 offset:26112
    ds_read_b64_tr_b16 v[18:19], v3 offset:26240
    v_mfma_f32_32x32x16_bf16 v[48:63], v[24:27], v[148:151], v[48:63]
    ds_read_b64_tr_b16 v[20:21], v3 offset:26144
    ds_read_b64_tr_b16 v[22:23], v3 offset:26272
    s_waitcnt lgkmcnt(4)
    v_mfma_f32_32x32x16_bf16 v[96:111], v[28:31], v[128:131], 0
    ds_read_b64_tr_b16 v[24:25], v4 offset:576
    ds_read_b64_tr_b16 v[26:27], v4 offset:704
    v_mul_f32 v72, v64, v72
    v_mul_f32 v73, v65, v73
    v_mfma_f32_32x32x16_bf16 v[112:127], v[12:15], v[128:131], 0
    ds_read_b64_tr_b16 v[28:29], v4 offset:608
    ds_read_b64_tr_b16 v[30:31], v4 offset:736
    v_exp_f32 v64, -v64
    v_exp_f32 v65, -v65
    s_waitcnt lgkmcnt(4)
    v_mfma_f32_32x32x16_bf16 v[32:47], v[16:19], v[152:155], v[32:47]
    ds_read_b64_tr_b16 v[12:13], v3 offset:26624
    ds_read_b64_tr_b16 v[14:15], v3 offset:26752
    v_add_f32 v64, 1.0, v64
    v_add_f32 v65, 1.0, v65
    v_mfma_f32_32x32x16_bf16 v[48:63], v[20:23], v[152:155], v[48:63]
    ds_read_b64_tr_b16 v[16:17], v3 offset:26656
    ds_read_b64_tr_b16 v[18:19], v3 offset:26784
    v_rcp_f32 v64, v64
    v_rcp_f32 v65, v65
    s_waitcnt lgkmcnt(4)
    v_mfma_f32_32x32x16_bf16 v[96:111], v[24:27], v[132:135], v[96:111]
    ds_read_b64_tr_b16 v[20:21], v4 offset:8768
    ds_read_b64_tr_b16 v[22:23], v4 offset:8896
    v_mul_f32 v64, v64, v72
    v_mul_f32 v65, v65, v73
    v_cvt_pk_bf16_f32 v72, v64, v65
    v_mfma_f32_32x32x16_bf16 v[112:127], v[28:31], v[132:135], v[112:127]
    ds_read_b64_tr_b16 v[24:25], v4 offset:8800
    ds_read_b64_tr_b16 v[26:27], v4 offset:8928
    v_mul_f32 v74, v66, v74
    v_mul_f32 v75, v67, v75
    s_waitcnt lgkmcnt(4)
    v_mfma_f32_32x32x16_bf16 v[32:47], v[12:15], v[156:159], v[32:47]
    s_barrier
    ds_read_b64_tr_b16 v[28:29], v3 offset:34816
    ds_read_b64_tr_b16 v[30:31], v3 offset:34944
    v_mfma_f32_32x32x16_bf16 v[48:63], v[16:19], v[156:159], v[48:63]
    ds_read_b64_tr_b16 v[12:13], v3 offset:34848
    ds_read_b64_tr_b16 v[14:15], v3 offset:34976
    v_exp_f32 v66, -v66
    v_exp_f32 v67, -v67
    s_waitcnt lgkmcnt(4)
    v_mfma_f32_32x32x16_bf16 v[96:111], v[20:23], v[136:139], v[96:111]
    ds_read_b64_tr_b16 v[16:17], v4 offset:9280
    ds_read_b64_tr_b16 v[18:19], v4 offset:9408
    v_add_f32 v66, 1.0, v66
    v_add_f32 v67, 1.0, v67
    v_mfma_f32_32x32x16_bf16 v[112:127], v[24:27], v[136:139], v[112:127]
    ds_read_b64_tr_b16 v[20:21], v4 offset:9312
    ds_read_b64_tr_b16 v[22:23], v4 offset:9440
    v_rcp_f32 v66, v66
    v_rcp_f32 v67, v67
    s_waitcnt lgkmcnt(4)
    v_mfma_f32_32x32x16_bf16 v[32:47], v[28:31], v[160:163], v[32:47]
    ds_read_b64_tr_b16 v[24:25], v3 offset:35328
    ds_read_b64_tr_b16 v[26:27], v3 offset:35456
    v_mul_f32 v66, v66, v74
    v_mul_f32 v67, v67, v75
    v_cvt_pk_bf16_f32 v73, v66, v67
    v_mfma_f32_32x32x16_bf16 v[48:63], v[12:15], v[160:163], v[48:63]
    ds_read_b64_tr_b16 v[28:29], v3 offset:35360
    ds_read_b64_tr_b16 v[30:31], v3 offset:35488
    v_mul_f32 v76, v68, v76
    v_mul_f32 v77, v69, v77
    s_waitcnt lgkmcnt(4)
    v_mfma_f32_32x32x16_bf16 v[96:111], v[16:19], v[140:143], v[96:111]
    ds_read_b64_tr_b16 v[12:13], v4 offset:17472
    ds_read_b64_tr_b16 v[14:15], v4 offset:17600
    v_exp_f32 v68, -v68
    v_mfma_f32_32x32x16_bf16 v[112:127], v[20:23], v[140:143], v[112:127]
    ds_read_b64_tr_b16 v[16:17], v4 offset:17504
    ds_read_b64_tr_b16 v[18:19], v4 offset:17632
    v_exp_f32 v69, -v69
    v_add_f32 v68, 1.0, v68
    v_add_f32 v69, 1.0, v69
    s_waitcnt lgkmcnt(4)
    v_mfma_f32_32x32x16_bf16 v[32:47], v[24:27], v[164:167], v[32:47]
    s_barrier
    ds_read_b64_tr_b16 v[20:21], v3 offset:43520
    ds_read_b64_tr_b16 v[22:23], v3 offset:43648
    v_mfma_f32_32x32x16_bf16 v[48:63], v[28:31], v[164:167], v[48:63]
    ds_read_b64_tr_b16 v[24:25], v3 offset:43552
    ds_read_b64_tr_b16 v[26:27], v3 offset:43680
    v_rcp_f32 v68, v68
    v_rcp_f32 v69, v69
    s_waitcnt lgkmcnt(4)
    v_mfma_f32_32x32x16_bf16 v[96:111], v[12:15], v[144:147], v[96:111]
    ds_read_b64_tr_b16 v[28:29], v4 offset:17984
    ds_read_b64_tr_b16 v[30:31], v4 offset:18112
    v_mul_f32 v68, v68, v76
    v_mul_f32 v69, v69, v77
    v_mfma_f32_32x32x16_bf16 v[112:127], v[16:19], v[144:147], v[112:127]
    ds_read_b64_tr_b16 v[12:13], v4 offset:18016
    ds_read_b64_tr_b16 v[14:15], v4 offset:18144
    v_cvt_pk_bf16_f32 v74, v68, v69
    v_mul_f32 v78, v70, v78
    v_mul_f32 v79, v71, v79
    s_waitcnt lgkmcnt(4)
    v_mfma_f32_32x32x16_bf16 v[32:47], v[20:23], v[168:171], v[32:47]
    ds_read_b64_tr_b16 v[16:17], v3 offset:44032
    ds_read_b64_tr_b16 v[18:19], v3 offset:44160
    v_exp_f32 v70, -v70
    v_mfma_f32_32x32x16_bf16 v[48:63], v[24:27], v[168:171], v[48:63]
    ds_read_b64_tr_b16 v[20:21], v3 offset:44064
    ds_read_b64_tr_b16 v[22:23], v3 offset:44192
    v_exp_f32 v71, -v71
    v_add_f32 v70, 1.0, v70
    v_add_f32 v71, 1.0, v71
    s_waitcnt lgkmcnt(4)
    v_mfma_f32_32x32x16_bf16 v[96:111], v[28:31], v[148:151], v[96:111]
    ds_read_b64_tr_b16 v[24:25], v4 offset:26176
    ds_read_b64_tr_b16 v[26:27], v4 offset:26304
    v_rcp_f32 v70, v70
    v_mfma_f32_32x32x16_bf16 v[112:127], v[12:15], v[148:151], v[112:127]
    ds_read_b64_tr_b16 v[28:29], v4 offset:26208
    ds_read_b64_tr_b16 v[30:31], v4 offset:26336
    v_rcp_f32 v71, v71
    v_mul_f32 v70, v70, v78
    v_mul_f32 v71, v71, v79
    s_waitcnt lgkmcnt(4)
    v_mfma_f32_32x32x16_bf16 v[32:47], v[16:19], v[172:175], v[32:47]
    s_barrier
    ds_read_b64_tr_b16 v[12:13], v3 offset:52224
    ds_read_b64_tr_b16 v[14:15], v3 offset:52352
    v_mfma_f32_32x32x16_bf16 v[48:63], v[20:23], v[172:175], v[48:63]
    ds_read_b64_tr_b16 v[16:17], v3 offset:52256
    ds_read_b64_tr_b16 v[18:19], v3 offset:52384
    v_cvt_pk_bf16_f32 v75, v70, v71
    buffer_store_dwordx4 v[72:75], v1, s[24:27], s61 offen offset:2048 sc1
    v_mul_f32 v88, v80, v88
    s_waitcnt lgkmcnt(4)
    v_mfma_f32_32x32x16_bf16 v[96:111], v[24:27], v[152:155], v[96:111]
    ds_read_b64_tr_b16 v[20:21], v4 offset:26688
    ds_read_b64_tr_b16 v[22:23], v4 offset:26816
    v_mul_f32 v89, v81, v89
    v_mfma_f32_32x32x16_bf16 v[112:127], v[28:31], v[152:155], v[112:127]
    ds_read_b64_tr_b16 v[24:25], v4 offset:26720
    ds_read_b64_tr_b16 v[26:27], v4 offset:26848
    v_exp_f32 v80, -v80
    v_exp_f32 v81, -v81
    s_waitcnt lgkmcnt(4)
    v_mfma_f32_32x32x16_bf16 v[32:47], v[12:15], v[176:179], v[32:47]
    ds_read_b64_tr_b16 v[28:29], v3 offset:52736
    ds_read_b64_tr_b16 v[30:31], v3 offset:52864
    v_add_f32 v80, 1.0, v80
    v_add_f32 v81, 1.0, v81
    v_mfma_f32_32x32x16_bf16 v[48:63], v[16:19], v[176:179], v[48:63]
    ds_read_b64_tr_b16 v[12:13], v3 offset:52768
    ds_read_b64_tr_b16 v[14:15], v3 offset:52896
    v_rcp_f32 v80, v80
    v_rcp_f32 v81, v81
    s_waitcnt lgkmcnt(4)
    v_mfma_f32_32x32x16_bf16 v[96:111], v[20:23], v[156:159], v[96:111]
    ds_read_b64_tr_b16 v[16:17], v4 offset:34880
    ds_read_b64_tr_b16 v[18:19], v4 offset:35008
    v_mul_f32 v80, v80, v88
    v_mul_f32 v81, v81, v89
    v_cvt_pk_bf16_f32 v88, v80, v81
    v_mfma_f32_32x32x16_bf16 v[112:127], v[24:27], v[156:159], v[112:127]
    ds_read_b64_tr_b16 v[20:21], v4 offset:34912
    ds_read_b64_tr_b16 v[22:23], v4 offset:35040
    v_subrev_u32 v3, 60928, v3
    v_mul_f32 v90, v82, v90
    v_mul_f32 v91, v83, v91
    s_waitcnt lgkmcnt(4)
    v_mfma_f32_32x32x16_bf16 v[32:47], v[28:31], v[180:183], v[32:47]
    s_barrier
    ds_read_b64_tr_b16 v[24:25], v3 offset:0
    ds_read_b64_tr_b16 v[26:27], v3 offset:128
    v_mfma_f32_32x32x16_bf16 v[48:63], v[12:15], v[180:183], v[48:63]
    ds_read_b64_tr_b16 v[28:29], v3 offset:32
    ds_read_b64_tr_b16 v[30:31], v3 offset:160
    v_exp_f32 v82, -v82
    v_exp_f32 v83, -v83
    s_waitcnt lgkmcnt(4)
    v_mfma_f32_32x32x16_bf16 v[96:111], v[16:19], v[160:163], v[96:111]
    ds_read_b64_tr_b16 v[12:13], v4 offset:35392
    ds_read_b64_tr_b16 v[14:15], v4 offset:35520
    v_mov_b32 v7, 1
    s_waitcnt vmcnt(1)
    buffer_store_dword v7, v1, s[32:35], 0 offen sc1
    v_add_f32 v82, 1.0, v82
    v_add_f32 v83, 1.0, v83
    v_mfma_f32_32x32x16_bf16 v[112:127], v[20:23], v[160:163], v[112:127]
    ds_read_b64_tr_b16 v[16:17], v4 offset:35424
    ds_read_b64_tr_b16 v[18:19], v4 offset:35552
    v_rcp_f32 v82, v82
    v_rcp_f32 v83, v83
    s_waitcnt lgkmcnt(4)
    v_mfma_f32_32x32x16_bf16 v[32:47], v[24:27], v[184:187], v[32:47]
    ds_read_b64_tr_b16 v[20:21], v3 offset:512
    ds_read_b64_tr_b16 v[22:23], v3 offset:640
    v_mul_f32 v82, v82, v90
    v_mul_f32 v83, v83, v91
    v_cvt_pk_bf16_f32 v89, v82, v83
    v_mfma_f32_32x32x16_bf16 v[48:63], v[28:31], v[184:187], v[48:63]
    ds_read_b64_tr_b16 v[24:25], v3 offset:544
    ds_read_b64_tr_b16 v[26:27], v3 offset:672
    v_mul_f32 v92, v84, v92
    v_mul_f32 v93, v85, v93
    s_waitcnt lgkmcnt(4)
    v_mfma_f32_32x32x16_bf16 v[96:111], v[12:15], v[164:167], v[96:111]
    ds_read_b64_tr_b16 v[28:29], v4 offset:43584
    ds_read_b64_tr_b16 v[30:31], v4 offset:43712
    v_exp_f32 v84, -v84
    v_mfma_f32_32x32x16_bf16 v[112:127], v[16:19], v[164:167], v[112:127]
    ds_read_b64_tr_b16 v[12:13], v4 offset:43616
    ds_read_b64_tr_b16 v[14:15], v4 offset:43744
    v_exp_f32 v85, -v85
    v_add_f32 v84, 1.0, v84
    v_add_f32 v85, 1.0, v85
    s_waitcnt lgkmcnt(4)
    v_mfma_f32_32x32x16_bf16 v[32:47], v[20:23], v[188:191], v[32:47]
    s_barrier
    ds_read_b64_tr_b16 v[16:17], v3 offset:8704
    ds_read_b64_tr_b16 v[18:19], v3 offset:8832
    v_mfma_f32_32x32x16_bf16 v[48:63], v[24:27], v[188:191], v[48:63]
    ds_read_b64_tr_b16 v[20:21], v3 offset:8736
    ds_read_b64_tr_b16 v[22:23], v3 offset:8864
    v_rcp_f32 v84, v84
    v_rcp_f32 v85, v85
    s_waitcnt lgkmcnt(4)
    v_mfma_f32_32x32x16_bf16 v[96:111], v[28:31], v[168:171], v[96:111]
    ds_read_b64_tr_b16 v[24:25], v4 offset:44096
    ds_read_b64_tr_b16 v[26:27], v4 offset:44224
    v_mul_f32 v84, v84, v92
    v_mul_f32 v85, v85, v93
    v_mfma_f32_32x32x16_bf16 v[112:127], v[12:15], v[168:171], v[112:127]
    ds_read_b64_tr_b16 v[28:29], v4 offset:44128
    ds_read_b64_tr_b16 v[30:31], v4 offset:44256
    v_cvt_pk_bf16_f32 v90, v84, v85
    v_mul_f32 v94, v86, v94
    v_mul_f32 v95, v87, v95
    s_waitcnt lgkmcnt(4)
    v_mfma_f32_32x32x16_bf16 v[32:47], v[16:19], v[192:195], v[32:47]
    ds_read_b64_tr_b16 v[12:13], v3 offset:9216
    ds_read_b64_tr_b16 v[14:15], v3 offset:9344
    v_exp_f32 v86, -v86
    v_mfma_f32_32x32x16_bf16 v[48:63], v[20:23], v[192:195], v[48:63]
    ds_read_b64_tr_b16 v[16:17], v3 offset:9248
    ds_read_b64_tr_b16 v[18:19], v3 offset:9376
    v_exp_f32 v87, -v87
    v_add_f32 v86, 1.0, v86
    v_add_f32 v87, 1.0, v87
    s_waitcnt lgkmcnt(4)
    v_mfma_f32_32x32x16_bf16 v[96:111], v[24:27], v[172:175], v[96:111]
    ds_read_b64_tr_b16 v[20:21], v4 offset:52288
    ds_read_b64_tr_b16 v[22:23], v4 offset:52416
    v_rcp_f32 v86, v86
    v_mfma_f32_32x32x16_bf16 v[112:127], v[28:31], v[172:175], v[112:127]
    ds_read_b64_tr_b16 v[24:25], v4 offset:52320
    ds_read_b64_tr_b16 v[26:27], v4 offset:52448
    v_rcp_f32 v87, v87
    v_mul_f32 v86, v86, v94
    v_mul_f32 v87, v87, v95
    s_waitcnt lgkmcnt(4)
    v_mfma_f32_32x32x16_bf16 v[32:47], v[12:15], v[196:199], v[32:47]
    s_barrier
    ds_read_b64_tr_b16 v[28:29], v3 offset:17408
    ds_read_b64_tr_b16 v[30:31], v3 offset:17536
    v_mfma_f32_32x32x16_bf16 v[48:63], v[16:19], v[196:199], v[48:63]
    ds_read_b64_tr_b16 v[12:13], v3 offset:17440
    ds_read_b64_tr_b16 v[14:15], v3 offset:17568
    v_cvt_pk_bf16_f32 v91, v86, v87
    buffer_store_dwordx4 v[88:91], v1, s[24:27], s61 offen offset:3072 sc1
    s_waitcnt lgkmcnt(4)
    v_mfma_f32_32x32x16_bf16 v[96:111], v[20:23], v[176:179], v[96:111]
    ds_read_b64_tr_b16 v[16:17], v4 offset:52800
    ds_read_b64_tr_b16 v[18:19], v4 offset:52928
    v_mfma_f32_32x32x16_bf16 v[112:127], v[24:27], v[176:179], v[112:127]
    ds_read_b64_tr_b16 v[20:21], v4 offset:52832
    ds_read_b64_tr_b16 v[22:23], v4 offset:52960
    s_waitcnt lgkmcnt(4)
    v_mfma_f32_32x32x16_bf16 v[32:47], v[28:31], v[200:203], v[32:47]
    ds_read_b64_tr_b16 v[24:25], v3 offset:17920
    ds_read_b64_tr_b16 v[26:27], v3 offset:18048
    v_mfma_f32_32x32x16_bf16 v[48:63], v[12:15], v[200:203], v[48:63]
    ds_read_b64_tr_b16 v[28:29], v3 offset:17952
    ds_read_b64_tr_b16 v[30:31], v3 offset:18080
    v_subrev_u32 v4, 60928, v4
    s_waitcnt lgkmcnt(4)
    v_mfma_f32_32x32x16_bf16 v[96:111], v[16:19], v[180:183], v[96:111]
    ds_read_b64_tr_b16 v[12:13], v4 offset:64
    ds_read_b64_tr_b16 v[14:15], v4 offset:192
    v_mfma_f32_32x32x16_bf16 v[112:127], v[20:23], v[180:183], v[112:127]
    ds_read_b64_tr_b16 v[16:17], v4 offset:96
    ds_read_b64_tr_b16 v[18:19], v4 offset:224
    s_waitcnt lgkmcnt(4)
    v_mfma_f32_32x32x16_bf16 v[32:47], v[24:27], v[204:207], v[32:47]
    s_barrier
    ds_read_b64_tr_b16 v[20:21], v3 offset:26112
    ds_read_b64_tr_b16 v[22:23], v3 offset:26240
    v_mfma_f32_32x32x16_bf16 v[48:63], v[28:31], v[204:207], v[48:63]
    ds_read_b64_tr_b16 v[24:25], v3 offset:26144
    ds_read_b64_tr_b16 v[26:27], v3 offset:26272
    s_waitcnt lgkmcnt(4)
    v_mfma_f32_32x32x16_bf16 v[96:111], v[12:15], v[184:187], v[96:111]
    ds_read_b64_tr_b16 v[28:29], v4 offset:576
    ds_read_b64_tr_b16 v[30:31], v4 offset:704
    v_mfma_f32_32x32x16_bf16 v[112:127], v[16:19], v[184:187], v[112:127]
    ds_read_b64_tr_b16 v[12:13], v4 offset:608
    ds_read_b64_tr_b16 v[14:15], v4 offset:736
    s_waitcnt lgkmcnt(4)
    v_mfma_f32_32x32x16_bf16 v[32:47], v[20:23], v[208:211], v[32:47]
    ds_read_b64_tr_b16 v[16:17], v3 offset:26624
    ds_read_b64_tr_b16 v[18:19], v3 offset:26752
    v_mfma_f32_32x32x16_bf16 v[48:63], v[24:27], v[208:211], v[48:63]
    ds_read_b64_tr_b16 v[20:21], v3 offset:26656
    ds_read_b64_tr_b16 v[22:23], v3 offset:26784
    s_waitcnt lgkmcnt(4)
    v_mfma_f32_32x32x16_bf16 v[96:111], v[28:31], v[188:191], v[96:111]
    ds_read_b64_tr_b16 v[24:25], v4 offset:8768
    ds_read_b64_tr_b16 v[26:27], v4 offset:8896
    v_mfma_f32_32x32x16_bf16 v[112:127], v[12:15], v[188:191], v[112:127]
    ds_read_b64_tr_b16 v[28:29], v4 offset:8800
    ds_read_b64_tr_b16 v[30:31], v4 offset:8928
    s_waitcnt lgkmcnt(4)
    v_mfma_f32_32x32x16_bf16 v[32:47], v[16:19], v[212:215], v[32:47]
    s_barrier
    ds_read_b64_tr_b16 v[12:13], v3 offset:34816
    ds_read_b64_tr_b16 v[14:15], v3 offset:34944
    v_mfma_f32_32x32x16_bf16 v[48:63], v[20:23], v[212:215], v[48:63]
    ds_read_b64_tr_b16 v[16:17], v3 offset:34848
    ds_read_b64_tr_b16 v[18:19], v3 offset:34976
    v_mov_b32 v128, 0
    v_mov_b32 v129, 0
    v_mov_b32 v130, 0
    s_waitcnt lgkmcnt(4)
    v_mfma_f32_32x32x16_bf16 v[96:111], v[24:27], v[192:195], v[96:111]
    ds_read_b64_tr_b16 v[20:21], v4 offset:9280
    ds_read_b64_tr_b16 v[22:23], v4 offset:9408
    v_mov_b32 v131, 0
    v_mov_b32 v132, 0
    v_mov_b32 v133, 0
    v_mfma_f32_32x32x16_bf16 v[112:127], v[28:31], v[192:195], v[112:127]
    ds_read_b64_tr_b16 v[24:25], v4 offset:9312
    ds_read_b64_tr_b16 v[26:27], v4 offset:9440
    v_mov_b32 v134, 0
    v_mov_b32 v135, 0
    v_mov_b32 v136, 0
    s_waitcnt lgkmcnt(4)
    v_mfma_f32_32x32x16_bf16 v[32:47], v[12:15], v[216:219], v[32:47]
    ds_read_b64_tr_b16 v[28:29], v3 offset:35328
    ds_read_b64_tr_b16 v[30:31], v3 offset:35456
    v_mov_b32 v137, 0
    v_mov_b32 v138, 0
    v_mov_b32 v139, 0
    v_mfma_f32_32x32x16_bf16 v[48:63], v[16:19], v[216:219], v[48:63]
    ds_read_b64_tr_b16 v[12:13], v3 offset:35360
    ds_read_b64_tr_b16 v[14:15], v3 offset:35488
    v_mov_b32 v140, 0
    v_mov_b32 v141, 0
    v_mov_b32 v142, 0
    v_mov_b32 v143, 0
    s_waitcnt lgkmcnt(4)
    v_mfma_f32_32x32x16_bf16 v[96:111], v[20:23], v[196:199], v[96:111]
    ds_read_b64_tr_b16 v[16:17], v4 offset:17472
    ds_read_b64_tr_b16 v[18:19], v4 offset:17600
    v_mov_b32 v144, 0
    v_mov_b32 v145, 0
    v_mfma_f32_32x32x16_bf16 v[112:127], v[24:27], v[196:199], v[112:127]
    ds_read_b64_tr_b16 v[20:21], v4 offset:17504
    ds_read_b64_tr_b16 v[22:23], v4 offset:17632
    v_mov_b32 v146, 0
    v_mov_b32 v147, 0
    v_mov_b32 v148, 0
    v_mov_b32 v149, 0
    s_waitcnt lgkmcnt(4)
    v_mfma_f32_32x32x16_bf16 v[32:47], v[28:31], v[220:223], v[32:47]
    s_barrier
    ds_read_b64_tr_b16 v[24:25], v3 offset:43520
    ds_read_b64_tr_b16 v[26:27], v3 offset:43648
    v_mfma_f32_32x32x16_bf16 v[48:63], v[12:15], v[220:223], v[48:63]
    ds_read_b64_tr_b16 v[28:29], v3 offset:43552
    ds_read_b64_tr_b16 v[30:31], v3 offset:43680
    v_mov_b32 v150, 0
    v_mov_b32 v151, 0
    v_mov_b32 v152, 0
    s_waitcnt lgkmcnt(4)
    v_mfma_f32_32x32x16_bf16 v[96:111], v[16:19], v[200:203], v[96:111]
    ds_read_b64_tr_b16 v[12:13], v4 offset:17984
    ds_read_b64_tr_b16 v[14:15], v4 offset:18112
    v_mov_b32 v153, 0
    v_mov_b32 v154, 0
    v_mov_b32 v155, 0
    v_mfma_f32_32x32x16_bf16 v[112:127], v[20:23], v[200:203], v[112:127]
    ds_read_b64_tr_b16 v[16:17], v4 offset:18016
    ds_read_b64_tr_b16 v[18:19], v4 offset:18144
    v_mov_b32 v156, 0
    v_mov_b32 v157, 0
    v_mov_b32 v158, 0
    v_mov_b32 v159, 0
    s_waitcnt lgkmcnt(4)
    v_mfma_f32_32x32x16_bf16 v[32:47], v[24:27], v[224:227], v[32:47]
    ds_read_b64_tr_b16 v[20:21], v3 offset:44032
    ds_read_b64_tr_b16 v[22:23], v3 offset:44160
    v_mov_b32 v168, 0
    v_mov_b32 v169, 0
    v_mfma_f32_32x32x16_bf16 v[48:63], v[28:31], v[224:227], v[48:63]
    ds_read_b64_tr_b16 v[24:25], v3 offset:44064
    ds_read_b64_tr_b16 v[26:27], v3 offset:44192
    v_mov_b32 v170, 0
    v_mov_b32 v171, 0
    v_mov_b32 v172, 0
    v_mov_b32 v173, 0
    s_waitcnt lgkmcnt(4)
    v_mfma_f32_32x32x16_bf16 v[96:111], v[12:15], v[204:207], v[96:111]
    ds_read_b64_tr_b16 v[28:29], v4 offset:26176
    ds_read_b64_tr_b16 v[30:31], v4 offset:26304
    v_mov_b32 v174, 0
    v_mov_b32 v175, 0
    v_mfma_f32_32x32x16_bf16 v[112:127], v[16:19], v[204:207], v[112:127]
    ds_read_b64_tr_b16 v[12:13], v4 offset:26208
    ds_read_b64_tr_b16 v[14:15], v4 offset:26336
    v_and_b32 v7, 51, v0
    v_and_b32 v10, 4, v0
    v_lshl_add_u32 v7, v10, 1, v7
    v_and_b32 v10, 8, v0
    s_waitcnt lgkmcnt(4)
    v_mfma_f32_32x32x16_bf16 v[32:47], v[20:23], v[228:231], v[32:47]
    s_barrier
    ds_read_b64_tr_b16 v[16:17], v3 offset:52224
    ds_read_b64_tr_b16 v[18:19], v3 offset:52352
    v_mfma_f32_32x32x16_bf16 v[48:63], v[24:27], v[228:231], v[48:63]
    ds_read_b64_tr_b16 v[20:21], v3 offset:52256
    ds_read_b64_tr_b16 v[22:23], v3 offset:52384
    v_lshrrev_b32 v10, 1, v10
    v_add_lshl_u32 v7, v7, v10, 4
    v_lshrrev_b32 v10, 5, v0
    v_lshlrev_b32 v10, 8, v10
    s_waitcnt lgkmcnt(4)
    v_mfma_f32_32x32x16_bf16 v[96:111], v[28:31], v[208:211], v[96:111]
    ds_read_b64_tr_b16 v[24:25], v4 offset:26688
    ds_read_b64_tr_b16 v[26:27], v4 offset:26816
    v_and_b32 v8, 15, v0
    v_lshl_add_u32 v10, v8, 4, v10
    v_mfma_f32_32x32x16_bf16 v[112:127], v[12:15], v[208:211], v[112:127]
    ds_read_b64_tr_b16 v[28:29], v4 offset:26720
    ds_read_b64_tr_b16 v[30:31], v4 offset:26848
    v_add_u32 v8, 1024, v10
    v_add_u32 v9, 1536, v10
    v_and_b32 v10, 27, v0
    v_cmp_eq_u32 vcc, 16, v10
    s_waitcnt lgkmcnt(4)
    v_mfma_f32_32x32x16_bf16 v[32:47], v[16:19], v[232:235], v[32:47]
    ds_read_b64_tr_b16 v[12:13], v3 offset:52736
    ds_read_b64_tr_b16 v[14:15], v3 offset:52864
    v_mov_b32 v10, 2064
    v_mov_b32 v11, 2048
    v_mfma_f32_32x32x16_bf16 v[48:63], v[20:23], v[232:235], v[48:63]
    ds_read_b64_tr_b16 v[16:17], v3 offset:52768
    ds_read_b64_tr_b16 v[18:19], v3 offset:52896
    v_cndmask_b32 v10, v10, v11, vcc
    v_and_b32 v11, 16, v0
    v_cmp_eq_u32 vcc, 0, v11
    s_nop 0
    s_waitcnt lgkmcnt(4)
    v_mfma_f32_32x32x16_bf16 v[96:111], v[24:27], v[212:215], v[96:111]
    ds_read_b64_tr_b16 v[20:21], v4 offset:34880
    ds_read_b64_tr_b16 v[22:23], v4 offset:35008
    s_nop 0
    v_cndmask_b32 v8, v10, v8, vcc
    v_cndmask_b32 v9, v10, v9, vcc
    v_mfma_f32_32x32x16_bf16 v[112:127], v[28:31], v[212:215], v[112:127]
    ds_read_b64_tr_b16 v[24:25], v4 offset:34912
    ds_read_b64_tr_b16 v[26:27], v4 offset:35040
    v_add_u32 v3, 60928, v3
    s_lshl_b32 s57, s58, 4
    s_add_u32 s57, s57, s51
    s_waitcnt lgkmcnt(4)
    v_mfma_f32_32x32x16_bf16 v[32:47], v[12:15], v[236:239], v[32:47]
    ds_read_b64_tr_b16 v[28:29], v3 offset:0
    ds_read_b64_tr_b16 v[30:31], v3 offset:128
    s_lshl_b32 s57, s57, 7
    s_add_u32 s57, s57, 16908288
    s_add_u32 s32, s22, s57
    s_addc_u32 s33, s23, 0
    v_mfma_f32_32x32x16_bf16 v[48:63], v[16:19], v[236:239], v[48:63]
    ds_read_b64_tr_b16 v[12:13], v3 offset:32
    ds_read_b64_tr_b16 v[14:15], v3 offset:160
    s_lshl_b32 s70, s54, 6
    s_lshl_b32 s57, s55, 3
    s_add_u32 s70, s70, s57
    s_waitcnt lgkmcnt(4)
    v_mfma_f32_32x32x16_bf16 v[96:111], v[20:23], v[216:219], v[96:111]
    ds_read_b64_tr_b16 v[16:17], v4 offset:35392
    ds_read_b64_tr_b16 v[18:19], v4 offset:35520
    s_lshl_b32 s57, s56, 1
    s_add_u32 s70, s70, s57
    s_lshl_b32 s70, s70, 10
    v_mfma_f32_32x32x16_bf16 v[112:127], v[24:27], v[216:219], v[112:127]
    ds_read_b64_tr_b16 v[20:21], v4 offset:35424
    ds_read_b64_tr_b16 v[22:23], v4 offset:35552
    s_add_u32 s70, s70, 4194304
    s_lshl_b32 s57, s55, 2
    s_add_u32 s57, s57, s56
    s_lshl_b32 s10, s57, 6
    s_waitcnt lgkmcnt(4)
    v_mfma_f32_32x32x16_bf16 v[32:47], v[28:31], v[240:243], v[32:47]
    ds_read_b64_tr_b16 v[24:25], v3 offset:512
    ds_read_b64_tr_b16 v[26:27], v3 offset:640
    s_add_u32 s10, s10, s54
    s_lshl_b32 s10, s10, 10
    v_mfma_f32_32x32x16_bf16 v[48:63], v[12:15], v[240:243], v[48:63]
    ds_read_b64_tr_b16 v[28:29], v3 offset:544
    ds_read_b64_tr_b16 v[30:31], v3 offset:672
    s_add_u32 s10, s10, 6291456
    s_add_u32 s11, s10, 32768
    s_lshl_b32 s57, s57, 5
    s_add_u32 s57, s57, s54
    s_waitcnt lgkmcnt(4)
    v_mfma_f32_32x32x16_bf16 v[96:111], v[16:19], v[220:223], v[96:111]
    ds_read_b64_tr_b16 v[12:13], v4 offset:43584
    ds_read_b64_tr_b16 v[14:15], v4 offset:43712
    s_lshl_b32 s57, s57, 7
    s_add_u32 s57, s57, 17039360
    v_mfma_f32_32x32x16_bf16 v[112:127], v[20:23], v[220:223], v[112:127]
    ds_read_b64_tr_b16 v[16:17], v4 offset:43616
    ds_read_b64_tr_b16 v[18:19], v4 offset:43744
    s_add_u32 s36, s22, s57
    s_addc_u32 s37, s23, 0
    s_mov_b32 s38, 4
    s_mov_b32 s39, 0x00020000
    s_mov_b32 s63, 0x7e800000
    s_waitcnt lgkmcnt(4)
    v_mfma_f32_32x32x16_bf16 v[32:47], v[24:27], v[244:247], v[32:47]
    ds_read_b64_tr_b16 v[20:21], v3 offset:8704
    ds_read_b64_tr_b16 v[22:23], v3 offset:8832
    s_mov_b32 s64, 0xd800000
    v_mfma_f32_32x32x16_bf16 v[48:63], v[28:31], v[244:247], v[48:63]
    ds_read_b64_tr_b16 v[24:25], v3 offset:8736
    ds_read_b64_tr_b16 v[26:27], v3 offset:8864
    s_waitcnt lgkmcnt(4)
    v_mfma_f32_32x32x16_bf16 v[96:111], v[12:15], v[224:227], v[96:111]
    ds_read_b64_tr_b16 v[28:29], v4 offset:44096
    ds_read_b64_tr_b16 v[30:31], v4 offset:44224
    v_mfma_f32_32x32x16_bf16 v[112:127], v[16:19], v[224:227], v[112:127]
    ds_read_b64_tr_b16 v[12:13], v4 offset:44128
    ds_read_b64_tr_b16 v[14:15], v4 offset:44256
    s_waitcnt lgkmcnt(4)
    v_mfma_f32_32x32x16_bf16 v[32:47], v[20:23], v[248:251], v[32:47]
    ds_read_b64_tr_b16 v[16:17], v3 offset:9216
    ds_read_b64_tr_b16 v[18:19], v3 offset:9344
    v_mfma_f32_32x32x16_bf16 v[48:63], v[24:27], v[248:251], v[48:63]
    ds_read_b64_tr_b16 v[20:21], v3 offset:9248
    ds_read_b64_tr_b16 v[22:23], v3 offset:9376
    s_waitcnt lgkmcnt(4)
    v_mfma_f32_32x32x16_bf16 v[96:111], v[28:31], v[228:231], v[96:111]
    ds_read_b64_tr_b16 v[24:25], v4 offset:52288
    ds_read_b64_tr_b16 v[26:27], v4 offset:52416
    v_mfma_f32_32x32x16_bf16 v[112:127], v[12:15], v[228:231], v[112:127]
    ds_read_b64_tr_b16 v[28:29], v4 offset:52320
    ds_read_b64_tr_b16 v[30:31], v4 offset:52448
    s_waitcnt lgkmcnt(4)
    v_mfma_f32_32x32x16_bf16 v[32:47], v[16:19], v[252:255], v[32:47]
    ds_read_b64_tr_b16 v[12:13], v4 offset:52800
    ds_read_b64_tr_b16 v[14:15], v4 offset:52928
    v_mfma_f32_32x32x16_bf16 v[48:63], v[20:23], v[252:255], v[48:63]
    ds_read_b64_tr_b16 v[16:17], v4 offset:52832
    ds_read_b64_tr_b16 v[18:19], v4 offset:52960
    v_add_u32 v4, 60928, v4
    s_waitcnt lgkmcnt(4)
    v_mfma_f32_32x32x16_bf16 v[96:111], v[24:27], v[232:235], v[96:111]
    ds_read_b64_tr_b16 v[20:21], v4 offset:64
    ds_read_b64_tr_b16 v[22:23], v4 offset:192
    v_mfma_f32_32x32x16_bf16 v[112:127], v[28:31], v[232:235], v[112:127]
    ds_read_b64_tr_b16 v[24:25], v4 offset:96
    ds_read_b64_tr_b16 v[26:27], v4 offset:224
    s_waitcnt lgkmcnt(4)
    v_mfma_f32_32x32x16_bf16 v[96:111], v[12:15], v[236:239], v[96:111]
    ds_read_b64_tr_b16 v[28:29], v4 offset:576
    ds_read_b64_tr_b16 v[30:31], v4 offset:704
    v_mfma_f32_32x32x16_bf16 v[112:127], v[16:19], v[236:239], v[112:127]
    ds_read_b64_tr_b16 v[12:13], v4 offset:608
    ds_read_b64_tr_b16 v[14:15], v4 offset:736
    v_mul_f32 v40, v32, v40
    v_mul_f32 v41, v33, v41
    v_exp_f32 v32, -v32
    s_waitcnt lgkmcnt(4)
    v_mfma_f32_32x32x16_bf16 v[96:111], v[20:23], v[240:243], v[96:111]
    ds_read_b64_tr_b16 v[16:17], v4 offset:8768
    ds_read_b64_tr_b16 v[18:19], v4 offset:8896
    v_exp_f32 v33, -v33
    v_add_f32 v32, 1.0, v32
    v_add_f32 v33, 1.0, v33
    v_mfma_f32_32x32x16_bf16 v[112:127], v[24:27], v[240:243], v[112:127]
    ds_read_b64_tr_b16 v[20:21], v4 offset:8800
    ds_read_b64_tr_b16 v[22:23], v4 offset:8928
    v_rcp_f32 v32, v32
    v_rcp_f32 v33, v33
    s_waitcnt lgkmcnt(4)
    v_mfma_f32_32x32x16_bf16 v[96:111], v[28:31], v[244:247], v[96:111]
    ds_read_b64_tr_b16 v[24:25], v4 offset:9280
    ds_read_b64_tr_b16 v[26:27], v4 offset:9408
    v_mul_f32 v32, v32, v40
    v_mul_f32 v33, v33, v41
    v_cvt_pk_bf16_f32 v40, v32, v33
    v_mul_f32 v42, v34, v42
    v_mfma_f32_32x32x16_bf16 v[112:127], v[12:15], v[244:247], v[112:127]
    ds_read_b64_tr_b16 v[28:29], v4 offset:9312
    ds_read_b64_tr_b16 v[30:31], v4 offset:9440
    v_mul_f32 v43, v35, v43
    v_exp_f32 v34, -v34
    s_waitcnt lgkmcnt(4)
    v_mfma_f32_32x32x16_bf16 v[96:111], v[16:19], v[248:251], v[96:111]
    v_exp_f32 v35, -v35
    v_add_f32 v34, 1.0, v34
    v_add_f32 v35, 1.0, v35
    v_mfma_f32_32x32x16_bf16 v[112:127], v[20:23], v[248:251], v[112:127]
    v_rcp_f32 v34, v34
    v_rcp_f32 v35, v35
    v_mul_f32 v34, v34, v42
    s_waitcnt lgkmcnt(0)
    v_mfma_f32_32x32x16_bf16 v[96:111], v[24:27], v[252:255], v[96:111]
    v_mul_f32 v35, v35, v43
    v_cvt_pk_bf16_f32 v41, v34, v35
    v_mul_f32 v44, v36, v44
    v_mfma_f32_32x32x16_bf16 v[112:127], v[28:31], v[252:255], v[112:127]
    v_mul_f32 v45, v37, v45
    v_exp_f32 v36, -v36
    v_exp_f32 v37, -v37
    s_barrier
    buffer_load_dwordx4 v[200:203], v1, s[24:27], s70 offen sc1
    buffer_load_dwordx4 v[204:207], v1, s[24:27], s70 offen offset:1024 sc1
L_tail:
    s_nop 7
    v_add_f32 v36, 1.0, v36
    v_add_f32 v37, 1.0, v37
    v_rcp_f32 v36, v36
    v_rcp_f32 v37, v37
    v_mul_f32 v36, v36, v44
    v_mul_f32 v37, v37, v45
    v_cvt_pk_bf16_f32 v42, v36, v37
    v_mul_f32 v46, v38, v46
    v_mul_f32 v47, v39, v47
    v_exp_f32 v38, -v38
    v_exp_f32 v39, -v39
    v_add_f32 v38, 1.0, v38
    v_add_f32 v39, 1.0, v39
    v_rcp_f32 v38, v38
    v_rcp_f32 v39, v39
    v_mul_f32 v38, v38, v46
    v_mul_f32 v39, v39, v47
    v_cvt_pk_bf16_f32 v43, v38, v39
    buffer_store_dwordx4 v[40:43], v1, s[24:27], s62 offen offset:0 sc1
    v_mul_f32 v56, v48, v56
    v_mul_f32 v57, v49, v57
    v_exp_f32 v48, -v48
    v_exp_f32 v49, -v49
    v_add_f32 v48, 1.0, v48
    v_add_f32 v49, 1.0, v49
    v_rcp_f32 v48, v48
    v_rcp_f32 v49, v49
    v_mul_f32 v48, v48, v56
    v_mul_f32 v49, v49, v57
    v_cvt_pk_bf16_f32 v56, v48, v49
    v_mul_f32 v58, v50, v58
    v_mul_f32 v59, v51, v59
    v_exp_f32 v50, -v50
    v_exp_f32 v51, -v51
    v_add_f32 v50, 1.0, v50
    v_add_f32 v51, 1.0, v51
    v_rcp_f32 v50, v50
    v_rcp_f32 v51, v51
    v_mul_f32 v50, v50, v58
    v_mul_f32 v51, v51, v59
    v_cvt_pk_bf16_f32 v57, v50, v51
    v_mul_f32 v60, v52, v60
    v_mul_f32 v61, v53, v61
    v_exp_f32 v52, -v52
    v_exp_f32 v53, -v53
    v_add_f32 v52, 1.0, v52
    v_add_f32 v53, 1.0, v53
    v_rcp_f32 v52, v52
    v_rcp_f32 v53, v53
    v_mul_f32 v52, v52, v60
    v_mul_f32 v53, v53, v61
    v_cvt_pk_bf16_f32 v58, v52, v53
    v_mul_f32 v62, v54, v62
    v_mul_f32 v63, v55, v63
    v_exp_f32 v54, -v54
    v_exp_f32 v55, -v55
    v_add_f32 v54, 1.0, v54
    v_add_f32 v55, 1.0, v55
    v_rcp_f32 v54, v54
    v_rcp_f32 v55, v55
    v_mul_f32 v54, v54, v62
    v_mul_f32 v55, v55, v63
    v_cvt_pk_bf16_f32 v59, v54, v55
    buffer_store_dwordx4 v[56:59], v1, s[24:27], s62 offen offset:1024 sc1
    v_mul_f32 v104, v96, v104
    v_mul_f32 v105, v97, v105
    v_exp_f32 v96, -v96
    v_exp_f32 v97, -v97
    v_add_f32 v96, 1.0, v96
    v_add_f32 v97, 1.0, v97
    v_rcp_f32 v96, v96
    v_rcp_f32 v97, v97
    v_mul_f32 v96, v96, v104
    v_mul_f32 v97, v97, v105
    v_cvt_pk_bf16_f32 v104, v96, v97
    v_mul_f32 v106, v98, v106
    v_mul_f32 v107, v99, v107
    v_exp_f32 v98, -v98
    v_exp_f32 v99, -v99
    v_add_f32 v98, 1.0, v98
    v_add_f32 v99, 1.0, v99
    v_rcp_f32 v98, v98
    v_rcp_f32 v99, v99
    v_mul_f32 v98, v98, v106
    v_mul_f32 v99, v99, v107
    v_cvt_pk_bf16_f32 v105, v98, v99
    v_mul_f32 v108, v100, v108
    v_mul_f32 v109, v101, v109
    v_exp_f32 v100, -v100
    v_exp_f32 v101, -v101
    v_add_f32 v100, 1.0, v100
    v_add_f32 v101, 1.0, v101
    v_rcp_f32 v100, v100
    v_rcp_f32 v101, v101
    v_mul_f32 v100, v100, v108
    v_mul_f32 v101, v101, v109
    v_cvt_pk_bf16_f32 v106, v100, v101
    v_mul_f32 v110, v102, v110
    v_mul_f32 v111, v103, v111
    v_exp_f32 v102, -v102
    v_exp_f32 v103, -v103
    v_add_f32 v102, 1.0, v102
    v_add_f32 v103, 1.0, v103
    v_rcp_f32 v102, v102
    v_rcp_f32 v103, v103
    v_mul_f32 v102, v102, v110
    v_mul_f32 v103, v103, v111
    v_cvt_pk_bf16_f32 v107, v102, v103
    buffer_store_dwordx4 v[104:107], v1, s[24:27], s62 offen offset:2048 sc1
    s_barrier
    ds_read_b128 v[192:195], v7
    ds_read_b128 v[196:199], v7 offset:2080
    ds_read_b128 v[160:163], v8
    ds_read_b128 v[164:167], v9
    v_mul_f32 v120, v112, v120
    v_mul_f32 v121, v113, v121
    v_exp_f32 v112, -v112
    v_exp_f32 v113, -v113
    v_add_f32 v112, 1.0, v112
    v_add_f32 v113, 1.0, v113
    v_rcp_f32 v112, v112
    v_rcp_f32 v113, v113
    v_mul_f32 v112, v112, v120
    v_mul_f32 v113, v113, v121
    v_cvt_pk_bf16_f32 v120, v112, v113
    s_waitcnt vmcnt(3)
    s_waitcnt lgkmcnt(0)
    v_mfma_f32_32x32x16_bf16 v[208:223], v[192:195], v[200:203], 0
    v_mul_f32 v122, v114, v122
    v_mul_f32 v123, v115, v123
    v_exp_f32 v114, -v114
    v_exp_f32 v115, -v115
    v_add_f32 v114, 1.0, v114
    v_mfma_f32_32x32x16_bf16 v[240:255], v[196:199], v[200:203], 0
    v_add_f32 v115, 1.0, v115
    v_rcp_f32 v114, v114
    v_rcp_f32 v115, v115
    v_mul_f32 v114, v114, v122
    v_mul_f32 v115, v115, v123
    v_mfma_f32_32x32x16_bf16 v[224:239], v[192:195], v[204:207], 0
    v_cvt_pk_bf16_f32 v121, v114, v115
    v_mul_f32 v124, v116, v124
    v_mul_f32 v125, v117, v125
    v_exp_f32 v116, -v116
    v_exp_f32 v117, -v117
    v_mfma_f32_32x32x16_bf16 v[64:79], v[196:199], v[204:207], 0
    v_add_f32 v116, 1.0, v116
    v_add_f32 v117, 1.0, v117
    v_rcp_f32 v116, v116
    v_rcp_f32 v117, v117
    v_mul_f32 v116, v116, v124
    v_mul_f32 v117, v117, v125
    v_cvt_pk_bf16_f32 v122, v116, v117
    v_mul_f32 v126, v118, v126
    v_mul_f32 v127, v119, v127
    v_exp_f32 v118, -v118
    v_exp_f32 v119, -v119
    v_add_f32 v118, 1.0, v118
    v_add_f32 v119, 1.0, v119
    v_rcp_f32 v118, v118
    v_rcp_f32 v119, v119
    v_mul_f32 v118, v118, v126
    v_mul_f32 v119, v119, v127
    v_cvt_pk_bf16_f32 v123, v118, v119
    buffer_store_dwordx4 v[120:123], v1, s[24:27], s62 offen offset:3072 sc1
    v_max3_f32 v208, v208, v209, v210
    v_max3_f32 v211, v211, v212, v213
    v_max3_f32 v208, v208, v214, v215
    v_max3_f32 v211, v211, v216, v217
    v_max3_f32 v208, v208, v218, v219
    v_max3_f32 v211, v211, v220, v221
    v_max3_f32 v208, v208, v222, v223
    v_max3_f32 v211, v211, v240, v241
    v_max3_f32 v208, v208, v242, v243
    v_max3_f32 v211, v211, v244, v245
    v_max3_f32 v208, v208, v246, v247
    v_max3_f32 v211, v211, v248, v249
    v_max3_f32 v208, v208, v250, v251
    v_max3_f32 v211, v211, v252, v253
    v_max3_f32 v208, v208, v254, v255
    v_max_f32 v208, v208, v211
    v_mov_b32 v211, v208
    v_max3_f32 v224, v224, v225, v226
    v_max3_f32 v227, v227, v228, v229
    v_max3_f32 v224, v224, v230, v231
    v_max3_f32 v227, v227, v232, v233
    v_max3_f32 v224, v224, v234, v235
    v_max3_f32 v227, v227, v236, v237
    v_max3_f32 v224, v224, v238, v239
    v_max3_f32 v227, v227, v64, v65
    v_max3_f32 v224, v224, v66, v67
    v_max3_f32 v227, v227, v68, v69
    v_max3_f32 v224, v224, v70, v71
    v_max3_f32 v227, v227, v72, v73
    v_max3_f32 v224, v224, v74, v75
    v_max3_f32 v227, v227, v76, v77
    v_max3_f32 v224, v224, v78, v79
    v_max_f32 v224, v224, v227
    v_mov_b32 v227, v224
    v_permlane32_swap_b32 v208, v211
    s_nop 0
    v_permlane32_swap_b32 v224, v227
    s_mov_b32 s57, 0xc2a00000
    v_max_f32 v208, v208, v211
    v_sub_f32 v240, s57, v208
    v_max_f32 v224, v224, v227
    v_sub_f32 v64, s57, v224
    v_mov_b32 v241, v240
    v_mov_b32 v242, v240
    v_mov_b32 v243, v240
    v_mov_b32 v244, v240
    v_mov_b32 v245, v240
    v_mov_b32 v246, v240
    v_mov_b32 v247, v240
    v_mov_b32 v248, v240
    v_mov_b32 v249, v240
    v_mov_b32 v250, v240
    v_mov_b32 v251, v240
    v_mov_b32 v252, v240
    v_mov_b32 v253, v240
    v_mov_b32 v254, v240
    v_mov_b32 v255, v240
    s_nop 1
    v_mfma_f32_32x32x16_bf16 v[208:223], v[192:195], v[200:203], v[240:255]
    v_mov_b32 v65, v64
    v_mov_b32 v66, v64
    v_mov_b32 v67, v64
    v_mov_b32 v68, v64
    v_mov_b32 v69, v64
    v_mov_b32 v70, v64
    v_mov_b32 v71, v64
    v_mov_b32 v72, v64
    v_mov_b32 v73, v64
    v_mov_b32 v74, v64
    v_mov_b32 v75, v64
    v_mov_b32 v76, v64
    v_mov_b32 v77, v64
    v_mov_b32 v78, v64
    v_mov_b32 v79, v64
    s_mov_b32 s68, 0
    v_mov_b32 v10, 1
    v_mov_b32 v11, 0xdddddddd
    s_branch L_att
.p2align 6
L_att_bar:
    s_barrier
L_att:
    v_exp_f32 v208, v208
    v_exp_f32 v209, v209
    v_smfmac_f32_32x32x32_bf16 v[144:159], v[172:175], v[232:239], v11
    v_exp_f32 v210, v210
    v_exp_f32 v211, v211
    v_exp_f32 v212, v212
    v_mfma_f32_32x32x16_bf16 v[224:239], v[192:195], v[204:207], v[64:79]
    ds_read_b128 v[196:199], v7 offset:2080
    ds_read_b128 v[168:171], v8 offset:2080
    ds_read_b128 v[172:175], v9 offset:2080
    v_exp_f32 v213, v213
    v_exp_f32 v214, v214
    v_exp_f32 v215, v215
    v_exp_f32 v216, v216
    v_exp_f32 v217, v217
    v_smfmac_f32_32x32x32_bf16 v[128:143], v[160:163], v[208:215], v11
    v_exp_f32 v218, v218
    v_exp_f32 v219, v219
    v_exp_f32 v220, v220
    v_exp_f32 v221, v221
    v_exp_f32 v222, v222
    v_exp_f32 v223, v223
    v_exp_f32 v224, v224
    v_exp_f32 v225, v225
    v_smfmac_f32_32x32x32_bf16 v[128:143], v[164:167], v[216:223], v11
    v_exp_f32 v226, v226
    v_exp_f32 v227, v227
    v_exp_f32 v228, v228
    s_waitcnt lgkmcnt(0)
    v_mfma_f32_32x32x16_bf16 v[208:223], v[196:199], v[200:203], v[240:255]
    v_exp_f32 v229, v229
    v_exp_f32 v230, v230
    v_exp_f32 v231, v231
    v_exp_f32 v232, v232
    v_exp_f32 v233, v233
    v_smfmac_f32_32x32x32_bf16 v[144:159], v[160:163], v[224:231], v11
    v_exp_f32 v234, v234
    v_exp_f32 v235, v235
    v_exp_f32 v236, v236
    v_exp_f32 v237, v237
    v_exp_f32 v238, v238
    v_exp_f32 v239, v239
    v_exp_f32 v208, v208
    v_exp_f32 v209, v209
    v_smfmac_f32_32x32x32_bf16 v[144:159], v[164:167], v[232:239], v11
    v_exp_f32 v210, v210
    v_exp_f32 v211, v211
    v_exp_f32 v212, v212
    v_mfma_f32_32x32x16_bf16 v[224:239], v[196:199], v[204:207], v[64:79]
    ds_read_b128 v[192:195], v7 offset:4160
    ds_read_b128 v[160:163], v8 offset:4160
    ds_read_b128 v[164:167], v9 offset:4160
    v_exp_f32 v213, v213
    v_exp_f32 v214, v214
    v_exp_f32 v215, v215
    v_exp_f32 v216, v216
    v_exp_f32 v217, v217
    v_smfmac_f32_32x32x32_bf16 v[128:143], v[168:171], v[208:215], v11
    s_waitcnt vmcnt(0)
    buffer_store_dword v10, v1, s[32:35], 0 offen sc1
    s_mov_b32 s34, 0
    v_exp_f32 v218, v218
    v_exp_f32 v219, v219
    v_exp_f32 v220, v220
    v_exp_f32 v221, v221
    v_exp_f32 v222, v222
    v_exp_f32 v223, v223
    v_exp_f32 v224, v224
    v_exp_f32 v225, v225
    v_smfmac_f32_32x32x32_bf16 v[128:143], v[172:175], v[216:223], v11
    v_exp_f32 v226, v226
    v_exp_f32 v227, v227
    v_exp_f32 v228, v228
    s_waitcnt lgkmcnt(0)
    v_mfma_f32_32x32x16_bf16 v[208:223], v[192:195], v[200:203], v[240:255]
    v_exp_f32 v229, v229
    v_exp_f32 v230, v230
    v_exp_f32 v231, v231
    v_exp_f32 v232, v232
    v_exp_f32 v233, v233
    v_smfmac_f32_32x32x32_bf16 v[144:159], v[168:171], v[224:231], v11
    v_exp_f32 v234, v234
    v_exp_f32 v235, v235
    v_exp_f32 v236, v236
    v_exp_f32 v237, v237
    v_exp_f32 v238, v238
    v_exp_f32 v239, v239
    v_exp_f32 v208, v208
    v_exp_f32 v209, v209
    v_smfmac_f32_32x32x32_bf16 v[144:159], v[172:175], v[232:239], v11
    v_exp_f32 v210, v210
    v_exp_f32 v211, v211
    v_exp_f32 v212, v212
    v_mfma_f32_32x32x16_bf16 v[224:239], v[192:195], v[204:207], v[64:79]
    ds_read_b128 v[196:199], v7 offset:6240
    ds_read_b128 v[168:171], v8 offset:6240
    ds_read_b128 v[172:175], v9 offset:6240
    v_exp_f32 v213, v213
    v_exp_f32 v214, v214
    v_exp_f32 v215, v215
    v_exp_f32 v216, v216
    v_exp_f32 v217, v217
    v_smfmac_f32_32x32x32_bf16 v[128:143], v[160:163], v[208:215], v11
    v_exp_f32 v218, v218
    v_exp_f32 v219, v219
    v_exp_f32 v220, v220
    v_exp_f32 v221, v221
    v_exp_f32 v222, v222
    v_exp_f32 v223, v223
    v_exp_f32 v224, v224
    v_exp_f32 v225, v225
    v_smfmac_f32_32x32x32_bf16 v[128:143], v[164:167], v[216:223], v11
    v_exp_f32 v226, v226
    v_exp_f32 v227, v227
    v_exp_f32 v228, v228
    s_waitcnt lgkmcnt(0)
    v_mfma_f32_32x32x16_bf16 v[208:223], v[196:199], v[200:203], v[240:255]
    v_exp_f32 v229, v229
    v_exp_f32 v230, v230
    v_exp_f32 v231, v231
    v_exp_f32 v232, v232
    v_exp_f32 v233, v233
    v_smfmac_f32_32x32x32_bf16 v[144:159], v[160:163], v[224:231], v11
    v_exp_f32 v234, v234
    v_exp_f32 v235, v235
    v_exp_f32 v236, v236
    v_exp_f32 v237, v237
    v_exp_f32 v238, v238
    v_exp_f32 v239, v239
    v_exp_f32 v208, v208
    v_exp_f32 v209, v209
    v_smfmac_f32_32x32x32_bf16 v[144:159], v[164:167], v[232:239], v11
    v_exp_f32 v210, v210
    v_exp_f32 v211, v211
    v_exp_f32 v212, v212
    v_mfma_f32_32x32x16_bf16 v[224:239], v[196:199], v[204:207], v[64:79]
    ds_read_b128 v[192:195], v7 offset:8320
    ds_read_b128 v[160:163], v8 offset:8320
    ds_read_b128 v[164:167], v9 offset:8320
    v_exp_f32 v213, v213
    v_exp_f32 v214, v214
    v_exp_f32 v215, v215
    v_exp_f32 v216, v216
    v_exp_f32 v217, v217
    v_smfmac_f32_32x32x32_bf16 v[128:143], v[168:171], v[208:215], v11
    v_exp_f32 v218, v218
    v_exp_f32 v219, v219
    v_exp_f32 v220, v220
    v_exp_f32 v221, v221
    v_exp_f32 v222, v222
    v_exp_f32 v223, v223
    v_exp_f32 v224, v224
    v_exp_f32 v225, v225
    v_smfmac_f32_32x32x32_bf16 v[128:143], v[172:175], v[216:223], v11
    v_exp_f32 v226, v226
    v_exp_f32 v227, v227
    v_exp_f32 v228, v228
    s_waitcnt lgkmcnt(0)
    v_mfma_f32_32x32x16_bf16 v[208:223], v[192:195], v[200:203], v[240:255]
    v_exp_f32 v229, v229
    v_exp_f32 v230, v230
    v_exp_f32 v231, v231
    v_exp_f32 v232, v232
    v_exp_f32 v233, v233
    v_smfmac_f32_32x32x32_bf16 v[144:159], v[168:171], v[224:231], v11
    v_exp_f32 v234, v234
    v_exp_f32 v235, v235
    v_exp_f32 v236, v236
    v_exp_f32 v237, v237
    v_exp_f32 v238, v238
    v_exp_f32 v239, v239
    v_exp_f32 v208, v208
    v_exp_f32 v209, v209
    v_smfmac_f32_32x32x32_bf16 v[144:159], v[172:175], v[232:239], v11
    v_exp_f32 v210, v210
    v_exp_f32 v211, v211
    v_exp_f32 v212, v212
    v_mfma_f32_32x32x16_bf16 v[224:239], v[192:195], v[204:207], v[64:79]
    ds_read_b128 v[196:199], v7 offset:10400
    ds_read_b128 v[168:171], v8 offset:10400
    ds_read_b128 v[172:175], v9 offset:10400
    v_exp_f32 v213, v213
    v_exp_f32 v214, v214
    v_exp_f32 v215, v215
    v_exp_f32 v216, v216
    v_exp_f32 v217, v217
    v_smfmac_f32_32x32x32_bf16 v[128:143], v[160:163], v[208:215], v11
    v_exp_f32 v218, v218
    v_exp_f32 v219, v219
    v_exp_f32 v220, v220
    v_exp_f32 v221, v221
    v_exp_f32 v222, v222
    v_exp_f32 v223, v223
    v_exp_f32 v224, v224
    v_exp_f32 v225, v225
    v_smfmac_f32_32x32x32_bf16 v[128:143], v[164:167], v[216:223], v11
    v_exp_f32 v226, v226
    v_exp_f32 v227, v227
    v_exp_f32 v228, v228
    s_waitcnt lgkmcnt(0)
    v_mfma_f32_32x32x16_bf16 v[208:223], v[196:199], v[200:203], v[240:255]
    v_exp_f32 v229, v229
    v_exp_f32 v230, v230
    v_exp_f32 v231, v231
    v_exp_f32 v232, v232
    v_exp_f32 v233, v233
    v_smfmac_f32_32x32x32_bf16 v[144:159], v[160:163], v[224:231], v11
    v_exp_f32 v234, v234
    v_exp_f32 v235, v235
    v_exp_f32 v236, v236
    v_exp_f32 v237, v237
    v_exp_f32 v238, v238
    v_exp_f32 v239, v239
    v_exp_f32 v208, v208
    v_exp_f32 v209, v209
    v_smfmac_f32_32x32x32_bf16 v[144:159], v[164:167], v[232:239], v11
    v_exp_f32 v210, v210
    v_exp_f32 v211, v211
    v_exp_f32 v212, v212
    v_mfma_f32_32x32x16_bf16 v[224:239], v[196:199], v[204:207], v[64:79]
    ds_read_b128 v[192:195], v7 offset:12480
    ds_read_b128 v[160:163], v8 offset:12480
    ds_read_b128 v[164:167], v9 offset:12480
    v_exp_f32 v213, v213
    v_exp_f32 v214, v214
    v_exp_f32 v215, v215
    v_exp_f32 v216, v216
    v_exp_f32 v217, v217
    v_smfmac_f32_32x32x32_bf16 v[128:143], v[168:171], v[208:215], v11
    v_exp_f32 v218, v218
    v_exp_f32 v219, v219
    v_exp_f32 v220, v220
    v_exp_f32 v221, v221
    v_exp_f32 v222, v222
    v_exp_f32 v223, v223
    v_exp_f32 v224, v224
    v_exp_f32 v225, v225
    v_smfmac_f32_32x32x32_bf16 v[128:143], v[172:175], v[216:223], v11
    v_exp_f32 v226, v226
    v_exp_f32 v227, v227
    v_exp_f32 v228, v228
    s_waitcnt lgkmcnt(0)
    v_mfma_f32_32x32x16_bf16 v[208:223], v[192:195], v[200:203], v[240:255]
    v_exp_f32 v229, v229
    v_exp_f32 v230, v230
    v_exp_f32 v231, v231
    v_exp_f32 v232, v232
    v_exp_f32 v233, v233
    v_smfmac_f32_32x32x32_bf16 v[144:159], v[168:171], v[224:231], v11
    v_exp_f32 v234, v234
    v_exp_f32 v235, v235
    v_exp_f32 v236, v236
    v_exp_f32 v237, v237
    v_exp_f32 v238, v238
    v_exp_f32 v239, v239
    v_exp_f32 v208, v208
    v_exp_f32 v209, v209
    v_smfmac_f32_32x32x32_bf16 v[144:159], v[172:175], v[232:239], v11
    v_exp_f32 v210, v210
    v_exp_f32 v211, v211
    v_exp_f32 v212, v212
    v_mfma_f32_32x32x16_bf16 v[224:239], v[192:195], v[204:207], v[64:79]
    ds_read_b128 v[196:199], v7 offset:14560
    ds_read_b128 v[168:171], v8 offset:14560
    ds_read_b128 v[172:175], v9 offset:14560
    v_exp_f32 v213, v213
    v_exp_f32 v214, v214
    v_exp_f32 v215, v215
    v_exp_f32 v216, v216
    v_exp_f32 v217, v217
    v_smfmac_f32_32x32x32_bf16 v[128:143], v[160:163], v[208:215], v11
    v_exp_f32 v218, v218
    v_exp_f32 v219, v219
    v_exp_f32 v220, v220
    v_exp_f32 v221, v221
    v_exp_f32 v222, v222
    v_exp_f32 v223, v223
    v_exp_f32 v224, v224
    v_exp_f32 v225, v225
    v_smfmac_f32_32x32x32_bf16 v[128:143], v[164:167], v[216:223], v11
    v_exp_f32 v226, v226
    v_exp_f32 v227, v227
    v_exp_f32 v228, v228
    s_waitcnt lgkmcnt(0)
    v_mfma_f32_32x32x16_bf16 v[208:223], v[196:199], v[200:203], v[240:255]
    v_exp_f32 v229, v229
    v_exp_f32 v230, v230
    v_exp_f32 v231, v231
    v_exp_f32 v232, v232
    v_exp_f32 v233, v233
    v_smfmac_f32_32x32x32_bf16 v[144:159], v[160:163], v[224:231], v11
    v_exp_f32 v234, v234
    v_exp_f32 v235, v235
    v_exp_f32 v236, v236
    v_exp_f32 v237, v237
    v_exp_f32 v238, v238
    v_exp_f32 v239, v239
    v_exp_f32 v208, v208
    v_exp_f32 v209, v209
    v_smfmac_f32_32x32x32_bf16 v[144:159], v[164:167], v[232:239], v11
    v_exp_f32 v210, v210
    v_exp_f32 v211, v211
    v_exp_f32 v212, v212
    v_mfma_f32_32x32x16_bf16 v[224:239], v[196:199], v[204:207], v[64:79]
    ds_read_b128 v[192:195], v7 offset:16640
    ds_read_b128 v[160:163], v8 offset:16640
    ds_read_b128 v[164:167], v9 offset:16640
    v_exp_f32 v213, v213
    v_exp_f32 v214, v214
    v_exp_f32 v215, v215
    v_exp_f32 v216, v216
    v_exp_f32 v217, v217
    v_smfmac_f32_32x32x32_bf16 v[128:143], v[168:171], v[208:215], v11
    v_exp_f32 v218, v218
    v_exp_f32 v219, v219
    v_exp_f32 v220, v220
    v_exp_f32 v221, v221
    v_exp_f32 v222, v222
    v_exp_f32 v223, v223
    v_exp_f32 v224, v224
    v_exp_f32 v225, v225
    v_smfmac_f32_32x32x32_bf16 v[128:143], v[172:175], v[216:223], v11
    v_exp_f32 v226, v226
    v_exp_f32 v227, v227
    v_exp_f32 v228, v228
    s_waitcnt lgkmcnt(0)
    v_mfma_f32_32x32x16_bf16 v[208:223], v[192:195], v[200:203], v[240:255]
    v_exp_f32 v229, v229
    v_exp_f32 v230, v230
    v_exp_f32 v231, v231
    v_exp_f32 v232, v232
    v_exp_f32 v233, v233
    v_smfmac_f32_32x32x32_bf16 v[144:159], v[168:171], v[224:231], v11
    v_add_u32 v7, 16640, v7
    v_add_u32 v8, 16640, v8
    v_add_u32 v9, 16640, v9
    v_exp_f32 v234, v234
    v_exp_f32 v235, v235
    v_exp_f32 v236, v236
    v_exp_f32 v237, v237
    v_exp_f32 v238, v238
    v_exp_f32 v239, v239
    s_add_u32 s68, s68, 1
    s_bitcmp1_b32 98, s68
    s_cbranch_scc1 L_att_bar
    s_cmp_lt_u32 s68, 8
    s_cbranch_scc1 L_att
    v_smfmac_f32_32x32x32_bf16 v[144:159], v[172:175], v[232:239], v11
    s_waitcnt lgkmcnt(0)
    buffer_store_dword v10, v1, s[36:39], 0 offen sc1
    v_add_f32 v208, |v128|, |v129|
    v_add_f32 v208, |v130|, v208
    v_add_f32 v208, |v131|, v208
    v_add_f32 v208, |v132|, v208
    v_add_f32 v208, |v133|, v208
    v_add_f32 v208, |v134|, v208
    v_add_f32 v208, |v135|, v208
    v_add_f32 v209, v208, v136
    s_nop 1
    v_add_f32 v210, |v144|, |v145|
    v_add_f32 v210, |v146|, v210
    v_add_f32 v210, |v147|, v210
    v_add_f32 v210, |v148|, v210
    v_add_f32 v210, |v149|, v210
    v_add_f32 v210, |v150|, v210
    v_add_f32 v210, |v151|, v210
    v_add_f32 v211, v210, v152
    v_min_f32 v212, v208, v210
    v_add_f32 v213, v209, v211
    v_cmp_gt_f32 s[74:75], s64, v212
    v_cmp_ngt_f32 vcc, s63, v213
    s_nop 1
    s_or_b64 vcc, vcc, s[74:75]
    s_cbranch_vccnz L_fallback
L_publish:
    v_rcp_f32 v136, v136
    s_nop 0
    v_mul_f32 v128, v128, v136
    v_mul_f32 v129, v129, v136
    v_mul_f32 v130, v130, v136
    v_mul_f32 v131, v131, v136
    v_mul_f32 v132, v132, v136
    v_mul_f32 v133, v133, v136
    v_mul_f32 v134, v134, v136
    v_mul_f32 v135, v135, v136
    v_cvt_pk_bf16_f32 v128, v128, v129
    v_cvt_pk_bf16_f32 v129, v130, v131
    v_cvt_pk_bf16_f32 v130, v132, v133
    v_cvt_pk_bf16_f32 v131, v134, v135
    v_min_u32 v128, -2, v128
    v_min_u32 v129, -2, v129
    v_min_u32 v130, -2, v130
    v_min_u32 v131, -2, v131
    buffer_store_dwordx4 v[128:131], v1, s[24:27], s10 offen sc1
    v_rcp_f32 v152, v152
    s_nop 0
    v_mul_f32 v144, v144, v152
    v_mul_f32 v145, v145, v152
    v_mul_f32 v146, v146, v152
    v_mul_f32 v147, v147, v152
    v_mul_f32 v148, v148, v152
    v_mul_f32 v149, v149, v152
    v_mul_f32 v150, v150, v152
    v_mul_f32 v151, v151, v152
    v_cvt_pk_bf16_f32 v144, v144, v145
    v_cvt_pk_bf16_f32 v145, v146, v147
    v_cvt_pk_bf16_f32 v146, v148, v149
    v_cvt_pk_bf16_f32 v147, v150, v151
    v_min_u32 v144, -2, v144
    v_min_u32 v145, -2, v145
    v_min_u32 v146, -2, v146
    v_min_u32 v147, -2, v147
    buffer_store_dwordx4 v[144:147], v1, s[24:27], s11 offen sc1
    s_barrier
    s_endpgm
L_fallback:
    s_lshl_b32 s65, s54, 17
    v_lshrrev_b32 v11, 5, v0
    v_lshlrev_b32 v11, 8, v11
    v_and_b32 v8, 15, v0
    v_lshl_add_u32 v8, v8, 4, v11
    v_and_b32 v11, 16, v0
    v_cmp_eq_u32 s[74:75], 0, v11
    v_mov_b32 v11, s69
    v_mov_b32 v184, 0xff800000
    s_mov_b32 s61, s65
    s_mov_b32 s66, 64
L_fb_max0:
    buffer_load_dwordx4 v[192:195], v1, s[24:27], s61 offen sc1
    s_waitcnt vmcnt(0)
    v_mfma_f32_32x32x16_bf16 v[208:223], v[192:195], v[200:203], 0
    s_add_u32 s61, s61, 2048
    s_sub_u32 s66, s66, 1
    s_nop 11
    v_max3_f32 v184, v184, v208, v209
    v_max3_f32 v184, v184, v210, v211
    v_max3_f32 v184, v184, v212, v213
    v_max3_f32 v184, v184, v214, v215
    v_max3_f32 v184, v184, v216, v217
    v_max3_f32 v184, v184, v218, v219
    v_max3_f32 v184, v184, v220, v221
    v_max3_f32 v184, v184, v222, v223
    s_cmp_lg_u32 s66, 0
    s_cbranch_scc1 L_fb_max0
    v_mov_b32 v185, v184
    s_nop 1
    v_permlane32_swap_b32 v184, v185
    v_max_f32 v184, v184, v185
    v_sub_f32 v240, 0, v184
    v_mov_b32 v128, 0
    v_sub_f32 v241, 0, v184
    v_mov_b32 v129, 0
    v_sub_f32 v242, 0, v184
    v_mov_b32 v130, 0
    v_sub_f32 v243, 0, v184
    v_mov_b32 v131, 0
    v_sub_f32 v244, 0, v184
    v_mov_b32 v132, 0
    v_sub_f32 v245, 0, v184
    v_mov_b32 v133, 0
    v_sub_f32 v246, 0, v184
    v_mov_b32 v134, 0
    v_sub_f32 v247, 0, v184
    v_mov_b32 v135, 0
    v_sub_f32 v248, 0, v184
    v_mov_b32 v136, 0
    v_sub_f32 v249, 0, v184
    v_mov_b32 v137, 0
    v_sub_f32 v250, 0, v184
    v_mov_b32 v138, 0
    v_sub_f32 v251, 0, v184
    v_mov_b32 v139, 0
    v_sub_f32 v252, 0, v184
    v_mov_b32 v140, 0
    v_sub_f32 v253, 0, v184
    v_mov_b32 v141, 0
    v_sub_f32 v254, 0, v184
    v_mov_b32 v142, 0
    v_sub_f32 v255, 0, v184
    v_mov_b32 v143, 0
    s_mov_b32 s61, s65
    s_mov_b32 s66, 64
L_fb_acc0:
    buffer_load_dwordx4 v[192:195], v1, s[24:27], s61 offen sc1
    buffer_load_dwordx4 v[160:163], v8, s[24:27], s61 offen offset:1024 sc1
    buffer_load_dwordx4 v[164:167], v8, s[24:27], s61 offen offset:1536 sc1
    s_waitcnt vmcnt(0)
    v_mfma_f32_32x32x16_bf16 v[208:223], v[192:195], v[200:203], v[240:255]
    v_cndmask_b32 v160, v11, v160, s[74:75]
    v_cndmask_b32 v161, v11, v161, s[74:75]
    v_cndmask_b32 v162, v11, v162, s[74:75]
    v_cndmask_b32 v163, v11, v163, s[74:75]
    v_cndmask_b32 v164, v11, v164, s[74:75]
    v_cndmask_b32 v165, v11, v165, s[74:75]
    v_cndmask_b32 v166, v11, v166, s[74:75]
    v_cndmask_b32 v167, v11, v167, s[74:75]
    s_add_u32 s61, s61, 2048
    s_sub_u32 s66, s66, 1
    s_nop 3
    v_exp_f32 v208, v208
    v_exp_f32 v209, v209
    v_exp_f32 v210, v210
    v_exp_f32 v211, v211
    v_exp_f32 v212, v212
    v_exp_f32 v213, v213
    v_exp_f32 v214, v214
    v_exp_f32 v215, v215
    v_exp_f32 v216, v216
    v_exp_f32 v217, v217
    v_exp_f32 v218, v218
    v_exp_f32 v219, v219
    v_exp_f32 v220, v220
    v_exp_f32 v221, v221
    v_exp_f32 v222, v222
    v_exp_f32 v223, v223
    s_nop 0
    v_cvt_pk_bf16_f32 v176, v208, v209
    v_cvt_pk_bf16_f32 v177, v210, v211
    v_cvt_pk_bf16_f32 v178, v212, v213
    v_cvt_pk_bf16_f32 v179, v214, v215
    v_cvt_pk_bf16_f32 v180, v216, v217
    v_cvt_pk_bf16_f32 v181, v218, v219
    v_cvt_pk_bf16_f32 v182, v220, v221
    v_cvt_pk_bf16_f32 v183, v222, v223
    s_nop 1
    v_mfma_f32_32x32x16_bf16 v[128:143], v[160:163], v[176:179], v[128:143]
    v_mfma_f32_32x32x16_bf16 v[128:143], v[164:167], v[180:183], v[128:143]
    s_cmp_lg_u32 s66, 0
    s_nop 11
    s_cbranch_scc1 L_fb_acc0
    v_mov_b32 v184, 0xff800000
    s_mov_b32 s61, s65
    s_mov_b32 s66, 64
L_fb_max1:
    buffer_load_dwordx4 v[192:195], v1, s[24:27], s61 offen sc1
    s_waitcnt vmcnt(0)
    v_mfma_f32_32x32x16_bf16 v[208:223], v[192:195], v[204:207], 0
    s_add_u32 s61, s61, 2048
    s_sub_u32 s66, s66, 1
    s_nop 11
    v_max3_f32 v184, v184, v208, v209
    v_max3_f32 v184, v184, v210, v211
    v_max3_f32 v184, v184, v212, v213
    v_max3_f32 v184, v184, v214, v215
    v_max3_f32 v184, v184, v216, v217
    v_max3_f32 v184, v184, v218, v219
    v_max3_f32 v184, v184, v220, v221
    v_max3_f32 v184, v184, v222, v223
    s_cmp_lg_u32 s66, 0
    s_cbranch_scc1 L_fb_max1
    v_mov_b32 v185, v184
    s_nop 1
    v_permlane32_swap_b32 v184, v185
    v_max_f32 v184, v184, v185
    v_sub_f32 v240, 0, v184
    v_mov_b32 v144, 0
    v_sub_f32 v241, 0, v184
    v_mov_b32 v145, 0
    v_sub_f32 v242, 0, v184
    v_mov_b32 v146, 0
    v_sub_f32 v243, 0, v184
    v_mov_b32 v147, 0
    v_sub_f32 v244, 0, v184
    v_mov_b32 v148, 0
    v_sub_f32 v245, 0, v184
    v_mov_b32 v149, 0
    v_sub_f32 v246, 0, v184
    v_mov_b32 v150, 0
    v_sub_f32 v247, 0, v184
    v_mov_b32 v151, 0
    v_sub_f32 v248, 0, v184
    v_mov_b32 v152, 0
    v_sub_f32 v249, 0, v184
    v_mov_b32 v153, 0
    v_sub_f32 v250, 0, v184
    v_mov_b32 v154, 0
    v_sub_f32 v251, 0, v184
    v_mov_b32 v155, 0
    v_sub_f32 v252, 0, v184
    v_mov_b32 v156, 0
    v_sub_f32 v253, 0, v184
    v_mov_b32 v157, 0
    v_sub_f32 v254, 0, v184
    v_mov_b32 v158, 0
    v_sub_f32 v255, 0, v184
    v_mov_b32 v159, 0
    s_mov_b32 s61, s65
    s_mov_b32 s66, 64
L_fb_acc1:
    buffer_load_dwordx4 v[192:195], v1, s[24:27], s61 offen sc1
    buffer_load_dwordx4 v[160:163], v8, s[24:27], s61 offen offset:1024 sc1
    buffer_load_dwordx4 v[164:167], v8, s[24:27], s61 offen offset:1536 sc1
    s_waitcnt vmcnt(0)
    v_mfma_f32_32x32x16_bf16 v[208:223], v[192:195], v[204:207], v[240:255]
    v_cndmask_b32 v160, v11, v160, s[74:75]
    v_cndmask_b32 v161, v11, v161, s[74:75]
    v_cndmask_b32 v162, v11, v162, s[74:75]
    v_cndmask_b32 v163, v11, v163, s[74:75]
    v_cndmask_b32 v164, v11, v164, s[74:75]
    v_cndmask_b32 v165, v11, v165, s[74:75]
    v_cndmask_b32 v166, v11, v166, s[74:75]
    v_cndmask_b32 v167, v11, v167, s[74:75]
    s_add_u32 s61, s61, 2048
    s_sub_u32 s66, s66, 1
    s_nop 3
    v_exp_f32 v208, v208
    v_exp_f32 v209, v209
    v_exp_f32 v210, v210
    v_exp_f32 v211, v211
    v_exp_f32 v212, v212
    v_exp_f32 v213, v213
    v_exp_f32 v214, v214
    v_exp_f32 v215, v215
    v_exp_f32 v216, v216
    v_exp_f32 v217, v217
    v_exp_f32 v218, v218
    v_exp_f32 v219, v219
    v_exp_f32 v220, v220
    v_exp_f32 v221, v221
    v_exp_f32 v222, v222
    v_exp_f32 v223, v223
    s_nop 0
    v_cvt_pk_bf16_f32 v176, v208, v209
    v_cvt_pk_bf16_f32 v177, v210, v211
    v_cvt_pk_bf16_f32 v178, v212, v213
    v_cvt_pk_bf16_f32 v179, v214, v215
    v_cvt_pk_bf16_f32 v180, v216, v217
    v_cvt_pk_bf16_f32 v181, v218, v219
    v_cvt_pk_bf16_f32 v182, v220, v221
    v_cvt_pk_bf16_f32 v183, v222, v223
    s_nop 1
    v_mfma_f32_32x32x16_bf16 v[144:159], v[160:163], v[176:179], v[144:159]
    v_mfma_f32_32x32x16_bf16 v[144:159], v[164:167], v[180:183], v[144:159]
    s_cmp_lg_u32 s66, 0
    s_nop 11
    s_cbranch_scc1 L_fb_acc1
    s_waitcnt vmcnt(0)
    s_waitcnt vmcnt(0)
    s_branch L_publish
L_helper:
    s_setprio 0
    s_waitcnt lgkmcnt(0)
    s_mov_b32 s24, s22
    s_mov_b32 s25, s23
    s_mov_b32 s26, 20971520
    s_mov_b32 s27, 0x00020000
    s_cmp_lt_u32 s56, 2
    s_cselect_b32 s36, s12, s14
    s_cselect_b32 s37, s13, s15
    s_mov_b32 s38, 1835008
    s_mov_b32 s39, 0x00020000
    s_mov_b32 s32, s6
    s_mov_b32 s33, s7
    s_mov_b32 s34, 1572864
    s_mov_b32 s35, 0x00020000
    s_cmp_eq_u32 s53, 0
    s_cselect_b32 s28, s32, s36
    s_cselect_b32 s29, s33, s37
    s_cselect_b32 s30, s34, s38
    s_mov_b32 s31, 0x00020000
    s_movk_i32 s57, 3584
    s_cselect_b32 s61, 3072, s57
    s_lshr_b32 s65, s56, 1
    s_and_b32 s66, s56, 1
    s_lshl_b32 s66, s66, 1
    s_mul_i32 s60, s52, 7
    s_lshl_b32 s57, s53, 1
    s_add_u32 s60, s60, s57
    s_sub_u32 s58, s60, 1
    s_lshl_b32 s57, s52, 1
    s_add_u32 s59, s57, s65
    s_cmp_eq_u32 s53, 0
    s_cselect_b32 s58, s59, s58
    s_lshl_b32 s58, s58, 7
    s_lshl_b32 s60, s60, 7
    s_and_b32 s59, s53, 1
    s_add_u32 s59, s59, s57
    s_lshl_b32 s59, s59, 7
    s_lshr_b32 s57, s53, 1
    s_add_u32 s57, s57, 1
    s_lshl_b32 s57, s57, 10
    s_add_u32 s59, s59, s57
    s_mov_b32 s68, s58
    s_mov_b32 s69, s59
    s_mov_b32 s70, s60
    s_mul_i32 s57, s66, s61
    s_add_u32 s58, s58, s57
    s_mul_i32 s57, s66, 3584
    s_add_u32 s60, s60, s57
    s_lshl_b32 s57, s65, 5
    s_add_u32 s57, s57, s66
    s_mul_i32 s57, s57, 3072
    s_add_u32 s59, s59, s57
    s_mul_i32 s62, s65, 4224
    s_mul_i32 s57, s66, 1056
    s_add_u32 s62, s62, s57
    s_mul_i32 s63, s65, 4352
    s_mul_i32 s57, s66, 1088
    s_add_u32 s63, s63, s57
    v_lshrrev_b32 v5, 3, v0
    v_and_b32 v6, 7, v0
    v_lshlrev_b32 v6, 4, v6
    s_lshl_b32 s57, s61, 2
    v_mad_u32_u24 v2, v5, s57, v6
    v_mul_u32_u24 v3, 12288, v5
    v_add_u32 v3, v3, v6
    v_mul_u32_u24 v4, 14336, v5
    v_add_u32 v4, v4, v6
    s_add_u32 m0, s62, 137728
    s_add_u32 s64, s58, s61
    buffer_load_dwordx4 v2, s[28:31], s58 offen lds
    s_add_u32 m0, s62, 138784
    s_lshl_b32 s57, s61, 5
    s_add_u32 s58, s58, s57
    buffer_load_dwordx4 v2, s[28:31], s64 offen lds
    s_add_u32 m0, s62, 146432
    s_add_u32 s64, s58, s61
    buffer_load_dwordx4 v2, s[28:31], s58 offen lds
    s_add_u32 m0, s62, 147488
    s_lshl_b32 s57, s61, 5
    s_add_u32 s58, s58, s57
    buffer_load_dwordx4 v2, s[28:31], s64 offen lds
    s_add_u32 m0, s62, 155136
    s_add_u32 s64, s58, s61
    buffer_load_dwordx4 v2, s[28:31], s58 offen lds
    s_add_u32 m0, s62, 156192
    s_lshl_b32 s57, s61, 5
    s_add_u32 s58, s58, s57
    buffer_load_dwordx4 v2, s[28:31], s64 offen lds
    s_lshl_b32 s64, s50, 2
    s_add_u32 s64, s64, s56
    s_lshl_b32 s57, s51, 6
    s_add_u32 s57, s57, s64
    v_mov_b32 v7, s57
    s_lshl_b32 s57, s64, 4
    s_add_u32 s57, s57, s51
    s_add_u32 s57, s57, 1024
    v_mov_b32 v8, s57
    v_cmp_eq_u32 vcc, 0, v0
    v_mov_b32 v5, 0x7ffffff0
    v_mov_b32 v6, 0
    v_cndmask_b32 v8, v8, v7, vcc
    s_lshl_b32 s57, s55, 2
    s_add_u32 s57, s57, s56
    s_lshl_b32 s57, s57, 5
    s_add_u32 s57, s57, s54
    s_add_u32 s57, s57, 2048
    v_cmp_eq_u32 vcc, 2, v0
    v_mov_b32 v7, s57
    s_nop 0
    v_cndmask_b32 v8, v8, v7, vcc
    v_lshlrev_b32 v8, 7, v8
    v_add_u32 v8, 16777216, v8
    v_cmp_gt_u32 vcc, 3, v0
    v_mov_b32 v32, -1
    v_mov_b32 v33, -1
    v_mov_b32 v34, -1
    v_mov_b32 v35, -1
    v_cndmask_b32 v8, v5, v8, vcc
    s_lshl_b32 s57, s55, 2
    s_add_u32 s57, s57, s56
    s_lshl_b32 s57, s57, 6
    s_add_u32 s57, s57, s54
    s_lshl_b32 s57, s57, 10
    s_add_u32 s57, s57, 6291456
    s_add_u32 s64, s57, 32768
    buffer_store_dword v6, v8, s[24:27], 0 offen sc1
    buffer_store_dwordx4 v[32:35], v1, s[24:27], s57 offen sc1
    buffer_store_dwordx4 v[32:35], v1, s[24:27], s64 offen sc1
    s_lshl_b32 s57, s55, 6
    s_lshl_b32 s64, s66, 4
    s_add_u32 s57, s57, s64
    v_and_b32 v5, 31, v0
    v_add_u32 v5, s57, v5
    v_mul_u32_u24 v7, 3584, v5
    v_mul_u32_u24 v8, 3072, v5
    v_mul_u32_u24 v26, s61, v5
    s_mov_b32 s40, s20
    s_mov_b32 s41, s21
    s_mov_b32 s42, 256
    s_mov_b32 s43, 0x00020000
    s_and_b32 s57, s2, 1
    s_lshl_b32 s57, s57, 7
    s_cmp_eq_u32 s56, 0
    s_cselect_b32 s57, s57, 4096
    v_lshlrev_b32 v5, 12, v0
    v_add_u32 v5, s57, v5
    v_mov_b32 v6, 1
    s_lshl_b32 s65, s54, 6
    s_add_u32 s65, s65, s56
    s_lshl_b32 s65, s65, 11
    s_mul_i32 s66, s56, 2080
    v_mov_b32 v16, 0x3f803f80
    v_mov_b32 v28, 0
    v_mov_b32 v17, 0x3f803f80
    v_mov_b32 v29, 0
    v_mov_b32 v18, 0x3f803f80
    v_mov_b32 v30, 0
    v_mov_b32 v19, 0x3f803f80
    v_mov_b32 v31, 0
    v_min_u32 v12, 15, v0
    v_mul_u32_u24 v12, 2080, v12
    v_and_b32 v44, 1, v0
    v_lshlrev_b32 v44, 7, v44
    s_lshr_b32 s57, s54, 3
    s_lshl_b32 s71, s57, 8
    s_bfe_u32 s57, s54, 0x10002
    s_lshl_b32 s57, s57, 6
    s_add_u32 s72, s71, s57
    s_add_u32 s72, s72, s56
    s_lshl_b32 s57, s55, 2
    s_add_u32 s57, s57, s56
    s_lshl_b32 s57, s57, 1
    s_add_u32 s71, s71, s57
    v_and_b32 v42, 15, v0
    v_lshlrev_b32 v42, 2, v42
    v_and_b32 v43, 16, v0
    v_lshl_add_u32 v42, v43, 3, v42
    v_add_u32 v42, s72, v42
    v_and_b32 v43, 1, v0
    v_add_u32 v43, s71, v43
    v_cmp_gt_u32 vcc, 32, v0
    s_mov_b32 s71, 16777216
    s_nop 0
    v_cndmask_b32 v45, v43, v42, vcc
    v_lshlrev_b32 v45, 7, v45
    s_waitcnt vmcnt(7)
    s_barrier
    s_add_u32 m0, s62, 41984
    s_add_u32 s64, s58, s61
    buffer_load_dwordx4 v2, s[28:31], s58 offen lds
    s_add_u32 m0, s62, 43040
    s_lshl_b32 s57, s61, 5
    s_add_u32 s58, s58, s57
    buffer_load_dwordx4 v2, s[28:31], s64 offen lds
    s_add_u32 m0, s62, 50688
    s_add_u32 s64, s58, s61
    buffer_load_dwordx4 v2, s[28:31], s58 offen lds
    s_add_u32 m0, s62, 51744
    s_lshl_b32 s57, s61, 5
    s_add_u32 s58, s58, s57
    buffer_load_dwordx4 v2, s[28:31], s64 offen lds
    s_add_u32 m0, s62, 59392
    s_add_u32 s64, s58, s61
    buffer_load_dwordx4 v2, s[28:31], s58 offen lds
    s_add_u32 m0, s62, 60448
    s_lshl_b32 s57, s61, 5
    s_add_u32 s58, s58, s57
    buffer_load_dwordx4 v2, s[28:31], s64 offen lds
    ds_write_b128 v12, v[16:19] offset:2048
    ds_write_b128 v12, v[28:31] offset:2064
    v_min_u32 v12, 47, v0
    v_mul_u32_u24 v12, 2080, v12
    s_setprio 0
    s_waitcnt vmcnt(11)
    s_barrier
    s_add_u32 m0, s62, 68096
    s_add_u32 s64, s58, s61
    buffer_load_dwordx4 v2, s[28:31], s58 offen lds
    s_add_u32 m0, s62, 69152
    s_lshl_b32 s57, s61, 5
    s_add_u32 s58, s58, s57
    buffer_load_dwordx4 v2, s[28:31], s64 offen lds
    s_waitcnt vmcnt(11)
    s_barrier
    s_add_u32 m0, s62, 76800
    s_add_u32 s64, s58, s61
    buffer_load_dwordx4 v2, s[28:31], s58 offen lds
    s_add_u32 m0, s62, 77856
    s_lshl_b32 s57, s61, 5
    s_add_u32 s58, s58, s57
    buffer_load_dwordx4 v2, s[28:31], s64 offen lds
    s_waitcnt vmcnt(8)
    s_barrier
    s_add_u32 m0, s62, 85504
    s_add_u32 s64, s58, s61
    buffer_load_dwordx4 v2, s[28:31], s58 offen lds
    s_add_u32 m0, s62, 86560
    s_lshl_b32 s57, s61, 5
    s_add_u32 s58, s58, s57
    buffer_load_dwordx4 v2, s[28:31], s64 offen lds
    buffer_load_dword v11, v8, s[32:35], s69 offen
    s_waitcnt vmcnt(9)
    s_barrier
    s_add_u32 m0, s62, 94208
    s_add_u32 s64, s58, s61
    buffer_load_dwordx4 v2, s[28:31], s58 offen lds
    s_add_u32 m0, s62, 95264
    s_lshl_b32 s57, s61, 5
    s_add_u32 s58, s58, s57
    buffer_load_dwordx4 v2, s[28:31], s64 offen lds
    s_waitcnt vmcnt(9)
    s_barrier
    s_add_u32 m0, s62, 102912
    s_add_u32 s64, s58, s61
    buffer_load_dwordx4 v2, s[28:31], s58 offen lds
    s_add_u32 m0, s62, 103968
    s_lshl_b32 s57, s61, 5
    s_add_u32 s58, s58, s57
    buffer_load_dwordx4 v2, s[28:31], s64 offen lds
    s_waitcnt vmcnt(9)
    s_barrier
    s_add_u32 m0, s62, 111616
    s_add_u32 s64, s58, s61
    buffer_load_dwordx4 v2, s[28:31], s58 offen lds
    s_add_u32 m0, s62, 112672
    s_lshl_b32 s57, s61, 5
    s_add_u32 s58, s58, s57
    buffer_load_dwordx4 v2, s[28:31], s64 offen lds
    s_waitcnt vmcnt(9)
    s_barrier
    s_add_u32 m0, s62, 120320
    s_add_u32 s64, s58, s61
    buffer_load_dwordx4 v2, s[28:31], s58 offen lds
    s_add_u32 m0, s62, 121376
    s_lshl_b32 s57, s61, 5
    s_add_u32 s58, s58, s57
    buffer_load_dwordx4 v2, s[28:31], s64 offen lds
    buffer_load_dword v11, v7, s[36:39], s70 offen
    s_waitcnt vmcnt(10)
    s_barrier
    s_add_u32 m0, s62, 129024
    s_add_u32 s64, s58, s61
    buffer_load_dwordx4 v2, s[28:31], s58 offen lds
    s_add_u32 m0, s62, 130080
    s_lshl_b32 s57, s61, 5
    s_add_u32 s58, s58, s57
    buffer_load_dwordx4 v2, s[28:31], s64 offen lds
    s_waitcnt vmcnt(9)
    s_barrier
    s_add_u32 m0, s62, 137728
    s_add_u32 s64, s58, s61
    buffer_load_dwordx4 v2, s[28:31], s58 offen lds
    s_add_u32 m0, s62, 138784
    s_lshl_b32 s57, s61, 5
    s_add_u32 s58, s58, s57
    buffer_load_dwordx4 v2, s[28:31], s64 offen lds
    s_waitcnt vmcnt(9)
    s_barrier
    s_add_u32 m0, s62, 146432
    s_add_u32 s64, s58, s61
    buffer_load_dwordx4 v2, s[28:31], s58 offen lds
    s_add_u32 m0, s62, 147488
    s_lshl_b32 s57, s61, 5
    s_add_u32 s58, s58, s57
    buffer_load_dwordx4 v2, s[28:31], s64 offen lds
    s_waitcnt vmcnt(9)
    s_barrier
    s_add_u32 m0, s63, 155136
    s_add_u32 s64, s59, 3072
    buffer_load_dwordx4 v3, s[32:35], s59 offen lds
    s_add_u32 m0, s63, 156224
    s_add_u32 s59, s59, 196608
    buffer_load_dwordx4 v3, s[32:35], s64 offen lds
    s_waitcnt vmcnt(9)
    s_barrier
    s_add_u32 m0, s63, 41984
    s_add_u32 s64, s59, 3072
    buffer_load_dwordx4 v3, s[32:35], s59 offen lds
    s_add_u32 m0, s63, 43072
    s_add_u32 s59, s59, 196608
    buffer_load_dwordx4 v3, s[32:35], s64 offen lds
    buffer_atomic_add v6, v5, s[40:43], 0 offen sc1
    s_waitcnt vmcnt(9)
    s_barrier
    s_add_u32 m0, s63, 50688
    s_add_u32 s64, s59, 3072
    buffer_load_dwordx4 v3, s[32:35], s59 offen lds
    s_add_u32 m0, s63, 51776
    s_add_u32 s59, s59, 196608
    buffer_load_dwordx4 v3, s[32:35], s64 offen lds
    s_waitcnt vmcnt(9)
    s_barrier
    s_add_u32 m0, s63, 59392
    s_add_u32 s64, s59, 3072
    buffer_load_dwordx4 v3, s[32:35], s59 offen lds
    s_add_u32 m0, s63, 60480
    s_add_u32 s59, s59, 196608
    buffer_load_dwordx4 v3, s[32:35], s64 offen lds
    s_waitcnt vmcnt(9)
    s_barrier
    s_add_u32 m0, s63, 68096
    s_add_u32 s64, s59, 3072
    buffer_load_dwordx4 v3, s[32:35], s59 offen lds
    s_add_u32 m0, s63, 69184
    s_add_u32 s59, s59, 196608
    buffer_load_dwordx4 v3, s[32:35], s64 offen lds
    s_waitcnt vmcnt(9)
    s_barrier
    s_add_u32 m0, s63, 76800
    s_add_u32 s64, s59, 3072
    buffer_load_dwordx4 v3, s[32:35], s59 offen lds
    s_add_u32 m0, s63, 77888
    s_add_u32 s59, s59, 196608
    buffer_load_dwordx4 v3, s[32:35], s64 offen lds
    s_waitcnt vmcnt(9)
    s_barrier
    s_add_u32 m0, s63, 85504
    s_add_u32 s64, s59, 3072
    buffer_load_dwordx4 v3, s[32:35], s59 offen lds
    s_add_u32 m0, s63, 86592
    s_add_u32 s59, s59, 196608
    buffer_load_dwordx4 v3, s[32:35], s64 offen lds
    s_waitcnt vmcnt(8)
    s_barrier
    s_add_u32 m0, s63, 94208
    s_add_u32 s64, s59, 3072
    buffer_load_dwordx4 v3, s[32:35], s59 offen lds
    s_add_u32 m0, s63, 95296
    s_add_u32 s59, s59, 196608
    buffer_load_dwordx4 v3, s[32:35], s64 offen lds
    s_waitcnt vmcnt(8)
    s_barrier
    s_add_u32 m0, s62, 102912
    s_add_u32 s64, s60, 3584
    buffer_load_dwordx4 v4, s[36:39], s60 offen lds
    s_add_u32 m0, s62, 103968
    s_add_u32 s60, s60, 114688
    buffer_load_dwordx4 v4, s[36:39], s64 offen lds
    s_waitcnt vmcnt(8)
    s_barrier
    s_add_u32 m0, s62, 111616
    s_add_u32 s64, s60, 3584
    buffer_load_dwordx4 v4, s[36:39], s60 offen lds
    s_add_u32 m0, s62, 112672
    s_add_u32 s60, s60, 114688
    buffer_load_dwordx4 v4, s[36:39], s64 offen lds
    s_waitcnt vmcnt(8)
    s_barrier
    s_add_u32 m0, s62, 120320
    s_add_u32 s64, s60, 3584
    buffer_load_dwordx4 v4, s[36:39], s60 offen lds
    s_add_u32 m0, s62, 121376
    s_add_u32 s60, s60, 114688
    buffer_load_dwordx4 v4, s[36:39], s64 offen lds
    s_waitcnt vmcnt(8)
    s_barrier
    s_add_u32 m0, s62, 129024
    s_add_u32 s64, s60, 3584
    buffer_load_dwordx4 v4, s[36:39], s60 offen lds
    s_add_u32 m0, s62, 130080
    s_add_u32 s60, s60, 114688
    buffer_load_dwordx4 v4, s[36:39], s64 offen lds
    s_waitcnt vmcnt(8)
    s_barrier
    s_add_u32 m0, s62, 137728
    s_add_u32 s64, s60, 3584
    buffer_load_dwordx4 v4, s[36:39], s60 offen lds
    s_add_u32 m0, s62, 138784
    s_add_u32 s60, s60, 114688
    buffer_load_dwordx4 v4, s[36:39], s64 offen lds
    s_waitcnt vmcnt(8)
    s_barrier
    s_add_u32 m0, s62, 146432
    s_add_u32 s64, s60, 3584
    buffer_load_dwordx4 v4, s[36:39], s60 offen lds
    s_add_u32 m0, s62, 147488
    s_add_u32 s60, s60, 114688
    buffer_load_dwordx4 v4, s[36:39], s64 offen lds
    s_waitcnt vmcnt(8)
    s_barrier
    s_add_u32 m0, s62, 155136
    s_add_u32 s64, s60, 3584
    buffer_load_dwordx4 v4, s[36:39], s60 offen lds
    s_add_u32 m0, s62, 156192
    s_add_u32 s60, s60, 114688
    buffer_load_dwordx4 v4, s[36:39], s64 offen lds
    s_waitcnt vmcnt(8)
    s_barrier
    s_add_u32 m0, s62, 41984
    s_add_u32 s64, s60, 3584
    buffer_load_dwordx4 v4, s[36:39], s60 offen lds
    s_add_u32 m0, s62, 43040
    s_add_u32 s60, s60, 114688
    buffer_load_dwordx4 v4, s[36:39], s64 offen lds
    s_waitcnt vmcnt(8)
    s_barrier
    s_add_u32 m0, s62, 50688
    s_add_u32 s64, s60, 3584
    buffer_load_dwordx4 v4, s[36:39], s60 offen lds
    s_add_u32 m0, s62, 51744
    s_add_u32 s60, s60, 114688
    buffer_load_dwordx4 v4, s[36:39], s64 offen lds
    v_lshrrev_b32 v36, 3, v0
    v_and_b32 v37, 7, v0
    v_lshlrev_b32 v37, 4, v37
    v_lshl_add_u32 v20, v36, 10, v37
    v_bfe_u32 v36, v0, 2, 2
    v_lshrrev_b32 v37, 5, v0
    v_lshl_add_u32 v36, v37, 2, v36
    s_waitcnt vmcnt(8)
    s_barrier
    s_add_u32 m0, s62, 59392
    s_add_u32 s64, s60, 3584
    buffer_load_dwordx4 v4, s[36:39], s60 offen lds
    s_add_u32 m0, s62, 60448
    s_add_u32 s60, s60, 114688
    buffer_load_dwordx4 v4, s[36:39], s64 offen lds
    v_lshlrev_b32 v36, 7, v36
    v_bfe_u32 v37, v0, 4, 1
    v_lshl_add_u32 v36, v37, 5, v36
    v_and_b32 v37, 3, v0
    v_lshl_add_u32 v38, v37, 3, v36
    s_mul_i32 s58, s56, 8320
    s_add_u32 s58, s58, 99840
    s_waitcnt vmcnt(8)
    s_barrier
    s_add_u32 m0, s62, 68096
    s_add_u32 s64, s60, 3584
    buffer_load_dwordx4 v4, s[36:39], s60 offen lds
    s_add_u32 m0, s62, 69152
    s_add_u32 s60, s60, 114688
    buffer_load_dwordx4 v4, s[36:39], s64 offen lds
    s_mul_i32 s59, s56, 6144
    s_add_u32 s59, s59, 124928
    v_add_u32 v21, s58, v38
    v_add_u32 v22, s59, v38
    v_mul_u32_u24 v24, 2080, v37
    v_add_u32 v24, s58, v24
    v_and_b32 v23, 31, v0
    s_waitcnt vmcnt(8)
    s_barrier
    s_add_u32 m0, s62, 76800
    s_add_u32 s64, s60, 3584
    buffer_load_dwordx4 v4, s[36:39], s60 offen lds
    s_add_u32 m0, s62, 77856
    s_add_u32 s60, s60, 114688
    buffer_load_dwordx4 v4, s[36:39], s64 offen lds
    v_lshlrev_b32 v23, 7, v23
    s_and_b32 s61, s56, 1
    s_lshl_b32 s61, s61, 6
    v_add_u32 v32, s61, v38
    v_xor_b32 v34, 64, v32
    v_add_u32 v33, s59, v32
    v_add_u32 v35, s59, v34
    s_waitcnt vmcnt(8)
    s_barrier
    s_add_u32 m0, s62, 85504
    s_add_u32 s64, s60, 3584
    buffer_load_dwordx4 v4, s[36:39], s60 offen lds
    s_add_u32 m0, s62, 86560
    s_add_u32 s60, s60, 114688
    buffer_load_dwordx4 v4, s[36:39], s64 offen lds
    s_lshl_b32 s58, s56, 13
    s_add_u32 s58, s58, 65536
    v_add_u32 v32, s58, v32
    v_add_u32 v34, s58, v34
    v_add_u32 v2, s58, v1
    v_xor_b32 v3, 8192, v2
    s_lshl_b32 s61, s56, 12
    s_waitcnt vmcnt(8)
    s_barrier
    s_add_u32 m0, s62, 94208
    s_add_u32 s64, s60, 3584
    buffer_load_dwordx4 v4, s[36:39], s60 offen lds
    s_add_u32 m0, s62, 95264
    s_add_u32 s60, s60, 114688
    buffer_load_dwordx4 v4, s[36:39], s64 offen lds
    v_add_u32 v25, s61, v1
    s_lshl_b32 s61, s56, 14
    v_add_u32 v6, s61, v1
    v_bfe_u32 v5, v0, 2, 2
    s_add_u32 s61, s48, 1
    v_add_u32 v5, s61, v5
    v_and_b32 v5, 3, v5
    s_waitcnt vmcnt(8)
    s_barrier
    s_add_u32 m0, s62, 102912
    s_add_u32 s64, s60, 3584
    buffer_load_dwordx4 v4, s[36:39], s60 offen lds
    s_add_u32 m0, s62, 103968
    s_add_u32 s60, s60, 114688
    buffer_load_dwordx4 v4, s[36:39], s64 offen lds
    v_lshl_add_u32 v5, v5, 2, v37
    v_lshlrev_b32 v5, 7, v5
    v_and_b32 v36, 31, v0
    v_lshlrev_b32 v36, 10, v36
    v_lshrrev_b32 v37, 5, v0
    v_lshl_add_u32 v26, v37, 3, v36
    v_lshl_add_u32 v7, v37, 4, v36
    s_waitcnt vmcnt(8)
    s_barrier
    s_add_u32 m0, s62, 111616
    s_add_u32 s64, s60, 3584
    buffer_load_dwordx4 v4, s[36:39], s60 offen lds
    s_add_u32 m0, s62, 112672
    s_add_u32 s60, s60, 114688
    buffer_load_dwordx4 v4, s[36:39], s64 offen lds
    buffer_load_dword v40, v44, s[40:43], 0 offen sc1
    s_waitcnt vmcnt(9)
    s_barrier
    s_waitcnt vmcnt(7)
    s_barrier
    s_waitcnt vmcnt(1)
    s_barrier
    s_waitcnt vmcnt(0)
    s_mov_b32 s67, 1048576
    s_branch L_poll_cnt_chk
L_poll_cnt:
    buffer_load_dword v40, v44, s[40:43], 0 offen sc1
    s_waitcnt vmcnt(0)
L_poll_cnt_chk:
    v_cmp_gt_u32 vcc, 0x80, v40
    s_nop 0
    s_cbranch_vccz L_poll_cnt_ok
    s_sub_u32 s67, s67, 1
    s_cbranch_scc1 L_poll_cnt_ok
    s_sleep 1
    s_branch L_poll_cnt
L_poll_cnt_ok:
    s_mov_b32 s67, 1048576
L_poll_kv:
    buffer_load_dword v41, v45, s[24:27], s71 offen sc1
    s_waitcnt vmcnt(0)
L_poll_kv_chk:
    v_cmp_ne_u32 vcc, 1, v41
    s_nop 0
    s_cbranch_vccz L_poll_kv_ok
    s_sub_u32 s67, s67, 1
    s_cbranch_scc1 L_poll_kv_ok
    s_sleep 1
    s_branch L_poll_kv
L_poll_kv_ok:
    s_mov_b32 m0, s66
    s_add_u32 s66, s66, 8320
    buffer_load_dwordx4 v1, s[24:27], s65 offen sc1 lds
    buffer_load_dwordx4 v1, s[24:27], s65 offen offset:1024 sc1 lds
    s_add_u32 s65, s65, 8192
    s_mov_b32 m0, s66
    s_add_u32 s66, s66, 8320
    buffer_load_dwordx4 v1, s[24:27], s65 offen sc1 lds
    buffer_load_dwordx4 v1, s[24:27], s65 offen offset:1024 sc1 lds
    s_add_u32 s65, s65, 8192
    s_mov_b32 m0, s66
    s_add_u32 s66, s66, 8320
    buffer_load_dwordx4 v1, s[24:27], s65 offen sc1 lds
    buffer_load_dwordx4 v1, s[24:27], s65 offen offset:1024 sc1 lds
    s_add_u32 s65, s65, 8192
    s_mov_b32 m0, s66
    s_add_u32 s66, s66, 8320
    buffer_load_dwordx4 v1, s[24:27], s65 offen sc1 lds
    buffer_load_dwordx4 v1, s[24:27], s65 offen offset:1024 sc1 lds
    s_add_u32 s65, s65, 8192
    s_barrier
    s_waitcnt vmcnt(0)
    s_waitcnt lgkmcnt(0)
    s_barrier
    s_mov_b32 m0, s66
    s_add_u32 s66, s66, 8320
    buffer_load_dwordx4 v1, s[24:27], s65 offen sc1 lds
    buffer_load_dwordx4 v1, s[24:27], s65 offen offset:1024 sc1 lds
    s_add_u32 s65, s65, 8192
    s_mov_b32 m0, s66
    s_add_u32 s66, s66, 8320
    buffer_load_dwordx4 v1, s[24:27], s65 offen sc1 lds
    buffer_load_dwordx4 v1, s[24:27], s65 offen offset:1024 sc1 lds
    s_add_u32 s65, s65, 8192
    s_mov_b32 m0, s66
    s_add_u32 s66, s66, 8320
    buffer_load_dwordx4 v1, s[24:27], s65 offen sc1 lds
    buffer_load_dwordx4 v1, s[24:27], s65 offen offset:1024 sc1 lds
    s_add_u32 s65, s65, 8192
    s_mov_b32 m0, s66
    s_add_u32 s66, s66, 8320
    buffer_load_dwordx4 v1, s[24:27], s65 offen sc1 lds
    buffer_load_dwordx4 v1, s[24:27], s65 offen offset:1024 sc1 lds
    s_add_u32 s65, s65, 8192
    s_mov_b32 m0, s66
    s_add_u32 s66, s66, 8320
    buffer_load_dwordx4 v1, s[24:27], s65 offen sc1 lds
    buffer_load_dwordx4 v1, s[24:27], s65 offen offset:1024 sc1 lds
    s_add_u32 s65, s65, 8192
    s_mov_b32 m0, s66
    s_add_u32 s66, s66, 8320
    buffer_load_dwordx4 v1, s[24:27], s65 offen sc1 lds
    buffer_load_dwordx4 v1, s[24:27], s65 offen offset:1024 sc1 lds
    s_add_u32 s65, s65, 8192
    s_mov_b32 m0, s66
    s_add_u32 s66, s66, 8320
    buffer_load_dwordx4 v1, s[24:27], s65 offen sc1 lds
    buffer_load_dwordx4 v1, s[24:27], s65 offen offset:1024 sc1 lds
    s_add_u32 s65, s65, 8192
    s_mov_b32 m0, s66
    s_add_u32 s66, s66, 8320
    buffer_load_dwordx4 v1, s[24:27], s65 offen sc1 lds
    buffer_load_dwordx4 v1, s[24:27], s65 offen offset:1024 sc1 lds
    s_add_u32 s65, s65, 8192
    ds_write_b128 v12, v[16:19] offset:2048
    ds_write_b128 v12, v[28:31] offset:2064
    s_setprio 0
    s_mov_b32 s50, s54
    s_mov_b32 s51, s55
    s_mul_i32 s68, s56, 8320
    s_add_u32 s68, s68, 99840
    s_mul_i32 s63, s56, 6144
    s_add_u32 s63, s63, 124928
    s_mov_b32 s28, s8
    s_mov_b32 s29, s9
    s_mov_b32 s30, 524288
    s_mov_b32 s31, 0x00020000
    s_mov_b32 s32, s16
    s_mov_b32 s33, s17
    s_mov_b32 s34, 1835008
    s_mov_b32 s35, 0x00020000
    s_mul_i32 s70, s56, 458752
    s_lshl_b32 s57, s51, 7
    s_add_u32 s70, s70, s57
    s_add_u32 m0, s68, 0
    s_add_u32 s64, s70, 8192
    buffer_load_dwordx4 v20, s[32:35], s70 offen lds
    s_add_u32 m0, s68, 1024
    s_add_u32 s70, s70, 16384
    buffer_load_dwordx4 v20, s[32:35], s64 offen lds
    s_add_u32 m0, s68, 2048
    s_add_u32 s64, s70, 8192
    buffer_load_dwordx4 v20, s[32:35], s70 offen lds
    s_add_u32 m0, s68, 3072
    s_add_u32 s70, s70, 16384
    buffer_load_dwordx4 v20, s[32:35], s64 offen lds
    s_add_u32 m0, s68, 4096
    s_add_u32 s64, s70, 8192
    buffer_load_dwordx4 v20, s[32:35], s70 offen lds
    s_add_u32 m0, s68, 5120
    s_add_u32 s70, s70, 16384
    buffer_load_dwordx4 v20, s[32:35], s64 offen lds
    s_add_u32 m0, s68, 6144
    s_add_u32 s64, s70, 8192
    buffer_load_dwordx4 v20, s[32:35], s70 offen lds
    s_add_u32 m0, s68, 7168
    s_add_u32 s70, s70, 16384
    buffer_load_dwordx4 v20, s[32:35], s64 offen lds
    s_add_u32 m0, s63, 8192
    s_add_u32 s64, s70, 8192
    buffer_load_dwordx4 v20, s[32:35], s70 offen lds
    s_add_u32 m0, s63, 9216
    s_add_u32 s70, s70, 16384
    buffer_load_dwordx4 v20, s[32:35], s64 offen lds
    s_add_u32 m0, s63, 10240
    s_add_u32 s64, s70, 8192
    buffer_load_dwordx4 v20, s[32:35], s70 offen lds
    s_add_u32 m0, s63, 11264
    s_add_u32 s70, s70, 16384
    buffer_load_dwordx4 v20, s[32:35], s64 offen lds
    s_add_u32 m0, s63, 12288
    s_add_u32 s64, s70, 8192
    buffer_load_dwordx4 v20, s[32:35], s70 offen lds
    s_add_u32 m0, s63, 13312
    s_add_u32 s70, s70, 16384
    buffer_load_dwordx4 v20, s[32:35], s64 offen lds
    s_waitcnt vmcnt(14)
    s_waitcnt lgkmcnt(0)
    s_barrier
    s_lshl_b32 s69, s50, 12
    s_add_u32 s69, s69, 16908288
    s_mov_b32 s67, 1048576
L_poll_h:
    buffer_load_dword v4, v23, s[24:27], s69 offen sc1
    s_waitcnt vmcnt(0)
L_poll_h_chk:
    v_cmp_ne_u32 vcc, 1, v4
    s_nop 0
    s_cbranch_vccz L_poll_h_ok
    s_sub_u32 s67, s67, 1
    s_cbranch_scc1 L_poll_h_ok
    s_sleep 1
    s_branch L_poll_h
L_poll_h_ok:
    s_mul_i32 s69, s50, 224
    s_mul_i32 s57, s56, 28
    s_add_u32 s69, s69, s57
    s_lshl_b32 s69, s69, 10
    s_add_u32 s69, s69, 8388608
    s_add_u32 s58, s69, 114688
    buffer_load_dwordx4 v[128:131], v1, s[24:27], s69 offen offset:0 sc1
    buffer_load_dwordx4 v[132:135], v1, s[24:27], s58 offen offset:0 sc1
    buffer_load_dwordx4 v[136:139], v1, s[24:27], s69 offen offset:1024 sc1
    buffer_load_dwordx4 v[140:143], v1, s[24:27], s58 offen offset:1024 sc1
    buffer_load_dwordx4 v[144:147], v1, s[24:27], s69 offen offset:2048 sc1
    buffer_load_dwordx4 v[148:151], v1, s[24:27], s58 offen offset:2048 sc1
    buffer_load_dwordx4 v[152:155], v1, s[24:27], s69 offen offset:3072 sc1
    buffer_load_dwordx4 v[156:159], v1, s[24:27], s58 offen offset:3072 sc1
    s_add_u32 s69, s69, 4096
    s_add_u32 s58, s58, 4096
    buffer_load_dwordx4 v[160:163], v1, s[24:27], s69 offen offset:0 sc1
    buffer_load_dwordx4 v[164:167], v1, s[24:27], s58 offen offset:0 sc1
    buffer_load_dwordx4 v[168:171], v1, s[24:27], s69 offen offset:1024 sc1
    buffer_load_dwordx4 v[172:175], v1, s[24:27], s58 offen offset:1024 sc1
    buffer_load_dwordx4 v[176:179], v1, s[24:27], s69 offen offset:2048 sc1
    buffer_load_dwordx4 v[180:183], v1, s[24:27], s58 offen offset:2048 sc1
    buffer_load_dwordx4 v[184:187], v1, s[24:27], s69 offen offset:3072 sc1
    buffer_load_dwordx4 v[188:191], v1, s[24:27], s58 offen offset:3072 sc1
    s_add_u32 s69, s69, 4096
    s_add_u32 s58, s58, 4096
    s_waitcnt vmcnt(14)
    ds_read_b64_tr_b16 v[48:49], v21 offset:0
    ds_read_b64_tr_b16 v[50:51], v21 offset:1024
    ds_read_b64_tr_b16 v[52:53], v21 offset:64
    ds_read_b64_tr_b16 v[54:55], v21 offset:1088
    s_waitcnt lgkmcnt(0)
    v_mfma_f32_32x32x16_bf16 v[64:79], v[48:51], v[128:131], 0
    s_add_u32 m0, s68, 0
    s_add_u32 s64, s70, 8192
    buffer_load_dwordx4 v20, s[32:35], s70 offen lds
    s_add_u32 m0, s68, 1024
    s_add_u32 s70, s70, 16384
    buffer_load_dwordx4 v20, s[32:35], s64 offen lds
    v_mfma_f32_32x32x16_bf16 v[96:111], v[48:51], v[132:135], 0
    v_mfma_f32_32x32x16_bf16 v[80:95], v[52:55], v[128:131], 0
    v_mfma_f32_32x32x16_bf16 v[112:127], v[52:55], v[132:135], 0
    buffer_load_dwordx4 v[128:131], v1, s[24:27], s69 offen offset:0 sc1
    buffer_load_dwordx4 v[132:135], v1, s[24:27], s58 offen offset:0 sc1
    s_waitcnt vmcnt(16)
    ds_read_b64_tr_b16 v[56:57], v21 offset:2048
    ds_read_b64_tr_b16 v[58:59], v21 offset:3072
    ds_read_b64_tr_b16 v[60:61], v21 offset:2112
    ds_read_b64_tr_b16 v[62:63], v21 offset:3136
    s_waitcnt lgkmcnt(0)
    v_mfma_f32_32x32x16_bf16 v[64:79], v[56:59], v[136:139], v[64:79]
    s_add_u32 m0, s68, 2048
    s_add_u32 s64, s70, 8192
    buffer_load_dwordx4 v20, s[32:35], s70 offen lds
    s_add_u32 m0, s68, 3072
    s_add_u32 s70, s70, 16384
    buffer_load_dwordx4 v20, s[32:35], s64 offen lds
    v_mfma_f32_32x32x16_bf16 v[96:111], v[56:59], v[140:143], v[96:111]
    v_mfma_f32_32x32x16_bf16 v[80:95], v[60:63], v[136:139], v[80:95]
    v_mfma_f32_32x32x16_bf16 v[112:127], v[60:63], v[140:143], v[112:127]
    buffer_load_dwordx4 v[136:139], v1, s[24:27], s69 offen offset:1024 sc1
    buffer_load_dwordx4 v[140:143], v1, s[24:27], s58 offen offset:1024 sc1
    s_waitcnt vmcnt(18)
    ds_read_b64_tr_b16 v[48:49], v21 offset:4096
    ds_read_b64_tr_b16 v[50:51], v21 offset:5120
    ds_read_b64_tr_b16 v[52:53], v21 offset:4160
    ds_read_b64_tr_b16 v[54:55], v21 offset:5184
    s_waitcnt lgkmcnt(0)
    v_mfma_f32_32x32x16_bf16 v[64:79], v[48:51], v[144:147], v[64:79]
    s_add_u32 m0, s68, 4096
    s_add_u32 s64, s70, 8192
    buffer_load_dwordx4 v20, s[32:35], s70 offen lds
    s_add_u32 m0, s68, 5120
    s_add_u32 s70, s70, 16384
    buffer_load_dwordx4 v20, s[32:35], s64 offen lds
    v_mfma_f32_32x32x16_bf16 v[96:111], v[48:51], v[148:151], v[96:111]
    v_mfma_f32_32x32x16_bf16 v[80:95], v[52:55], v[144:147], v[80:95]
    v_mfma_f32_32x32x16_bf16 v[112:127], v[52:55], v[148:151], v[112:127]
    buffer_load_dwordx4 v[144:147], v1, s[24:27], s69 offen offset:2048 sc1
    buffer_load_dwordx4 v[148:151], v1, s[24:27], s58 offen offset:2048 sc1
    s_waitcnt vmcnt(20)
    ds_read_b64_tr_b16 v[56:57], v21 offset:6144
    ds_read_b64_tr_b16 v[58:59], v21 offset:7168
    ds_read_b64_tr_b16 v[60:61], v21 offset:6208
    ds_read_b64_tr_b16 v[62:63], v21 offset:7232
    s_waitcnt lgkmcnt(0)
    v_mfma_f32_32x32x16_bf16 v[64:79], v[56:59], v[152:155], v[64:79]
    s_add_u32 m0, s68, 6144
    s_add_u32 s64, s70, 8192
    buffer_load_dwordx4 v20, s[32:35], s70 offen lds
    s_add_u32 m0, s68, 7168
    s_add_u32 s70, s70, 16384
    buffer_load_dwordx4 v20, s[32:35], s64 offen lds
    v_mfma_f32_32x32x16_bf16 v[96:111], v[56:59], v[156:159], v[96:111]
    v_mfma_f32_32x32x16_bf16 v[80:95], v[60:63], v[152:155], v[80:95]
    v_mfma_f32_32x32x16_bf16 v[112:127], v[60:63], v[156:159], v[112:127]
    buffer_load_dwordx4 v[152:155], v1, s[24:27], s69 offen offset:3072 sc1
    buffer_load_dwordx4 v[156:159], v1, s[24:27], s58 offen offset:3072 sc1
    s_add_u32 s69, s69, 4096
    s_add_u32 s58, s58, 4096
    s_waitcnt vmcnt(22)
    ds_read_b64_tr_b16 v[48:49], v22 offset:8192
    ds_read_b64_tr_b16 v[50:51], v22 offset:9216
    ds_read_b64_tr_b16 v[52:53], v22 offset:8256
    ds_read_b64_tr_b16 v[54:55], v22 offset:9280
    s_waitcnt lgkmcnt(0)
    v_mfma_f32_32x32x16_bf16 v[64:79], v[48:51], v[160:163], v[64:79]
    s_add_u32 m0, s63, 8192
    s_add_u32 s64, s70, 8192
    buffer_load_dwordx4 v20, s[32:35], s70 offen lds
    s_add_u32 m0, s63, 9216
    s_add_u32 s70, s70, 16384
    buffer_load_dwordx4 v20, s[32:35], s64 offen lds
    v_mfma_f32_32x32x16_bf16 v[96:111], v[48:51], v[164:167], v[96:111]
    v_mfma_f32_32x32x16_bf16 v[80:95], v[52:55], v[160:163], v[80:95]
    v_mfma_f32_32x32x16_bf16 v[112:127], v[52:55], v[164:167], v[112:127]
    buffer_load_dwordx4 v[160:163], v1, s[24:27], s69 offen offset:0 sc1
    buffer_load_dwordx4 v[164:167], v1, s[24:27], s58 offen offset:0 sc1
    s_waitcnt vmcnt(24)
    ds_read_b64_tr_b16 v[56:57], v22 offset:10240
    ds_read_b64_tr_b16 v[58:59], v22 offset:11264
    ds_read_b64_tr_b16 v[60:61], v22 offset:10304
    ds_read_b64_tr_b16 v[62:63], v22 offset:11328
    s_waitcnt lgkmcnt(0)
    v_mfma_f32_32x32x16_bf16 v[64:79], v[56:59], v[168:171], v[64:79]
    s_add_u32 m0, s63, 10240
    s_add_u32 s64, s70, 8192
    buffer_load_dwordx4 v20, s[32:35], s70 offen lds
    s_add_u32 m0, s63, 11264
    s_add_u32 s70, s70, 16384
    buffer_load_dwordx4 v20, s[32:35], s64 offen lds
    v_mfma_f32_32x32x16_bf16 v[96:111], v[56:59], v[172:175], v[96:111]
    v_mfma_f32_32x32x16_bf16 v[80:95], v[60:63], v[168:171], v[80:95]
    v_mfma_f32_32x32x16_bf16 v[112:127], v[60:63], v[172:175], v[112:127]
    buffer_load_dwordx4 v[168:171], v1, s[24:27], s69 offen offset:1024 sc1
    buffer_load_dwordx4 v[172:175], v1, s[24:27], s58 offen offset:1024 sc1
    s_waitcnt vmcnt(26)
    ds_read_b64_tr_b16 v[48:49], v22 offset:12288
    ds_read_b64_tr_b16 v[50:51], v22 offset:13312
    ds_read_b64_tr_b16 v[52:53], v22 offset:12352
    ds_read_b64_tr_b16 v[54:55], v22 offset:13376
    s_waitcnt lgkmcnt(0)
    v_mfma_f32_32x32x16_bf16 v[64:79], v[48:51], v[176:179], v[64:79]
    s_add_u32 m0, s63, 12288
    s_add_u32 s64, s70, 8192
    buffer_load_dwordx4 v20, s[32:35], s70 offen lds
    s_add_u32 m0, s63, 13312
    s_add_u32 s70, s70, 16384
    buffer_load_dwordx4 v20, s[32:35], s64 offen lds
    v_mfma_f32_32x32x16_bf16 v[96:111], v[48:51], v[180:183], v[96:111]
    v_mfma_f32_32x32x16_bf16 v[80:95], v[52:55], v[176:179], v[80:95]
    v_mfma_f32_32x32x16_bf16 v[112:127], v[52:55], v[180:183], v[112:127]
    buffer_load_dwordx4 v[176:179], v1, s[24:27], s69 offen offset:2048 sc1
    buffer_load_dwordx4 v[180:183], v1, s[24:27], s58 offen offset:2048 sc1
    s_waitcnt vmcnt(26)
    ds_read_b64_tr_b16 v[56:57], v21 offset:0
    ds_read_b64_tr_b16 v[58:59], v21 offset:1024
    ds_read_b64_tr_b16 v[60:61], v21 offset:64
    ds_read_b64_tr_b16 v[62:63], v21 offset:1088
    s_waitcnt lgkmcnt(0)
    v_mfma_f32_32x32x16_bf16 v[64:79], v[56:59], v[184:187], v[64:79]
    s_add_u32 m0, s68, 0
    s_add_u32 s64, s70, 8192
    buffer_load_dwordx4 v20, s[32:35], s70 offen lds
    s_add_u32 m0, s68, 1024
    s_add_u32 s70, s70, 16384
    buffer_load_dwordx4 v20, s[32:35], s64 offen lds
    v_mfma_f32_32x32x16_bf16 v[96:111], v[56:59], v[188:191], v[96:111]
    v_mfma_f32_32x32x16_bf16 v[80:95], v[60:63], v[184:187], v[80:95]
    v_mfma_f32_32x32x16_bf16 v[112:127], v[60:63], v[188:191], v[112:127]
    buffer_load_dwordx4 v[184:187], v1, s[24:27], s69 offen offset:3072 sc1
    buffer_load_dwordx4 v[188:191], v1, s[24:27], s58 offen offset:3072 sc1
    s_add_u32 s69, s69, 4096
    s_add_u32 s58, s58, 4096
    s_waitcnt vmcnt(26)
    ds_read_b64_tr_b16 v[48:49], v21 offset:2048
    ds_read_b64_tr_b16 v[50:51], v21 offset:3072
    ds_read_b64_tr_b16 v[52:53], v21 offset:2112
    ds_read_b64_tr_b16 v[54:55], v21 offset:3136
    s_waitcnt lgkmcnt(0)
    v_mfma_f32_32x32x16_bf16 v[64:79], v[48:51], v[128:131], v[64:79]
    s_add_u32 m0, s68, 2048
    s_add_u32 s64, s70, 8192
    buffer_load_dwordx4 v20, s[32:35], s70 offen lds
    s_add_u32 m0, s68, 3072
    s_add_u32 s70, s70, 16384
    buffer_load_dwordx4 v20, s[32:35], s64 offen lds
    v_mfma_f32_32x32x16_bf16 v[96:111], v[48:51], v[132:135], v[96:111]
    v_mfma_f32_32x32x16_bf16 v[80:95], v[52:55], v[128:131], v[80:95]
    v_mfma_f32_32x32x16_bf16 v[112:127], v[52:55], v[132:135], v[112:127]
    buffer_load_dwordx4 v[128:131], v1, s[24:27], s69 offen offset:0 sc1
    buffer_load_dwordx4 v[132:135], v1, s[24:27], s58 offen offset:0 sc1
    s_waitcnt vmcnt(26)
    ds_read_b64_tr_b16 v[56:57], v21 offset:4096
    ds_read_b64_tr_b16 v[58:59], v21 offset:5120
    ds_read_b64_tr_b16 v[60:61], v21 offset:4160
    ds_read_b64_tr_b16 v[62:63], v21 offset:5184
    s_waitcnt lgkmcnt(0)
    v_mfma_f32_32x32x16_bf16 v[64:79], v[56:59], v[136:139], v[64:79]
    s_add_u32 m0, s68, 4096
    s_add_u32 s64, s70, 8192
    buffer_load_dwordx4 v20, s[32:35], s70 offen lds
    s_add_u32 m0, s68, 5120
    s_add_u32 s70, s70, 16384
    buffer_load_dwordx4 v20, s[32:35], s64 offen lds
    v_mfma_f32_32x32x16_bf16 v[96:111], v[56:59], v[140:143], v[96:111]
    v_mfma_f32_32x32x16_bf16 v[80:95], v[60:63], v[136:139], v[80:95]
    v_mfma_f32_32x32x16_bf16 v[112:127], v[60:63], v[140:143], v[112:127]
    buffer_load_dwordx4 v[136:139], v1, s[24:27], s69 offen offset:1024 sc1
    buffer_load_dwordx4 v[140:143], v1, s[24:27], s58 offen offset:1024 sc1
    s_waitcnt vmcnt(26)
    ds_read_b64_tr_b16 v[48:49], v21 offset:6144
    ds_read_b64_tr_b16 v[50:51], v21 offset:7168
    ds_read_b64_tr_b16 v[52:53], v21 offset:6208
    ds_read_b64_tr_b16 v[54:55], v21 offset:7232
    s_waitcnt lgkmcnt(0)
    v_mfma_f32_32x32x16_bf16 v[64:79], v[48:51], v[144:147], v[64:79]
    s_add_u32 m0, s68, 6144
    s_add_u32 s64, s70, 8192
    buffer_load_dwordx4 v20, s[32:35], s70 offen lds
    s_add_u32 m0, s68, 7168
    s_add_u32 s70, s70, 16384
    buffer_load_dwordx4 v20, s[32:35], s64 offen lds
    v_mfma_f32_32x32x16_bf16 v[96:111], v[48:51], v[148:151], v[96:111]
    v_mfma_f32_32x32x16_bf16 v[80:95], v[52:55], v[144:147], v[80:95]
    v_mfma_f32_32x32x16_bf16 v[112:127], v[52:55], v[148:151], v[112:127]
    buffer_load_dwordx4 v[144:147], v1, s[24:27], s69 offen offset:2048 sc1
    buffer_load_dwordx4 v[148:151], v1, s[24:27], s58 offen offset:2048 sc1
    s_waitcnt vmcnt(26)
    ds_read_b64_tr_b16 v[56:57], v22 offset:8192
    ds_read_b64_tr_b16 v[58:59], v22 offset:9216
    ds_read_b64_tr_b16 v[60:61], v22 offset:8256
    ds_read_b64_tr_b16 v[62:63], v22 offset:9280
    s_waitcnt lgkmcnt(0)
    v_mfma_f32_32x32x16_bf16 v[64:79], v[56:59], v[152:155], v[64:79]
    s_add_u32 m0, s63, 8192
    s_add_u32 s64, s70, 8192
    buffer_load_dwordx4 v20, s[32:35], s70 offen lds
    s_add_u32 m0, s63, 9216
    s_add_u32 s70, s70, 16384
    buffer_load_dwordx4 v20, s[32:35], s64 offen lds
    v_mfma_f32_32x32x16_bf16 v[96:111], v[56:59], v[156:159], v[96:111]
    v_mfma_f32_32x32x16_bf16 v[80:95], v[60:63], v[152:155], v[80:95]
    v_mfma_f32_32x32x16_bf16 v[112:127], v[60:63], v[156:159], v[112:127]
    buffer_load_dwordx4 v[152:155], v1, s[24:27], s69 offen offset:3072 sc1
    buffer_load_dwordx4 v[156:159], v1, s[24:27], s58 offen offset:3072 sc1
    s_add_u32 s69, s69, 4096
    s_add_u32 s58, s58, 4096
    s_waitcnt vmcnt(26)
    ds_read_b64_tr_b16 v[48:49], v22 offset:10240
    ds_read_b64_tr_b16 v[50:51], v22 offset:11264
    ds_read_b64_tr_b16 v[52:53], v22 offset:10304
    ds_read_b64_tr_b16 v[54:55], v22 offset:11328
    s_waitcnt lgkmcnt(0)
    v_mfma_f32_32x32x16_bf16 v[64:79], v[48:51], v[160:163], v[64:79]
    s_add_u32 m0, s63, 10240
    s_add_u32 s64, s70, 8192
    buffer_load_dwordx4 v20, s[32:35], s70 offen lds
    s_add_u32 m0, s63, 11264
    s_add_u32 s70, s70, 16384
    buffer_load_dwordx4 v20, s[32:35], s64 offen lds
    v_mfma_f32_32x32x16_bf16 v[96:111], v[48:51], v[164:167], v[96:111]
    v_mfma_f32_32x32x16_bf16 v[80:95], v[52:55], v[160:163], v[80:95]
    v_mfma_f32_32x32x16_bf16 v[112:127], v[52:55], v[164:167], v[112:127]
    buffer_load_dwordx4 v[160:163], v1, s[24:27], s69 offen offset:0 sc1
    buffer_load_dwordx4 v[164:167], v1, s[24:27], s58 offen offset:0 sc1
    s_waitcnt vmcnt(26)
    ds_read_b64_tr_b16 v[56:57], v22 offset:12288
    ds_read_b64_tr_b16 v[58:59], v22 offset:13312
    ds_read_b64_tr_b16 v[60:61], v22 offset:12352
    ds_read_b64_tr_b16 v[62:63], v22 offset:13376
    s_waitcnt lgkmcnt(0)
    v_mfma_f32_32x32x16_bf16 v[64:79], v[56:59], v[168:171], v[64:79]
    s_add_u32 m0, s63, 12288
    s_add_u32 s64, s70, 8192
    buffer_load_dwordx4 v20, s[32:35], s70 offen lds
    s_add_u32 m0, s63, 13312
    s_add_u32 s70, s70, 16384
    buffer_load_dwordx4 v20, s[32:35], s64 offen lds
    v_mfma_f32_32x32x16_bf16 v[96:111], v[56:59], v[172:175], v[96:111]
    v_mfma_f32_32x32x16_bf16 v[80:95], v[60:63], v[168:171], v[80:95]
    v_mfma_f32_32x32x16_bf16 v[112:127], v[60:63], v[172:175], v[112:127]
    buffer_load_dwordx4 v[168:171], v1, s[24:27], s69 offen offset:1024 sc1
    buffer_load_dwordx4 v[172:175], v1, s[24:27], s58 offen offset:1024 sc1
    s_waitcnt vmcnt(26)
    ds_read_b64_tr_b16 v[48:49], v21 offset:0
    ds_read_b64_tr_b16 v[50:51], v21 offset:1024
    ds_read_b64_tr_b16 v[52:53], v21 offset:64
    ds_read_b64_tr_b16 v[54:55], v21 offset:1088
    s_waitcnt lgkmcnt(0)
    v_mfma_f32_32x32x16_bf16 v[64:79], v[48:51], v[176:179], v[64:79]
    s_add_u32 m0, s68, 0
    s_add_u32 s64, s70, 8192
    buffer_load_dwordx4 v20, s[32:35], s70 offen lds
    s_add_u32 m0, s68, 1024
    s_add_u32 s70, s70, 16384
    buffer_load_dwordx4 v20, s[32:35], s64 offen lds
    v_mfma_f32_32x32x16_bf16 v[96:111], v[48:51], v[180:183], v[96:111]
    v_mfma_f32_32x32x16_bf16 v[80:95], v[52:55], v[176:179], v[80:95]
    v_mfma_f32_32x32x16_bf16 v[112:127], v[52:55], v[180:183], v[112:127]
    buffer_load_dwordx4 v[176:179], v1, s[24:27], s69 offen offset:2048 sc1
    buffer_load_dwordx4 v[180:183], v1, s[24:27], s58 offen offset:2048 sc1
    s_waitcnt vmcnt(26)
    ds_read_b64_tr_b16 v[56:57], v21 offset:2048
    ds_read_b64_tr_b16 v[58:59], v21 offset:3072
    ds_read_b64_tr_b16 v[60:61], v21 offset:2112
    ds_read_b64_tr_b16 v[62:63], v21 offset:3136
    s_waitcnt lgkmcnt(0)
    v_mfma_f32_32x32x16_bf16 v[64:79], v[56:59], v[184:187], v[64:79]
    s_add_u32 m0, s68, 2048
    s_add_u32 s64, s70, 8192
    buffer_load_dwordx4 v20, s[32:35], s70 offen lds
    s_add_u32 m0, s68, 3072
    s_add_u32 s70, s70, 16384
    buffer_load_dwordx4 v20, s[32:35], s64 offen lds
    v_mfma_f32_32x32x16_bf16 v[96:111], v[56:59], v[188:191], v[96:111]
    v_mfma_f32_32x32x16_bf16 v[80:95], v[60:63], v[184:187], v[80:95]
    v_mfma_f32_32x32x16_bf16 v[112:127], v[60:63], v[188:191], v[112:127]
    buffer_load_dwordx4 v[184:187], v1, s[24:27], s69 offen offset:3072 sc1
    buffer_load_dwordx4 v[188:191], v1, s[24:27], s58 offen offset:3072 sc1
    s_add_u32 s69, s69, 4096
    s_add_u32 s58, s58, 4096
    s_waitcnt vmcnt(26)
    ds_read_b64_tr_b16 v[48:49], v21 offset:4096
    ds_read_b64_tr_b16 v[50:51], v21 offset:5120
    ds_read_b64_tr_b16 v[52:53], v21 offset:4160
    ds_read_b64_tr_b16 v[54:55], v21 offset:5184
    s_waitcnt lgkmcnt(0)
    v_mfma_f32_32x32x16_bf16 v[64:79], v[48:51], v[128:131], v[64:79]
    s_add_u32 m0, s68, 4096
    s_add_u32 s64, s70, 8192
    buffer_load_dwordx4 v20, s[32:35], s70 offen lds
    s_add_u32 m0, s68, 5120
    s_add_u32 s70, s70, 16384
    buffer_load_dwordx4 v20, s[32:35], s64 offen lds
    v_mfma_f32_32x32x16_bf16 v[96:111], v[48:51], v[132:135], v[96:111]
    v_mfma_f32_32x32x16_bf16 v[80:95], v[52:55], v[128:131], v[80:95]
    v_mfma_f32_32x32x16_bf16 v[112:127], v[52:55], v[132:135], v[112:127]
    buffer_load_dwordx4 v[128:131], v1, s[24:27], s69 offen offset:0 sc1
    buffer_load_dwordx4 v[132:135], v1, s[24:27], s58 offen offset:0 sc1
    s_waitcnt vmcnt(26)
    ds_read_b64_tr_b16 v[56:57], v21 offset:6144
    ds_read_b64_tr_b16 v[58:59], v21 offset:7168
    ds_read_b64_tr_b16 v[60:61], v21 offset:6208
    ds_read_b64_tr_b16 v[62:63], v21 offset:7232
    s_waitcnt lgkmcnt(0)
    v_mfma_f32_32x32x16_bf16 v[64:79], v[56:59], v[136:139], v[64:79]
    s_add_u32 m0, s68, 6144
    s_add_u32 s64, s70, 8192
    buffer_load_dwordx4 v20, s[32:35], s70 offen lds
    s_add_u32 m0, s68, 7168
    s_add_u32 s70, s70, 16384
    buffer_load_dwordx4 v20, s[32:35], s64 offen lds
    v_mfma_f32_32x32x16_bf16 v[96:111], v[56:59], v[140:143], v[96:111]
    v_mfma_f32_32x32x16_bf16 v[80:95], v[60:63], v[136:139], v[80:95]
    v_mfma_f32_32x32x16_bf16 v[112:127], v[60:63], v[140:143], v[112:127]
    buffer_load_dwordx4 v[136:139], v1, s[24:27], s69 offen offset:1024 sc1
    buffer_load_dwordx4 v[140:143], v1, s[24:27], s58 offen offset:1024 sc1
    s_waitcnt vmcnt(26)
    ds_read_b64_tr_b16 v[48:49], v22 offset:8192
    ds_read_b64_tr_b16 v[50:51], v22 offset:9216
    ds_read_b64_tr_b16 v[52:53], v22 offset:8256
    ds_read_b64_tr_b16 v[54:55], v22 offset:9280
    s_waitcnt lgkmcnt(0)
    v_mfma_f32_32x32x16_bf16 v[64:79], v[48:51], v[144:147], v[64:79]
    s_add_u32 m0, s63, 8192
    s_add_u32 s64, s70, 8192
    buffer_load_dwordx4 v20, s[32:35], s70 offen lds
    s_add_u32 m0, s63, 9216
    s_add_u32 s70, s70, 16384
    buffer_load_dwordx4 v20, s[32:35], s64 offen lds
    v_mfma_f32_32x32x16_bf16 v[96:111], v[48:51], v[148:151], v[96:111]
    v_mfma_f32_32x32x16_bf16 v[80:95], v[52:55], v[144:147], v[80:95]
    v_mfma_f32_32x32x16_bf16 v[112:127], v[52:55], v[148:151], v[112:127]
    buffer_load_dwordx4 v[144:147], v1, s[24:27], s69 offen offset:2048 sc1
    buffer_load_dwordx4 v[148:151], v1, s[24:27], s58 offen offset:2048 sc1
    s_waitcnt vmcnt(26)
    ds_read_b64_tr_b16 v[56:57], v22 offset:10240
    ds_read_b64_tr_b16 v[58:59], v22 offset:11264
    ds_read_b64_tr_b16 v[60:61], v22 offset:10304
    ds_read_b64_tr_b16 v[62:63], v22 offset:11328
    s_waitcnt lgkmcnt(0)
    v_mfma_f32_32x32x16_bf16 v[64:79], v[56:59], v[152:155], v[64:79]
    s_add_u32 m0, s63, 10240
    s_add_u32 s64, s70, 8192
    buffer_load_dwordx4 v20, s[32:35], s70 offen lds
    s_add_u32 m0, s63, 11264
    s_add_u32 s70, s70, 16384
    buffer_load_dwordx4 v20, s[32:35], s64 offen lds
    v_mfma_f32_32x32x16_bf16 v[96:111], v[56:59], v[156:159], v[96:111]
    v_mfma_f32_32x32x16_bf16 v[80:95], v[60:63], v[152:155], v[80:95]
    v_mfma_f32_32x32x16_bf16 v[112:127], v[60:63], v[156:159], v[112:127]
    buffer_load_dwordx4 v[152:155], v1, s[24:27], s69 offen offset:3072 sc1
    buffer_load_dwordx4 v[156:159], v1, s[24:27], s58 offen offset:3072 sc1
    s_add_u32 s69, s69, 4096
    s_add_u32 s58, s58, 4096
    s_waitcnt vmcnt(26)
    ds_read_b64_tr_b16 v[48:49], v22 offset:12288
    ds_read_b64_tr_b16 v[50:51], v22 offset:13312
    ds_read_b64_tr_b16 v[52:53], v22 offset:12352
    ds_read_b64_tr_b16 v[54:55], v22 offset:13376
    s_waitcnt lgkmcnt(0)
    v_mfma_f32_32x32x16_bf16 v[64:79], v[48:51], v[160:163], v[64:79]
    s_add_u32 m0, s63, 12288
    s_add_u32 s64, s70, 8192
    buffer_load_dwordx4 v20, s[32:35], s70 offen lds
    s_add_u32 m0, s63, 13312
    s_add_u32 s70, s70, 16384
    buffer_load_dwordx4 v20, s[32:35], s64 offen lds
    v_mfma_f32_32x32x16_bf16 v[96:111], v[48:51], v[164:167], v[96:111]
    v_mfma_f32_32x32x16_bf16 v[80:95], v[52:55], v[160:163], v[80:95]
    v_mfma_f32_32x32x16_bf16 v[112:127], v[52:55], v[164:167], v[112:127]
    s_waitcnt vmcnt(24)
    ds_read_b64_tr_b16 v[56:57], v21 offset:0
    ds_read_b64_tr_b16 v[58:59], v21 offset:1024
    ds_read_b64_tr_b16 v[60:61], v21 offset:64
    ds_read_b64_tr_b16 v[62:63], v21 offset:1088
    s_waitcnt lgkmcnt(0)
    v_mfma_f32_32x32x16_bf16 v[64:79], v[56:59], v[168:171], v[64:79]
    v_mfma_f32_32x32x16_bf16 v[96:111], v[56:59], v[172:175], v[96:111]
    v_mfma_f32_32x32x16_bf16 v[80:95], v[60:63], v[168:171], v[80:95]
    v_mfma_f32_32x32x16_bf16 v[112:127], v[60:63], v[172:175], v[112:127]
    s_waitcnt vmcnt(20)
    ds_read_b64_tr_b16 v[48:49], v21 offset:2048
    ds_read_b64_tr_b16 v[50:51], v21 offset:3072
    ds_read_b64_tr_b16 v[52:53], v21 offset:2112
    ds_read_b64_tr_b16 v[54:55], v21 offset:3136
    s_waitcnt lgkmcnt(0)
    v_mfma_f32_32x32x16_bf16 v[64:79], v[48:51], v[176:179], v[64:79]
    v_mfma_f32_32x32x16_bf16 v[96:111], v[48:51], v[180:183], v[96:111]
    v_mfma_f32_32x32x16_bf16 v[80:95], v[52:55], v[176:179], v[80:95]
    v_mfma_f32_32x32x16_bf16 v[112:127], v[52:55], v[180:183], v[112:127]
    s_waitcnt vmcnt(16)
    ds_read_b64_tr_b16 v[56:57], v21 offset:4096
    ds_read_b64_tr_b16 v[58:59], v21 offset:5120
    ds_read_b64_tr_b16 v[60:61], v21 offset:4160
    ds_read_b64_tr_b16 v[62:63], v21 offset:5184
    s_waitcnt lgkmcnt(0)
    v_mfma_f32_32x32x16_bf16 v[64:79], v[56:59], v[184:187], v[64:79]
    v_mfma_f32_32x32x16_bf16 v[96:111], v[56:59], v[188:191], v[96:111]
    v_mfma_f32_32x32x16_bf16 v[80:95], v[60:63], v[184:187], v[80:95]
    v_mfma_f32_32x32x16_bf16 v[112:127], v[60:63], v[188:191], v[112:127]
    s_waitcnt vmcnt(12)
    ds_read_b64_tr_b16 v[48:49], v21 offset:6144
    ds_read_b64_tr_b16 v[50:51], v21 offset:7168
    ds_read_b64_tr_b16 v[52:53], v21 offset:6208
    ds_read_b64_tr_b16 v[54:55], v21 offset:7232
    s_waitcnt lgkmcnt(0)
    v_mfma_f32_32x32x16_bf16 v[64:79], v[48:51], v[128:131], v[64:79]
    v_mfma_f32_32x32x16_bf16 v[96:111], v[48:51], v[132:135], v[96:111]
    v_mfma_f32_32x32x16_bf16 v[80:95], v[52:55], v[128:131], v[80:95]
    v_mfma_f32_32x32x16_bf16 v[112:127], v[52:55], v[132:135], v[112:127]
    s_waitcnt vmcnt(8)
    ds_read_b64_tr_b16 v[56:57], v22 offset:8192
    ds_read_b64_tr_b16 v[58:59], v22 offset:9216
    ds_read_b64_tr_b16 v[60:61], v22 offset:8256
    ds_read_b64_tr_b16 v[62:63], v22 offset:9280
    s_waitcnt lgkmcnt(0)
    v_mfma_f32_32x32x16_bf16 v[64:79], v[56:59], v[136:139], v[64:79]
    v_mfma_f32_32x32x16_bf16 v[96:111], v[56:59], v[140:143], v[96:111]
    v_mfma_f32_32x32x16_bf16 v[80:95], v[60:63], v[136:139], v[80:95]
    v_mfma_f32_32x32x16_bf16 v[112:127], v[60:63], v[140:143], v[112:127]
    s_waitcnt vmcnt(4)
    ds_read_b64_tr_b16 v[48:49], v22 offset:10240
    ds_read_b64_tr_b16 v[50:51], v22 offset:11264
    ds_read_b64_tr_b16 v[52:53], v22 offset:10304
    ds_read_b64_tr_b16 v[54:55], v22 offset:11328
    s_waitcnt lgkmcnt(0)
    v_mfma_f32_32x32x16_bf16 v[64:79], v[48:51], v[144:147], v[64:79]
    v_mfma_f32_32x32x16_bf16 v[96:111], v[48:51], v[148:151], v[96:111]
    v_mfma_f32_32x32x16_bf16 v[80:95], v[52:55], v[144:147], v[80:95]
    v_mfma_f32_32x32x16_bf16 v[112:127], v[52:55], v[148:151], v[112:127]
    s_waitcnt vmcnt(0)
    ds_read_b64_tr_b16 v[56:57], v22 offset:12288
    ds_read_b64_tr_b16 v[58:59], v22 offset:13312
    ds_read_b64_tr_b16 v[60:61], v22 offset:12352
    ds_read_b64_tr_b16 v[62:63], v22 offset:13376
    s_waitcnt lgkmcnt(0)
    v_mfma_f32_32x32x16_bf16 v[64:79], v[56:59], v[152:155], v[64:79]
    v_mfma_f32_32x32x16_bf16 v[96:111], v[56:59], v[156:159], v[96:111]
    v_mfma_f32_32x32x16_bf16 v[80:95], v[60:63], v[152:155], v[80:95]
    v_mfma_f32_32x32x16_bf16 v[112:127], v[60:63], v[156:159], v[112:127]
    s_lshl_b32 s65, s54, 6
    s_lshl_b32 s57, s56, 2
    s_add_u32 s65, s65, s57
    s_add_u32 s65, s65, 48
    s_lshl_b32 s65, s65, 11
    s_mov_b32 s66, s68
    s_mov_b32 m0, s66
    s_add_u32 s66, s66, 2080
    buffer_load_dwordx4 v1, s[24:27], s65 offen sc1 lds
    buffer_load_dwordx4 v1, s[24:27], s65 offen offset:1024 sc1 lds
    s_add_u32 s65, s65, 2048
    s_mov_b32 m0, s66
    s_add_u32 s66, s66, 2080
    buffer_load_dwordx4 v1, s[24:27], s65 offen sc1 lds
    buffer_load_dwordx4 v1, s[24:27], s65 offen offset:1024 sc1 lds
    s_add_u32 s65, s65, 2048
    s_mov_b32 m0, s66
    s_add_u32 s66, s66, 2080
    buffer_load_dwordx4 v1, s[24:27], s65 offen sc1 lds
    buffer_load_dwordx4 v1, s[24:27], s65 offen offset:1024 sc1 lds
    s_add_u32 s65, s65, 2048
    s_mov_b32 m0, s66
    s_add_u32 s66, s66, 2080
    buffer_load_dwordx4 v1, s[24:27], s65 offen sc1 lds
    buffer_load_dwordx4 v1, s[24:27], s65 offen offset:1024 sc1 lds
    s_add_u32 s65, s65, 2048
    ds_write_b128 v24, v[16:19] offset:2048
    ds_write_b128 v24, v[28:31] offset:2064
    s_mov_b32 s36, s4
    s_mov_b32 s37, s5
    s_mov_b32 s38, 2097152
    s_mov_b32 s39, 0x00020000
    s_mov_b32 s32, s18
    s_mov_b32 s33, s19
    s_mov_b32 s34, 2097152
    s_mov_b32 s35, 0x00020000
    s_lshl_b32 s59, s50, 1
    s_lshr_b32 s57, s56, 1
    s_add_u32 s59, s59, s57
    s_mov_b32 s60, s59
    s_lshl_b32 s59, s59, 15
    s_lshl_b32 s57, s51, 7
    s_add_u32 s59, s59, s57
    s_and_b32 s57, s56, 1
    s_lshl_b32 s57, s57, 6
    s_add_u32 s59, s59, s57
    buffer_load_dwordx2 v[8:9], v26, s[36:39], s59 offen offset:0
    buffer_load_dwordx2 v[10:11], v26, s[36:39], s59 offen offset:16
    buffer_load_dwordx2 v[12:13], v26, s[36:39], s59 offen offset:32
    buffer_load_dwordx2 v[14:15], v26, s[36:39], s59 offen offset:48
    s_waitcnt vmcnt(0) lgkmcnt(0)
    s_barrier
    ds_write_b128 v25, v[64:67] offset:0
    ds_write_b128 v25, v[68:71] offset:1024
    ds_write_b128 v25, v[72:75] offset:2048
    ds_write_b128 v25, v[76:79] offset:3072
    ds_write_b128 v25, v[80:83] offset:16384
    ds_write_b128 v25, v[84:87] offset:17408
    ds_write_b128 v25, v[88:91] offset:18432
    ds_write_b128 v25, v[92:95] offset:19456
    ds_write_b128 v25, v[96:99] offset:32768
    ds_write_b128 v25, v[100:103] offset:33792
    ds_write_b128 v25, v[104:107] offset:34816
    ds_write_b128 v25, v[108:111] offset:35840
    ds_write_b128 v25, v[112:115] offset:49152
    ds_write_b128 v25, v[116:119] offset:50176
    ds_write_b128 v25, v[120:123] offset:51200
    ds_write_b128 v25, v[124:127] offset:52224
    s_waitcnt lgkmcnt(0)
    s_lshl_b32 s68, s56, 13
    s_add_u32 s68, s68, 65536
    s_and_b32 s57, s56, 1
    s_lshl_b32 s70, s57, 18
    s_lshl_b32 s57, s51, 7
    s_add_u32 s62, s70, s57
    s_add_u32 s65, s48, 1
    s_and_b32 s65, s65, 3
    s_add_u32 s66, s48, 2
    s_and_b32 s66, s66, 3
    s_add_u32 s61, s48, 3
    s_and_b32 s61, s61, 3
    s_add_u32 s71, s48, 4
    s_and_b32 s71, s71, 3
    s_barrier
    s_lshl_b32 s70, s65, 16
    s_add_u32 s70, s70, s62
    s_add_u32 m0, s68, 0
    s_add_u32 s64, s70, 8192
    buffer_load_dwordx4 v20, s[28:31], s70 offen lds
    s_add_u32 m0, s68, 1024
    s_add_u32 s70, s70, 16384
    buffer_load_dwordx4 v20, s[28:31], s64 offen lds
    s_add_u32 m0, s68, 2048
    s_add_u32 s64, s70, 8192
    buffer_load_dwordx4 v20, s[28:31], s70 offen lds
    s_add_u32 m0, s68, 3072
    s_add_u32 s70, s70, 16384
    buffer_load_dwordx4 v20, s[28:31], s64 offen lds
    s_add_u32 m0, s68, 4096
    s_add_u32 s64, s70, 8192
    buffer_load_dwordx4 v20, s[28:31], s70 offen lds
    s_add_u32 m0, s68, 5120
    s_add_u32 s70, s70, 16384
    buffer_load_dwordx4 v20, s[28:31], s64 offen lds
    s_add_u32 m0, s68, 6144
    s_add_u32 s64, s70, 8192
    buffer_load_dwordx4 v20, s[28:31], s70 offen lds
    s_add_u32 m0, s68, 7168
    s_add_u32 s70, s70, 16384
    buffer_load_dwordx4 v20, s[28:31], s64 offen lds
    s_lshl_b32 s70, s66, 16
    s_add_u32 s70, s70, s62
    s_add_u32 m0, s63, 8192
    s_add_u32 s64, s70, 8192
    buffer_load_dwordx4 v20, s[28:31], s70 offen lds
    s_add_u32 m0, s63, 9216
    s_add_u32 s70, s70, 16384
    buffer_load_dwordx4 v20, s[28:31], s64 offen lds
    s_add_u32 m0, s63, 10240
    s_add_u32 s64, s70, 8192
    buffer_load_dwordx4 v20, s[28:31], s70 offen lds
    s_add_u32 m0, s63, 11264
    s_add_u32 s70, s70, 16384
    buffer_load_dwordx4 v20, s[28:31], s64 offen lds
    s_add_u32 m0, s63, 12288
    s_add_u32 s64, s70, 8192
    buffer_load_dwordx4 v20, s[28:31], s70 offen lds
    s_add_u32 m0, s63, 13312
    s_add_u32 s70, s70, 16384
    buffer_load_dwordx4 v20, s[28:31], s64 offen lds
    s_waitcnt vmcnt(12)
    ds_read_b64_tr_b16 v[128:129], v32 offset:0
    ds_read_b64_tr_b16 v[130:131], v32 offset:1024
    ds_read_b64_tr_b16 v[132:133], v34 offset:0
    ds_read_b64_tr_b16 v[134:135], v34 offset:1024
    s_waitcnt lgkmcnt(0)
    s_add_u32 m0, s68, 0
    s_add_u32 s64, s70, 8192
    buffer_load_dwordx4 v20, s[28:31], s70 offen lds
    s_add_u32 m0, s68, 1024
    s_add_u32 s70, s70, 16384
    buffer_load_dwordx4 v20, s[28:31], s64 offen lds
    s_waitcnt vmcnt(12)
    ds_read_b64_tr_b16 v[136:137], v32 offset:2048
    ds_read_b64_tr_b16 v[138:139], v32 offset:3072
    ds_read_b64_tr_b16 v[140:141], v34 offset:2048
    ds_read_b64_tr_b16 v[142:143], v34 offset:3072
    s_waitcnt lgkmcnt(0)
    s_lshl_b32 s70, s61, 16
    s_add_u32 s70, s70, s62
    s_add_u32 m0, s68, 2048
    s_add_u32 s64, s70, 8192
    buffer_load_dwordx4 v20, s[28:31], s70 offen lds
    s_add_u32 m0, s68, 3072
    s_add_u32 s70, s70, 16384
    buffer_load_dwordx4 v20, s[28:31], s64 offen lds
    s_waitcnt vmcnt(12)
    ds_read_b64_tr_b16 v[144:145], v32 offset:4096
    ds_read_b64_tr_b16 v[146:147], v32 offset:5120
    ds_read_b64_tr_b16 v[148:149], v34 offset:4096
    ds_read_b64_tr_b16 v[150:151], v34 offset:5120
    s_waitcnt lgkmcnt(0)
    s_add_u32 m0, s68, 4096
    s_add_u32 s64, s70, 8192
    buffer_load_dwordx4 v20, s[28:31], s70 offen lds
    s_add_u32 m0, s68, 5120
    s_add_u32 s70, s70, 16384
    buffer_load_dwordx4 v20, s[28:31], s64 offen lds
    s_waitcnt vmcnt(12)
    ds_read_b64_tr_b16 v[152:153], v32 offset:6144
    ds_read_b64_tr_b16 v[154:155], v32 offset:7168
    ds_read_b64_tr_b16 v[156:157], v34 offset:6144
    ds_read_b64_tr_b16 v[158:159], v34 offset:7168
    s_waitcnt lgkmcnt(0)
    s_add_u32 m0, s68, 6144
    s_add_u32 s64, s70, 8192
    buffer_load_dwordx4 v20, s[28:31], s70 offen lds
    s_add_u32 m0, s68, 7168
    s_add_u32 s70, s70, 16384
    buffer_load_dwordx4 v20, s[28:31], s64 offen lds
    s_waitcnt vmcnt(12)
    ds_read_b64_tr_b16 v[160:161], v33 offset:8192
    ds_read_b64_tr_b16 v[162:163], v33 offset:9216
    ds_read_b64_tr_b16 v[164:165], v35 offset:8192
    ds_read_b64_tr_b16 v[166:167], v35 offset:9216
    s_waitcnt lgkmcnt(0)
    s_add_u32 m0, s63, 8192
    s_add_u32 s64, s70, 8192
    buffer_load_dwordx4 v20, s[28:31], s70 offen lds
    s_add_u32 m0, s63, 9216
    s_add_u32 s70, s70, 16384
    buffer_load_dwordx4 v20, s[28:31], s64 offen lds
    s_waitcnt vmcnt(12)
    ds_read_b64_tr_b16 v[168:169], v33 offset:10240
    ds_read_b64_tr_b16 v[170:171], v33 offset:11264
    ds_read_b64_tr_b16 v[172:173], v35 offset:10240
    ds_read_b64_tr_b16 v[174:175], v35 offset:11264
    s_waitcnt lgkmcnt(0)
    s_lshl_b32 s70, s71, 16
    s_add_u32 s70, s70, s62
    s_add_u32 m0, s63, 10240
    s_add_u32 s64, s70, 8192
    buffer_load_dwordx4 v20, s[28:31], s70 offen lds
    s_add_u32 m0, s63, 11264
    s_add_u32 s70, s70, 16384
    buffer_load_dwordx4 v20, s[28:31], s64 offen lds
    s_waitcnt vmcnt(12)
    ds_read_b64_tr_b16 v[176:177], v33 offset:12288
    ds_read_b64_tr_b16 v[178:179], v33 offset:13312
    ds_read_b64_tr_b16 v[180:181], v35 offset:12288
    ds_read_b64_tr_b16 v[182:183], v35 offset:13312
    s_waitcnt lgkmcnt(0)
    s_add_u32 m0, s63, 12288
    s_add_u32 s64, s70, 8192
    buffer_load_dwordx4 v20, s[28:31], s70 offen lds
    s_add_u32 m0, s63, 13312
    s_add_u32 s70, s70, 16384
    buffer_load_dwordx4 v20, s[28:31], s64 offen lds
    s_waitcnt vmcnt(12)
    ds_read_b64_tr_b16 v[184:185], v32 offset:0
    ds_read_b64_tr_b16 v[186:187], v32 offset:1024
    ds_read_b64_tr_b16 v[188:189], v34 offset:0
    ds_read_b64_tr_b16 v[190:191], v34 offset:1024
    s_waitcnt lgkmcnt(0)
    s_add_u32 m0, s68, 0
    s_add_u32 s64, s70, 8192
    buffer_load_dwordx4 v20, s[28:31], s70 offen lds
    s_add_u32 m0, s68, 1024
    s_add_u32 s70, s70, 16384
    buffer_load_dwordx4 v20, s[28:31], s64 offen lds
    s_waitcnt vmcnt(12)
    ds_read_b64_tr_b16 v[192:193], v32 offset:2048
    ds_read_b64_tr_b16 v[194:195], v32 offset:3072
    ds_read_b64_tr_b16 v[196:197], v34 offset:2048
    ds_read_b64_tr_b16 v[198:199], v34 offset:3072
    s_waitcnt lgkmcnt(0)
    s_add_u32 m0, s68, 2048
    s_add_u32 s64, s70, 8192
    buffer_load_dwordx4 v20, s[28:31], s70 offen lds
    s_add_u32 m0, s68, 3072
    s_add_u32 s70, s70, 16384
    buffer_load_dwordx4 v20, s[28:31], s64 offen lds
    s_waitcnt vmcnt(12)
    ds_read_b64_tr_b16 v[200:201], v32 offset:4096
    ds_read_b64_tr_b16 v[202:203], v32 offset:5120
    ds_read_b64_tr_b16 v[204:205], v34 offset:4096
    ds_read_b64_tr_b16 v[206:207], v34 offset:5120
    s_waitcnt vmcnt(10)
    ds_read_b64_tr_b16 v[208:209], v32 offset:6144
    ds_read_b64_tr_b16 v[210:211], v32 offset:7168
    ds_read_b64_tr_b16 v[212:213], v34 offset:6144
    ds_read_b64_tr_b16 v[214:215], v34 offset:7168
    s_waitcnt vmcnt(8)
    ds_read_b64_tr_b16 v[216:217], v33 offset:8192
    ds_read_b64_tr_b16 v[218:219], v33 offset:9216
    ds_read_b64_tr_b16 v[220:221], v35 offset:8192
    ds_read_b64_tr_b16 v[222:223], v35 offset:9216
    s_waitcnt vmcnt(6)
    ds_read_b64_tr_b16 v[224:225], v33 offset:10240
    ds_read_b64_tr_b16 v[226:227], v33 offset:11264
    ds_read_b64_tr_b16 v[228:229], v35 offset:10240
    ds_read_b64_tr_b16 v[230:231], v35 offset:11264
    s_waitcnt vmcnt(4)
    ds_read_b64_tr_b16 v[232:233], v33 offset:12288
    ds_read_b64_tr_b16 v[234:235], v33 offset:13312
    ds_read_b64_tr_b16 v[236:237], v35 offset:12288
    ds_read_b64_tr_b16 v[238:239], v35 offset:13312
    s_waitcnt vmcnt(2)
    ds_read_b64_tr_b16 v[240:241], v32 offset:0
    ds_read_b64_tr_b16 v[242:243], v32 offset:1024
    ds_read_b64_tr_b16 v[244:245], v34 offset:0
    ds_read_b64_tr_b16 v[246:247], v34 offset:1024
    s_waitcnt vmcnt(0)
    ds_read_b64_tr_b16 v[248:249], v32 offset:2048
    ds_read_b64_tr_b16 v[250:251], v32 offset:3072
    ds_read_b64_tr_b16 v[252:253], v34 offset:2048
    ds_read_b64_tr_b16 v[254:255], v34 offset:3072
    s_waitcnt lgkmcnt(0)
    ds_read_b128 v[48:51], v6 offset:0
    ds_read_b128 v[52:55], v6 offset:1024
    ds_read_b128 v[56:59], v6 offset:2048
    ds_read_b128 v[60:63], v6 offset:3072
    ds_read_b128 v[32:35], v6 offset:4096
    ds_read_b128 v[36:39], v6 offset:5120
    ds_read_b128 v[40:43], v6 offset:6144
    ds_read_b128 v[44:47], v6 offset:7168
    ds_read_b128 v[16:19], v6 offset:8192
    ds_read_b128 v[20:23], v6 offset:9216
    ds_read_b128 v[24:27], v6 offset:10240
    ds_read_b128 v[28:31], v6 offset:11264
    s_and_b32 s57, s56, 1
    s_lshl_b32 s57, s57, 4
    s_lshl_b32 s68, s50, 5
    s_add_u32 s68, s68, s57
    s_lshl_b32 s68, s68, 7
    s_add_u32 s68, s68, 17039360
    s_and_b32 s57, s56, 1
    s_lshl_b32 s57, s57, 4
    s_lshl_b32 s58, s60, 5
    s_add_u32 s58, s58, s57
    s_lshl_b32 s58, s58, 10
    s_add_u32 s58, s58, 6291456
    s_lshl_b32 s65, s65, 12
    s_add_u32 s65, s65, s58
    s_lshl_b32 s66, s66, 12
    s_add_u32 s66, s66, s58
    s_lshl_b32 s61, s61, 12
    s_add_u32 s61, s61, s58
    s_lshl_b32 s71, s71, 12
    s_add_u32 s71, s71, s58
    s_mov_b32 s57, 0xbf317218
    s_mov_b32 s63, 0x40402d8f
    s_waitcnt vmcnt(0) lgkmcnt(0)
    s_barrier
    v_add_f32 v48, v48, v32
    v_add_f32 v49, v49, v33
    v_add_f32 v50, v50, v34
    v_add_f32 v51, v51, v35
    v_add_f32 v52, v52, v36
    v_add_f32 v53, v53, v37
    v_add_f32 v54, v54, v38
    v_add_f32 v55, v55, v39
    v_add_f32 v56, v56, v40
    v_add_f32 v57, v57, v41
    v_add_f32 v58, v58, v42
    v_add_f32 v59, v59, v43
    v_add_f32 v60, v60, v44
    v_add_f32 v61, v61, v45
    v_add_f32 v62, v62, v46
    v_add_f32 v63, v63, v47
    ds_read_b128 v[32:35], v6 offset:12288
    ds_read_b128 v[36:39], v6 offset:13312
    ds_read_b128 v[40:43], v6 offset:14336
    ds_read_b128 v[44:47], v6 offset:15360
    v_add_f32 v48, v48, v16
    v_add_f32 v49, v49, v17
    v_add_f32 v50, v50, v18
    v_add_f32 v51, v51, v19
    v_add_f32 v52, v52, v20
    v_add_f32 v53, v53, v21
    v_add_f32 v54, v54, v22
    v_add_f32 v55, v55, v23
    v_add_f32 v56, v56, v24
    v_add_f32 v57, v57, v25
    v_add_f32 v58, v58, v26
    v_add_f32 v59, v59, v27
    v_add_f32 v60, v60, v28
    v_add_f32 v61, v61, v29
    v_add_f32 v62, v62, v30
    v_add_f32 v63, v63, v31
    s_waitcnt lgkmcnt(0)
    v_add_f32 v48, v48, v32
    v_add_f32 v49, v49, v33
    v_add_f32 v50, v50, v34
    v_add_f32 v51, v51, v35
    v_add_f32 v52, v52, v36
    v_add_f32 v53, v53, v37
    v_add_f32 v54, v54, v38
    v_add_f32 v55, v55, v39
    v_add_f32 v56, v56, v40
    v_add_f32 v57, v57, v41
    v_add_f32 v58, v58, v42
    v_add_f32 v59, v59, v43
    v_add_f32 v60, v60, v44
    v_add_f32 v61, v61, v45
    v_add_f32 v62, v62, v46
    v_add_f32 v63, v63, v47
    s_mov_b32 s67, 1048576
L_poll_o:
    buffer_load_dword v4, v5, s[24:27], s68 offen sc1
    s_waitcnt vmcnt(0)
L_poll_o_chk:
    v_cmp_ne_u32 vcc, 1, v4
    s_nop 0
    s_cbranch_vccz L_poll_o_ok
    s_sub_u32 s67, s67, 1
    s_cbranch_scc1 L_poll_o_ok
    s_sleep 2
    s_branch L_poll_o
L_poll_o_ok:
    s_mov_b32 s70, 1048576
    buffer_load_dwordx4 v[64:67], v1, s[24:27], s65 offen offset:0 sc1
    buffer_load_dwordx4 v[68:71], v1, s[24:27], s65 offen offset:1024 sc1
    buffer_load_dwordx4 v[72:75], v1, s[24:27], s65 offen offset:2048 sc1
    buffer_load_dwordx4 v[76:79], v1, s[24:27], s65 offen offset:3072 sc1
    v_mul_f32 v16, s57, v48
    v_mul_f32 v17, s57, v49
    v_mul_f32 v18, s57, v50
    v_mul_f32 v19, s57, v51
    v_mul_f32 v20, s57, v52
    v_mul_f32 v21, s57, v53
    v_mul_f32 v22, s57, v54
    buffer_load_dwordx4 v[80:83], v1, s[24:27], s66 offen offset:0 sc1
    v_mul_f32 v23, s57, v55
    v_mul_f32 v24, s57, v56
    v_mul_f32 v25, s57, v57
    v_mul_f32 v26, s57, v58
    v_mul_f32 v27, s57, v59
    v_mul_f32 v28, s57, v60
    v_mul_f32 v29, s57, v61
    buffer_load_dwordx4 v[84:87], v1, s[24:27], s66 offen offset:1024 sc1
    v_mul_f32 v30, s57, v62
    v_mul_f32 v31, s57, v63
    v_exp_f32 v16, v16
    v_exp_f32 v17, v17
    v_exp_f32 v18, v18
    v_exp_f32 v19, v19
    v_exp_f32 v20, v20
    buffer_load_dwordx4 v[88:91], v1, s[24:27], s66 offen offset:2048 sc1
    v_exp_f32 v21, v21
    v_exp_f32 v22, v22
    v_exp_f32 v23, v23
    v_exp_f32 v24, v24
    v_exp_f32 v25, v25
    v_exp_f32 v26, v26
    v_exp_f32 v27, v27
    buffer_load_dwordx4 v[92:95], v1, s[24:27], s66 offen offset:3072 sc1
    v_exp_f32 v28, v28
    v_exp_f32 v29, v29
    v_exp_f32 v30, v30
    v_exp_f32 v31, v31
    v_fma_f32 v16, v16, s63, s63
    v_fma_f32 v17, v17, s63, s63
    v_fma_f32 v18, v18, s63, s63
    buffer_load_dwordx4 v[96:99], v1, s[24:27], s61 offen offset:0 sc1
    v_fma_f32 v19, v19, s63, s63
    v_fma_f32 v20, v20, s63, s63
    v_fma_f32 v21, v21, s63, s63
    v_fma_f32 v22, v22, s63, s63
    v_fma_f32 v23, v23, s63, s63
    v_fma_f32 v24, v24, s63, s63
    v_fma_f32 v25, v25, s63, s63
    buffer_load_dwordx4 v[100:103], v1, s[24:27], s61 offen offset:1024 sc1
    v_fma_f32 v26, v26, s63, s63
    v_fma_f32 v27, v27, s63, s63
    v_fma_f32 v28, v28, s63, s63
    v_fma_f32 v29, v29, s63, s63
    v_fma_f32 v30, v30, s63, s63
    v_fma_f32 v31, v31, s63, s63
    v_rcp_f32 v16, v16
    buffer_load_dwordx4 v[104:107], v1, s[24:27], s61 offen offset:2048 sc1
    v_rcp_f32 v17, v17
    v_rcp_f32 v18, v18
    v_rcp_f32 v19, v19
    v_rcp_f32 v20, v20
    v_rcp_f32 v21, v21
    v_rcp_f32 v22, v22
    v_rcp_f32 v23, v23
    buffer_load_dwordx4 v[108:111], v1, s[24:27], s61 offen offset:3072 sc1
    v_rcp_f32 v24, v24
    v_rcp_f32 v25, v25
    v_rcp_f32 v26, v26
    v_rcp_f32 v27, v27
    v_rcp_f32 v28, v28
    v_rcp_f32 v29, v29
    v_rcp_f32 v30, v30
    buffer_load_dwordx4 v[112:115], v1, s[24:27], s71 offen offset:0 sc1
    v_rcp_f32 v31, v31
    v_mul_f32 v48, v48, v16
    v_mul_f32 v49, v49, v17
    v_mul_f32 v50, v50, v18
    v_mul_f32 v51, v51, v19
    v_mul_f32 v52, v52, v20
    v_mul_f32 v53, v53, v21
    buffer_load_dwordx4 v[116:119], v1, s[24:27], s71 offen offset:1024 sc1
    v_mul_f32 v54, v54, v22
    v_mul_f32 v55, v55, v23
    v_mul_f32 v56, v56, v24
    v_mul_f32 v57, v57, v25
    v_mul_f32 v58, v58, v26
    v_mul_f32 v59, v59, v27
    v_mul_f32 v60, v60, v28
    buffer_load_dwordx4 v[120:123], v1, s[24:27], s71 offen offset:2048 sc1
    v_mul_f32 v61, v61, v29
    v_mul_f32 v62, v62, v30
    v_mul_f32 v63, v63, v31
    buffer_load_dwordx4 v[124:127], v1, s[24:27], s71 offen offset:3072 sc1
    s_branch L_o_mm
L_o_again:
    buffer_load_dwordx4 v[64:67], v1, s[24:27], s65 offen offset:0 sc1
    buffer_load_dwordx4 v[68:71], v1, s[24:27], s65 offen offset:1024 sc1
    buffer_load_dwordx4 v[72:75], v1, s[24:27], s65 offen offset:2048 sc1
    buffer_load_dwordx4 v[76:79], v1, s[24:27], s65 offen offset:3072 sc1
    buffer_load_dwordx4 v[80:83], v1, s[24:27], s66 offen offset:0 sc1
    buffer_load_dwordx4 v[84:87], v1, s[24:27], s66 offen offset:1024 sc1
    buffer_load_dwordx4 v[88:91], v1, s[24:27], s66 offen offset:2048 sc1
    buffer_load_dwordx4 v[92:95], v1, s[24:27], s66 offen offset:3072 sc1
    buffer_load_dwordx4 v[96:99], v1, s[24:27], s61 offen offset:0 sc1
    buffer_load_dwordx4 v[100:103], v1, s[24:27], s61 offen offset:1024 sc1
    buffer_load_dwordx4 v[104:107], v1, s[24:27], s61 offen offset:2048 sc1
    buffer_load_dwordx4 v[108:111], v1, s[24:27], s61 offen offset:3072 sc1
    buffer_load_dwordx4 v[112:115], v1, s[24:27], s71 offen offset:0 sc1
    buffer_load_dwordx4 v[116:119], v1, s[24:27], s71 offen offset:1024 sc1
    buffer_load_dwordx4 v[120:123], v1, s[24:27], s71 offen offset:2048 sc1
    buffer_load_dwordx4 v[124:127], v1, s[24:27], s71 offen offset:3072 sc1
L_o_mm:
    s_waitcnt vmcnt(15)
    v_mfma_f32_32x32x16_bf16 v[32:47], v[132:135], v[64:67], 0
    v_max_u32 v4, v64, v65
    v_mfma_f32_32x32x16_bf16 v[16:31], v[128:131], v[64:67], 0
    v_max3_u32 v4, v4, v66, v67
    s_waitcnt vmcnt(14)
    v_mfma_f32_32x32x16_bf16 v[32:47], v[140:143], v[68:71], v[32:47]
    v_max3_u32 v4, v4, v68, v69
    v_mfma_f32_32x32x16_bf16 v[16:31], v[136:139], v[68:71], v[16:31]
    v_max3_u32 v4, v4, v70, v71
    s_waitcnt vmcnt(13)
    v_mfma_f32_32x32x16_bf16 v[32:47], v[148:151], v[72:75], v[32:47]
    v_max3_u32 v4, v4, v72, v73
    v_mfma_f32_32x32x16_bf16 v[16:31], v[144:147], v[72:75], v[16:31]
    v_max3_u32 v4, v4, v74, v75
    s_waitcnt vmcnt(12)
    v_mfma_f32_32x32x16_bf16 v[32:47], v[156:159], v[76:79], v[32:47]
    v_max3_u32 v4, v4, v76, v77
    v_mfma_f32_32x32x16_bf16 v[16:31], v[152:155], v[76:79], v[16:31]
    v_max3_u32 v4, v4, v78, v79
    s_waitcnt vmcnt(11)
    v_mfma_f32_32x32x16_bf16 v[32:47], v[164:167], v[80:83], v[32:47]
    v_max3_u32 v4, v4, v80, v81
    v_mfma_f32_32x32x16_bf16 v[16:31], v[160:163], v[80:83], v[16:31]
    v_max3_u32 v4, v4, v82, v83
    s_waitcnt vmcnt(10)
    v_mfma_f32_32x32x16_bf16 v[32:47], v[172:175], v[84:87], v[32:47]
    v_max3_u32 v4, v4, v84, v85
    v_mfma_f32_32x32x16_bf16 v[16:31], v[168:171], v[84:87], v[16:31]
    v_max3_u32 v4, v4, v86, v87
    s_waitcnt vmcnt(9)
    v_mfma_f32_32x32x16_bf16 v[32:47], v[180:183], v[88:91], v[32:47]
    v_max3_u32 v4, v4, v88, v89
    v_mfma_f32_32x32x16_bf16 v[16:31], v[176:179], v[88:91], v[16:31]
    v_max3_u32 v4, v4, v90, v91
    s_waitcnt vmcnt(8)
    v_mfma_f32_32x32x16_bf16 v[32:47], v[188:191], v[92:95], v[32:47]
    v_max3_u32 v4, v4, v92, v93
    v_mfma_f32_32x32x16_bf16 v[16:31], v[184:187], v[92:95], v[16:31]
    v_max3_u32 v4, v4, v94, v95
    s_waitcnt vmcnt(7)
    v_mfma_f32_32x32x16_bf16 v[32:47], v[196:199], v[96:99], v[32:47]
    v_max3_u32 v4, v4, v96, v97
    v_mfma_f32_32x32x16_bf16 v[16:31], v[192:195], v[96:99], v[16:31]
    v_max3_u32 v4, v4, v98, v99
    s_waitcnt vmcnt(6)
    v_mfma_f32_32x32x16_bf16 v[32:47], v[204:207], v[100:103], v[32:47]
    v_max3_u32 v4, v4, v100, v101
    v_mfma_f32_32x32x16_bf16 v[16:31], v[200:203], v[100:103], v[16:31]
    v_max3_u32 v4, v4, v102, v103
    s_waitcnt vmcnt(5)
    v_mfma_f32_32x32x16_bf16 v[32:47], v[212:215], v[104:107], v[32:47]
    v_max3_u32 v4, v4, v104, v105
    v_mfma_f32_32x32x16_bf16 v[16:31], v[208:211], v[104:107], v[16:31]
    v_max3_u32 v4, v4, v106, v107
    s_waitcnt vmcnt(4)
    v_mfma_f32_32x32x16_bf16 v[32:47], v[220:223], v[108:111], v[32:47]
    v_max3_u32 v4, v4, v108, v109
    v_mfma_f32_32x32x16_bf16 v[16:31], v[216:219], v[108:111], v[16:31]
    v_max3_u32 v4, v4, v110, v111
    s_waitcnt vmcnt(3)
    v_mfma_f32_32x32x16_bf16 v[32:47], v[228:231], v[112:115], v[32:47]
    v_max3_u32 v4, v4, v112, v113
    v_mfma_f32_32x32x16_bf16 v[16:31], v[224:227], v[112:115], v[16:31]
    v_max3_u32 v4, v4, v114, v115
    s_waitcnt vmcnt(2)
    v_mfma_f32_32x32x16_bf16 v[32:47], v[236:239], v[116:119], v[32:47]
    v_max3_u32 v4, v4, v116, v117
    v_mfma_f32_32x32x16_bf16 v[16:31], v[232:235], v[116:119], v[16:31]
    v_max3_u32 v4, v4, v118, v119
    s_waitcnt vmcnt(1)
    v_mfma_f32_32x32x16_bf16 v[32:47], v[244:247], v[120:123], v[32:47]
    v_max3_u32 v4, v4, v120, v121
    v_mfma_f32_32x32x16_bf16 v[16:31], v[240:243], v[120:123], v[16:31]
    v_max3_u32 v4, v4, v122, v123
    s_waitcnt vmcnt(0)
    v_mfma_f32_32x32x16_bf16 v[32:47], v[252:255], v[124:127], v[32:47]
    v_max3_u32 v4, v4, v124, v125
    v_mfma_f32_32x32x16_bf16 v[16:31], v[248:251], v[124:127], v[16:31]
    v_max3_u32 v4, v4, v126, v127
    v_cmp_eq_u32 vcc, -1, v4
    s_nop 0
    s_cbranch_vccz L_o_done
    s_sub_u32 s70, s70, 1
    s_nop 7
    s_cbranch_scc0 L_o_again
L_o_done:
    s_mov_b32 s57, 0xffff0000
    s_nop 3
    v_lshlrev_b32 v64, 16, v8
    v_and_b32 v65, s57, v8
    v_lshlrev_b32 v66, 16, v9
    v_and_b32 v67, s57, v9
    v_lshlrev_b32 v68, 16, v10
    v_and_b32 v69, s57, v10
    ds_write_b128 v2, v[32:35] offset:0
    ds_write_b128 v2, v[36:39] offset:1024
    ds_write_b128 v2, v[40:43] offset:2048
    ds_write_b128 v2, v[44:47] offset:3072
    v_lshlrev_b32 v70, 16, v11
    v_and_b32 v71, s57, v11
    v_lshlrev_b32 v72, 16, v12
    v_and_b32 v73, s57, v12
    v_lshlrev_b32 v74, 16, v13
    v_and_b32 v75, s57, v13
    v_lshlrev_b32 v76, 16, v14
    v_and_b32 v77, s57, v14
    v_lshlrev_b32 v78, 16, v15
    v_and_b32 v79, s57, v15
    s_waitcnt lgkmcnt(0)
    s_barrier
    ds_read_b128 v[32:35], v3 offset:0
    ds_read_b128 v[36:39], v3 offset:1024
    ds_read_b128 v[40:43], v3 offset:2048
    ds_read_b128 v[44:47], v3 offset:3072
    s_waitcnt lgkmcnt(3)
    v_add_f32 v16, v16, v32
    v_add_f32 v17, v17, v33
    v_add_f32 v18, v18, v34
    v_add_f32 v19, v19, v35
    v_fma_f32 v64, v16, v48, v64
    v_fma_f32 v65, v17, v49, v65
    v_fma_f32 v66, v18, v50, v66
    v_fma_f32 v67, v19, v51, v67
    v_cvt_pk_bf16_f32 v8, v64, v65
    v_cvt_pk_bf16_f32 v9, v66, v67
    s_waitcnt lgkmcnt(2)
    v_add_f32 v20, v20, v36
    v_add_f32 v21, v21, v37
    v_add_f32 v22, v22, v38
    v_add_f32 v23, v23, v39
    v_fma_f32 v68, v20, v52, v68
    v_fma_f32 v69, v21, v53, v69
    v_fma_f32 v70, v22, v54, v70
    v_fma_f32 v71, v23, v55, v71
    v_cvt_pk_bf16_f32 v10, v68, v69
    v_cvt_pk_bf16_f32 v11, v70, v71
    s_nop 0
    v_permlane32_swap_b32 v8, v10
    v_permlane32_swap_b32 v9, v11
    buffer_store_dwordx4 v[8:11], v7, s[32:35], s59 offen offset:0
    s_waitcnt lgkmcnt(1)
    v_add_f32 v24, v24, v40
    v_add_f32 v25, v25, v41
    v_add_f32 v26, v26, v42
    v_add_f32 v27, v27, v43
    v_fma_f32 v72, v24, v56, v72
    v_fma_f32 v73, v25, v57, v73
    v_fma_f32 v74, v26, v58, v74
    v_fma_f32 v75, v27, v59, v75
    v_cvt_pk_bf16_f32 v12, v72, v73
    v_cvt_pk_bf16_f32 v13, v74, v75
    s_waitcnt lgkmcnt(0)
    v_add_f32 v28, v28, v44
    v_add_f32 v29, v29, v45
    v_add_f32 v30, v30, v46
    v_add_f32 v31, v31, v47
    v_fma_f32 v76, v28, v60, v76
    v_fma_f32 v77, v29, v61, v77
    v_fma_f32 v78, v30, v62, v78
    v_fma_f32 v79, v31, v63, v79
    v_cvt_pk_bf16_f32 v14, v76, v77
    v_cvt_pk_bf16_f32 v15, v78, v79
    s_nop 0
    v_permlane32_swap_b32 v12, v14
    v_permlane32_swap_b32 v13, v15
    buffer_store_dwordx4 v[12:15], v7, s[32:35], s59 offen offset:32
L_exit:
    s_endpgm
L_code_end:
.section .rodata,"a"
.p2align 6
.amdhsa_kernel recurrent_scan__softmax_full_mha__glu_gated_swiglu__prompt_kernel
  .amdhsa_next_free_vgpr 256
  .amdhsa_next_free_sgpr 102
  .amdhsa_accum_offset 256
  .amdhsa_group_segment_fixed_size 0
  .amdhsa_kernarg_size 80
  .amdhsa_user_sgpr_count 2
  .amdhsa_user_sgpr_kernarg_segment_ptr 1
  .amdhsa_system_sgpr_workgroup_id_x 1
.end_amdhsa_kernel
```
